```python
import torch

def _softmax(x, axis=-1):
    return torch.softmax(x, dim=axis)

def _gelu(x):
    return torch.nn.functional.gelu(x, approximate='tanh')

def _silu(x):
    return torch.nn.functional.silu(x)

def _sigmoid(x):
    return torch.sigmoid(x)

def _layernorm(x, axis=-1, eps=1e-05):
    m = x.mean(dim=axis, keepdim=True)
    v = x.var(dim=axis, keepdim=True, unbiased=False)
    return (x - m) / torch.sqrt(v + eps)

def _scatter_add(tgt, idx, src, axis=0):
    return tgt.clone().index_add_(axis, idx, src)

def _segment_sum(src, seg, n):
    out = torch.zeros((n,) + src.shape[1:], dtype=src.dtype)
    return out.index_add_(0, seg, src)

def _pad(x, pw):
    flat = tuple((v for pair in reversed(pw) for v in pair))
    return torch.nn.functional.pad(x, flat)
kernel_name = 'adaLN_cond__ssm_conv_s4__dense_activation_silu__prompt'

def setup_inputs():

    _w = lambda a: (lambda t: t.to(torch.bfloat16) if t.is_floating_point() else t)(torch.as_tensor(a))

    def _A_setup():
        B, L, D, N = (1, 2048, 576, 128)
        A_re = -(lambda _x: torch.exp(torch.as_tensor(_x)))((lambda *s: torch.randn(*s, dtype=torch.bfloat16) * 3.2)(D, N))
        A_im = torch.pi * (lambda *s: torch.randn(*s, dtype=torch.bfloat16) * 0.05)(D, N)
        B_re = (lambda *s: torch.randn(*s, dtype=torch.bfloat16) * 0.1)(D, N)
        B_im = (lambda *s: torch.randn(*s, dtype=torch.bfloat16) * 0.1)(D, N)
        C_re = (lambda *s: torch.randn(*s, dtype=torch.bfloat16) * 0.1)(D, N)
        C_im = (lambda *s: torch.randn(*s, dtype=torch.bfloat16) * 0.1)(D, N)
        log_dt = (lambda *s: torch.randn(*s, dtype=torch.bfloat16) * 0.05)(D) * 0.5 - 4.0
        Dskip = (lambda *s: torch.randn(*s, dtype=torch.bfloat16) * 0.05)(D)
        return {'u': _w((lambda *s: torch.randn(*s, dtype=torch.bfloat16) * 0.05)(B, L, D)), 'A_re': _w(A_re), 'A_im': _w(A_im), 'B_re': _w(B_re), 'B_im': _w(B_im), 'C_re': _w(C_re), 'C_im': _w(C_im), 'log_dt': _w(log_dt), 'Dskip': _w(Dskip)}
    _A_in = _A_setup()

    def _B_setup():
        B, S, D, F = (1, 2048, 576, 4608)
        return {'x': _w((lambda *s: torch.randn(*s, dtype=torch.bfloat16) * 0.05)(B, S, D)), 'w1': _w((lambda *s: torch.randn(*s, dtype=torch.bfloat16) * 3.2)(D, F) * D ** (-0.5)), 'w2': _w((lambda *s: torch.randn(*s, dtype=torch.bfloat16) * 0.4)(F, D) * F ** (-0.5))}
    _B_in = _B_setup()
    return {'A_u': _A_in['u'], 'A_A_re': _A_in['A_re'], 'A_A_im': _A_in['A_im'], 'A_B_re': _A_in['B_re'], 'A_B_im': _A_in['B_im'], 'A_C_re': _A_in['C_re'], 'A_C_im': _A_in['C_im'], 'A_log_dt': _A_in['log_dt'], 'A_Dskip': _A_in['Dskip'], 'B_x': _B_in['x'], 'B_w1': _B_in['w1'], 'B_w2': _B_in['w2'], 'c': _w((lambda *s: torch.randn(*s, dtype=torch.bfloat16) * 0.2)(1, 576) * 8.0), 'w_mod': _w((lambda *s: torch.randn(*s, dtype=torch.bfloat16) * 0.2)(576, 6 * 576) * 576 ** (-0.5) * 8.0)}

def reference(A_u, A_A_re, A_A_im, A_B_re, A_B_im, A_C_re, A_C_im, A_log_dt, A_Dskip, B_x, B_w1, B_w2, c, w_mod):

    def _A_ref(u, A_re, A_im, B_re, B_im, C_re, C_im, log_dt, Dskip):
        Bsz, L, D = u.shape
        dt = torch.exp(log_dt)[:, None]
        A = A_re + 1j * A_im
        Bc = B_re + 1j * B_im
        Cc = C_re + 1j * C_im
        logdA = dt * A
        dB = dt * Bc
        l = (lambda x, dt: x.to(dt))(torch.arange(L), A_re.dtype)
        P = torch.exp(logdA[:, :, None] * l[None, None, :])
        K = torch.einsum('dn,dnl,dn->dl', Cc, P, dB).real
        L2 = 2 * L
        Kp = _pad(K, ((0, 0), (0, L)))
        up = (lambda x, *d: x.permute(*d))(u, 0, 2, 1)
        up = _pad(up, ((0, 0), (0, 0), (0, L)))
        Kf = (lambda x, axes=(-2, -1): torch.fft.rfft2(x.float(), dim=axes))(Kp[:, None, :], axes=(-2, -1))
        Uf = (lambda x, axes=(-2, -1): torch.fft.rfft2(x.float(), dim=axes))(up[:, :, None, :], axes=(-2, -1))
        Yf = Uf * Kf[None, :, :, :]
        y = (lambda x, s, axes=(-2, -1): torch.fft.irfft2(x, s=s, dim=axes).to(torch.bfloat16))(Yf, (1, L2), axes=(-2, -1))[:, :, 0, :L]
        y = (lambda x, *d: x.permute(*d))(y, 0, 2, 1) + u * Dskip[None, None, :]
        return y

    def _B_ref(x, w1, w2):
        h = torch.einsum('bsd,df->bsf', x, w1)
        h = _silu(h)
        out = torch.einsum('bsf,fd->bsd', h, w2)
        return out
    x = A_u
    mod = (_silu(c) @ w_mod).reshape(c.shape[0], 6, 1, -1)
    sa, ca, ga, sb, cb, gb = (mod[:, 0].clone(), mod[:, 1].clone(), mod[:, 2].clone(), mod[:, 3].clone(), mod[:, 4].clone(), mod[:, 5].clone())
    h = _layernorm(x, axis=-1) * (1 + ca) + sa
    x = x + ga * _A_ref(h, A_A_re, A_A_im, A_B_re, A_B_im, A_C_re, A_C_im, A_log_dt, A_Dskip)
    h = _layernorm(x, axis=-1) * (1 + cb) + sb
    x = x + gb * _B_ref(h, B_w1, B_w2)
    return x
```

```asm
; @launch kernel=prep_kernel grid=(1310,1,1) block=(256,1,1) lds=20480
; @launch kernel=conv_kernel grid=(576,1,1) block=(256,1,1) lds=43520
; @launch kernel=ln2_kernel grid=(32,1,1) block=(1024,1,1) lds=157696
; @launch kernel=mlp_kernel grid=(256,1,1) block=(256,1,1) lds=151552
; @launch kernel=reduce_kernel grid=(576,1,1) block=(256,1,1) lds=0
.amdgcn_target "amdgcn-amd-amdhsa--gfx950"
.text
.globl prep_kernel
.p2align 8
.type prep_kernel,@function
prep_kernel:
    s_cmp_ge_u32 s2, 1310
    s_cbranch_scc1 prep_end
    s_load_dwordx2 s[18:19], s[0:1], 128
    v_and_b32 v1, 63, v0
    v_lshrrev_b32 v2, 6, v0
    s_cmp_lt_u32 s2, 32
    s_cbranch_scc1 prep_ln1
    s_cmp_lt_u32 s2, 86
    s_cbranch_scc1 prep_mod
    s_sub_u32 s2, s2, 86
    s_cmp_lt_u32 s2, 576
    s_cbranch_scc1 prep_kgen
    s_branch prep_pack
prep_kgen:
    s_load_dwordx4 s[4:7], s[0:1], 8
    s_load_dwordx4 s[8:11], s[0:1], 24
    s_load_dwordx4 s[12:15], s[0:1], 40
    s_load_dwordx2 s[16:17], s[0:1], 56
    v_and_b32 v3, 15, v1
    v_lshrrev_b32 v4, 4, v1
    v_lshrrev_b32 v5, 1, v4
    v_and_b32 v6, 1, v4
    v_cmp_eq_u32 s[20:21], 1, v6
    s_lshl_b32 s22, s2, 8
    v_lshlrev_b32 v7, 6, v2
    v_lshlrev_b32 v8, 5, v5
    v_add3_u32 v7, v7, v8, s22
    v_cvt_f32_u32 v9, v3
    s_mov_b32 s23, 0x3fb8aa3b
    s_mov_b32 s24, 0x3e22f983
    v_mul_f32 v10, s23, v9
    v_mul_f32 v11, s24, v9
    v_mul_f32 v12, 16.0, v10
    v_mul_f32 v13, 16.0, v11
    s_mov_b32 s25, 0x43b8aa3b
    s_mov_b32 s26, 0x4222f983
    v_mov_b32 v14, s2
    v_lshlrev_b32 v14, 1, v14
    s_waitcnt lgkmcnt(0)
    global_load_dwordx4 v[16:19], v7, s[4:5]
    global_load_dwordx4 v[20:23], v7, s[4:5] offset:16
    global_load_dwordx4 v[24:27], v7, s[6:7]
    global_load_dwordx4 v[28:31], v7, s[6:7] offset:16
    global_load_dwordx4 v[32:35], v7, s[8:9]
    global_load_dwordx4 v[36:39], v7, s[8:9] offset:16
    global_load_dwordx4 v[40:43], v7, s[10:11]
    global_load_dwordx4 v[44:47], v7, s[10:11] offset:16
    global_load_dwordx4 v[48:51], v7, s[12:13]
    global_load_dwordx4 v[52:55], v7, s[12:13] offset:16
    global_load_dwordx4 v[56:59], v7, s[14:15]
    global_load_dwordx4 v[60:63], v7, s[14:15] offset:16
    global_load_ushort v15, v14, s[16:17]
    v_mov_b32 v128, 0
    v_mov_b32 v129, 0
    v_mov_b32 v130, 0
    v_mov_b32 v131, 0
    v_mov_b32 v132, 0
    v_mov_b32 v133, 0
    v_mov_b32 v134, 0
    v_mov_b32 v135, 0
    v_mov_b32 v136, 0
    v_mov_b32 v137, 0
    v_mov_b32 v138, 0
    v_mov_b32 v139, 0
    v_mov_b32 v140, 0
    v_mov_b32 v141, 0
    v_mov_b32 v142, 0
    v_mov_b32 v143, 0
    s_waitcnt vmcnt(0)
    v_lshlrev_b32 v15, 16, v15
    v_mul_f32 v15, s23, v15
    v_exp_f32 v15, v15
    s_nop 0
    v_cvt_pk_bf16_f32 v15, v15, v15
    v_lshlrev_b32 v15, 16, v15
    v_lshlrev_b32 v64, 16, v16
    v_lshlrev_b32 v65, 16, v24
    v_lshlrev_b32 v66, 16, v32
    v_lshlrev_b32 v67, 16, v40
    v_lshlrev_b32 v68, 16, v48
    v_lshlrev_b32 v69, 16, v56
    v_mul_f32 v70, v15, v64
    v_mul_f32 v71, v15, v65
    v_mul_f32 v72, v15, v66
    v_mul_f32 v73, v15, v67
    v_mul_f32 v74, v68, v72
    v_mul_f32 v75, v68, v73
    v_fma_f32 v74, -v69, v73, v74
    v_fma_f32 v75, v69, v72, v75
    v_mul_f32 v78, v12, v70
    v_mul_f32 v79, v13, v71
    v_exp_f32 v80, v78
    v_fract_f32 v79, v79
    v_cos_f32 v81, v79
    v_sin_f32 v82, v79
    s_nop 0
    v_mul_f32 v76, v80, v81
    v_mul_f32 v77, v80, v82
    v_mul_f32 v78, v10, v70
    v_mul_f32 v79, v11, v71
    v_exp_f32 v80, v78
    v_fract_f32 v79, v79
    v_cos_f32 v81, v79
    v_sin_f32 v82, v79
    s_nop 0
    v_mul_f32 v83, v80, v81
    v_mul_f32 v84, v80, v82
    v_mul_f32 v78, s25, v70
    v_mul_f32 v79, s26, v71
    v_exp_f32 v80, v78
    v_fract_f32 v79, v79
    v_cos_f32 v81, v79
    v_sin_f32 v82, v79
    s_nop 0
    v_mul_f32 v85, v80, v81
    v_mul_f32 v86, v80, v82
    v_mul_f32 v87, v74, v76
    v_mul_f32 v88, v74, v77
    v_fma_f32 v87, -v75, v77, v87
    v_fma_f32 v88, v75, v76, v88
    v_mul_f32 v89, v76, v76
    v_mul_f32 v90, v76, v77
    v_fma_f32 v89, -v77, v77, v89
    v_add_f32 v90, v90, v90
    v_mul_f32 v91, v89, v89
    v_mul_f32 v92, v89, v90
    v_fma_f32 v91, -v90, v90, v91
    v_add_f32 v92, v92, v92
    v_mul_f32 v93, v91, v91
    v_mul_f32 v94, v91, v92
    v_fma_f32 v93, -v92, v92, v93
    v_add_f32 v94, v94, v94
    v_mul_f32 v95, v85, v85
    v_mul_f32 v96, v85, v86
    v_fma_f32 v95, -v86, v86, v95
    v_add_f32 v96, v96, v96
    v_mul_f32 v97, v95, v95
    v_mul_f32 v98, v95, v96
    v_fma_f32 v97, -v96, v96, v97
    v_add_f32 v98, v98, v98
    v_mul_f32 v99, v74, v85
    v_mul_f32 v100, v74, v86
    v_fma_f32 v99, -v75, v86, v99
    v_fma_f32 v100, v75, v85, v100
    v_mul_f32 v101, v99, v89
    v_mul_f32 v102, v99, v90
    v_fma_f32 v101, -v100, v90, v101
    v_fma_f32 v102, v100, v89, v102
    v_mul_f32 v99, v74, v95
    v_mul_f32 v100, v74, v96
    v_fma_f32 v99, -v75, v96, v99
    v_fma_f32 v100, v75, v95, v100
    v_mul_f32 v103, v99, v91
    v_mul_f32 v104, v99, v92
    v_fma_f32 v103, -v100, v92, v103
    v_fma_f32 v104, v100, v91, v104
    v_mul_f32 v99, v74, v97
    v_mul_f32 v100, v74, v98
    v_fma_f32 v99, -v75, v98, v99
    v_fma_f32 v100, v75, v97, v100
    v_mul_f32 v105, v99, v93
    v_mul_f32 v106, v99, v94
    v_fma_f32 v105, -v100, v94, v105
    v_fma_f32 v106, v100, v93, v106
    v_mul_f32 v107, v83, v83
    v_mul_f32 v108, v83, v84
    v_fma_f32 v107, -v84, v84, v107
    v_add_f32 v108, v108, v108
    v_mul_f32 v109, v107, v107
    v_mul_f32 v110, v107, v108
    v_fma_f32 v109, -v108, v108, v109
    v_add_f32 v110, v110, v110
    v_mul_f32 v111, v109, v109
    v_mul_f32 v112, v109, v110
    v_fma_f32 v111, -v110, v110, v111
    v_add_f32 v112, v112, v112
    v_cndmask_b32_e64 v113, v87, -v88, s[20:21]
    v_cndmask_b32_e64 v114, v83, v84, s[20:21]
    v_cndmask_b32_e64 v115, v101, -v102, s[20:21]
    v_cndmask_b32_e64 v116, v107, v108, s[20:21]
    v_cndmask_b32_e64 v117, v103, -v104, s[20:21]
    v_cndmask_b32_e64 v118, v109, v110, s[20:21]
    v_cndmask_b32_e64 v119, v105, -v106, s[20:21]
    v_cndmask_b32_e64 v120, v111, v112, s[20:21]
    s_nop 1
    v_mfma_f32_16x16x4_f32 v[128:131], v113, v114, v[128:131]
    v_mfma_f32_16x16x4_f32 v[132:135], v115, v116, v[132:135]
    v_mfma_f32_16x16x4_f32 v[136:139], v117, v118, v[136:139]
    v_mfma_f32_16x16x4_f32 v[140:143], v119, v120, v[140:143]
    v_and_b32 v64, 0xffff0000, v16
    v_and_b32 v65, 0xffff0000, v24
    v_and_b32 v66, 0xffff0000, v32
    v_and_b32 v67, 0xffff0000, v40
    v_and_b32 v68, 0xffff0000, v48
    v_and_b32 v69, 0xffff0000, v56
    v_mul_f32 v70, v15, v64
    v_mul_f32 v71, v15, v65
    v_mul_f32 v72, v15, v66
    v_mul_f32 v73, v15, v67
    v_mul_f32 v74, v68, v72
    v_mul_f32 v75, v68, v73
    v_fma_f32 v74, -v69, v73, v74
    v_fma_f32 v75, v69, v72, v75
    v_mul_f32 v78, v12, v70
    v_mul_f32 v79, v13, v71
    v_exp_f32 v80, v78
    v_fract_f32 v79, v79
    v_cos_f32 v81, v79
    v_sin_f32 v82, v79
    s_nop 0
    v_mul_f32 v76, v80, v81
    v_mul_f32 v77, v80, v82
    v_mul_f32 v78, v10, v70
    v_mul_f32 v79, v11, v71
    v_exp_f32 v80, v78
    v_fract_f32 v79, v79
    v_cos_f32 v81, v79
    v_sin_f32 v82, v79
    s_nop 0
    v_mul_f32 v83, v80, v81
    v_mul_f32 v84, v80, v82
    v_mul_f32 v78, s25, v70
    v_mul_f32 v79, s26, v71
    v_exp_f32 v80, v78
    v_fract_f32 v79, v79
    v_cos_f32 v81, v79
    v_sin_f32 v82, v79
    s_nop 0
    v_mul_f32 v85, v80, v81
    v_mul_f32 v86, v80, v82
    v_mul_f32 v87, v74, v76
    v_mul_f32 v88, v74, v77
    v_fma_f32 v87, -v75, v77, v87
    v_fma_f32 v88, v75, v76, v88
    v_mul_f32 v89, v76, v76
    v_mul_f32 v90, v76, v77
    v_fma_f32 v89, -v77, v77, v89
    v_add_f32 v90, v90, v90
    v_mul_f32 v91, v89, v89
    v_mul_f32 v92, v89, v90
    v_fma_f32 v91, -v90, v90, v91
    v_add_f32 v92, v92, v92
    v_mul_f32 v93, v91, v91
    v_mul_f32 v94, v91, v92
    v_fma_f32 v93, -v92, v92, v93
    v_add_f32 v94, v94, v94
    v_mul_f32 v95, v85, v85
    v_mul_f32 v96, v85, v86
    v_fma_f32 v95, -v86, v86, v95
    v_add_f32 v96, v96, v96
    v_mul_f32 v97, v95, v95
    v_mul_f32 v98, v95, v96
    v_fma_f32 v97, -v96, v96, v97
    v_add_f32 v98, v98, v98
    v_mul_f32 v99, v74, v85
    v_mul_f32 v100, v74, v86
    v_fma_f32 v99, -v75, v86, v99
    v_fma_f32 v100, v75, v85, v100
    v_mul_f32 v101, v99, v89
    v_mul_f32 v102, v99, v90
    v_fma_f32 v101, -v100, v90, v101
    v_fma_f32 v102, v100, v89, v102
    v_mul_f32 v99, v74, v95
    v_mul_f32 v100, v74, v96
    v_fma_f32 v99, -v75, v96, v99
    v_fma_f32 v100, v75, v95, v100
    v_mul_f32 v103, v99, v91
    v_mul_f32 v104, v99, v92
    v_fma_f32 v103, -v100, v92, v103
    v_fma_f32 v104, v100, v91, v104
    v_mul_f32 v99, v74, v97
    v_mul_f32 v100, v74, v98
    v_fma_f32 v99, -v75, v98, v99
    v_fma_f32 v100, v75, v97, v100
    v_mul_f32 v105, v99, v93
    v_mul_f32 v106, v99, v94
    v_fma_f32 v105, -v100, v94, v105
    v_fma_f32 v106, v100, v93, v106
    v_mul_f32 v107, v83, v83
    v_mul_f32 v108, v83, v84
    v_fma_f32 v107, -v84, v84, v107
    v_add_f32 v108, v108, v108
    v_mul_f32 v109, v107, v107
    v_mul_f32 v110, v107, v108
    v_fma_f32 v109, -v108, v108, v109
    v_add_f32 v110, v110, v110
    v_mul_f32 v111, v109, v109
    v_mul_f32 v112, v109, v110
    v_fma_f32 v111, -v110, v110, v111
    v_add_f32 v112, v112, v112
    v_cndmask_b32_e64 v113, v87, -v88, s[20:21]
    v_cndmask_b32_e64 v114, v83, v84, s[20:21]
    v_cndmask_b32_e64 v115, v101, -v102, s[20:21]
    v_cndmask_b32_e64 v116, v107, v108, s[20:21]
    v_cndmask_b32_e64 v117, v103, -v104, s[20:21]
    v_cndmask_b32_e64 v118, v109, v110, s[20:21]
    v_cndmask_b32_e64 v119, v105, -v106, s[20:21]
    v_cndmask_b32_e64 v120, v111, v112, s[20:21]
    s_nop 1
    v_mfma_f32_16x16x4_f32 v[128:131], v113, v114, v[128:131]
    v_mfma_f32_16x16x4_f32 v[132:135], v115, v116, v[132:135]
    v_mfma_f32_16x16x4_f32 v[136:139], v117, v118, v[136:139]
    v_mfma_f32_16x16x4_f32 v[140:143], v119, v120, v[140:143]
    v_lshlrev_b32 v64, 16, v17
    v_lshlrev_b32 v65, 16, v25
    v_lshlrev_b32 v66, 16, v33
    v_lshlrev_b32 v67, 16, v41
    v_lshlrev_b32 v68, 16, v49
    v_lshlrev_b32 v69, 16, v57
    v_mul_f32 v70, v15, v64
    v_mul_f32 v71, v15, v65
    v_mul_f32 v72, v15, v66
    v_mul_f32 v73, v15, v67
    v_mul_f32 v74, v68, v72
    v_mul_f32 v75, v68, v73
    v_fma_f32 v74, -v69, v73, v74
    v_fma_f32 v75, v69, v72, v75
    v_mul_f32 v78, v12, v70
    v_mul_f32 v79, v13, v71
    v_exp_f32 v80, v78
    v_fract_f32 v79, v79
    v_cos_f32 v81, v79
    v_sin_f32 v82, v79
    s_nop 0
    v_mul_f32 v76, v80, v81
    v_mul_f32 v77, v80, v82
    v_mul_f32 v78, v10, v70
    v_mul_f32 v79, v11, v71
    v_exp_f32 v80, v78
    v_fract_f32 v79, v79
    v_cos_f32 v81, v79
    v_sin_f32 v82, v79
    s_nop 0
    v_mul_f32 v83, v80, v81
    v_mul_f32 v84, v80, v82
    v_mul_f32 v78, s25, v70
    v_mul_f32 v79, s26, v71
    v_exp_f32 v80, v78
    v_fract_f32 v79, v79
    v_cos_f32 v81, v79
    v_sin_f32 v82, v79
    s_nop 0
    v_mul_f32 v85, v80, v81
    v_mul_f32 v86, v80, v82
    v_mul_f32 v87, v74, v76
    v_mul_f32 v88, v74, v77
    v_fma_f32 v87, -v75, v77, v87
    v_fma_f32 v88, v75, v76, v88
    v_mul_f32 v89, v76, v76
    v_mul_f32 v90, v76, v77
    v_fma_f32 v89, -v77, v77, v89
    v_add_f32 v90, v90, v90
    v_mul_f32 v91, v89, v89
    v_mul_f32 v92, v89, v90
    v_fma_f32 v91, -v90, v90, v91
    v_add_f32 v92, v92, v92
    v_mul_f32 v93, v91, v91
    v_mul_f32 v94, v91, v92
    v_fma_f32 v93, -v92, v92, v93
    v_add_f32 v94, v94, v94
    v_mul_f32 v95, v85, v85
    v_mul_f32 v96, v85, v86
    v_fma_f32 v95, -v86, v86, v95
    v_add_f32 v96, v96, v96
    v_mul_f32 v97, v95, v95
    v_mul_f32 v98, v95, v96
    v_fma_f32 v97, -v96, v96, v97
    v_add_f32 v98, v98, v98
    v_mul_f32 v99, v74, v85
    v_mul_f32 v100, v74, v86
    v_fma_f32 v99, -v75, v86, v99
    v_fma_f32 v100, v75, v85, v100
    v_mul_f32 v101, v99, v89
    v_mul_f32 v102, v99, v90
    v_fma_f32 v101, -v100, v90, v101
    v_fma_f32 v102, v100, v89, v102
    v_mul_f32 v99, v74, v95
    v_mul_f32 v100, v74, v96
    v_fma_f32 v99, -v75, v96, v99
    v_fma_f32 v100, v75, v95, v100
    v_mul_f32 v103, v99, v91
    v_mul_f32 v104, v99, v92
    v_fma_f32 v103, -v100, v92, v103
    v_fma_f32 v104, v100, v91, v104
    v_mul_f32 v99, v74, v97
    v_mul_f32 v100, v74, v98
    v_fma_f32 v99, -v75, v98, v99
    v_fma_f32 v100, v75, v97, v100
    v_mul_f32 v105, v99, v93
    v_mul_f32 v106, v99, v94
    v_fma_f32 v105, -v100, v94, v105
    v_fma_f32 v106, v100, v93, v106
    v_mul_f32 v107, v83, v83
    v_mul_f32 v108, v83, v84
    v_fma_f32 v107, -v84, v84, v107
    v_add_f32 v108, v108, v108
    v_mul_f32 v109, v107, v107
    v_mul_f32 v110, v107, v108
    v_fma_f32 v109, -v108, v108, v109
    v_add_f32 v110, v110, v110
    v_mul_f32 v111, v109, v109
    v_mul_f32 v112, v109, v110
    v_fma_f32 v111, -v110, v110, v111
    v_add_f32 v112, v112, v112
    v_cndmask_b32_e64 v113, v87, -v88, s[20:21]
    v_cndmask_b32_e64 v114, v83, v84, s[20:21]
    v_cndmask_b32_e64 v115, v101, -v102, s[20:21]
    v_cndmask_b32_e64 v116, v107, v108, s[20:21]
    v_cndmask_b32_e64 v117, v103, -v104, s[20:21]
    v_cndmask_b32_e64 v118, v109, v110, s[20:21]
    v_cndmask_b32_e64 v119, v105, -v106, s[20:21]
    v_cndmask_b32_e64 v120, v111, v112, s[20:21]
    s_nop 1
    v_mfma_f32_16x16x4_f32 v[128:131], v113, v114, v[128:131]
    v_mfma_f32_16x16x4_f32 v[132:135], v115, v116, v[132:135]
    v_mfma_f32_16x16x4_f32 v[136:139], v117, v118, v[136:139]
    v_mfma_f32_16x16x4_f32 v[140:143], v119, v120, v[140:143]
    v_and_b32 v64, 0xffff0000, v17
    v_and_b32 v65, 0xffff0000, v25
    v_and_b32 v66, 0xffff0000, v33
    v_and_b32 v67, 0xffff0000, v41
    v_and_b32 v68, 0xffff0000, v49
    v_and_b32 v69, 0xffff0000, v57
    v_mul_f32 v70, v15, v64
    v_mul_f32 v71, v15, v65
    v_mul_f32 v72, v15, v66
    v_mul_f32 v73, v15, v67
    v_mul_f32 v74, v68, v72
    v_mul_f32 v75, v68, v73
    v_fma_f32 v74, -v69, v73, v74
    v_fma_f32 v75, v69, v72, v75
    v_mul_f32 v78, v12, v70
    v_mul_f32 v79, v13, v71
    v_exp_f32 v80, v78
    v_fract_f32 v79, v79
    v_cos_f32 v81, v79
    v_sin_f32 v82, v79
    s_nop 0
    v_mul_f32 v76, v80, v81
    v_mul_f32 v77, v80, v82
    v_mul_f32 v78, v10, v70
    v_mul_f32 v79, v11, v71
    v_exp_f32 v80, v78
    v_fract_f32 v79, v79
    v_cos_f32 v81, v79
    v_sin_f32 v82, v79
    s_nop 0
    v_mul_f32 v83, v80, v81
    v_mul_f32 v84, v80, v82
    v_mul_f32 v78, s25, v70
    v_mul_f32 v79, s26, v71
    v_exp_f32 v80, v78
    v_fract_f32 v79, v79
    v_cos_f32 v81, v79
    v_sin_f32 v82, v79
    s_nop 0
    v_mul_f32 v85, v80, v81
    v_mul_f32 v86, v80, v82
    v_mul_f32 v87, v74, v76
    v_mul_f32 v88, v74, v77
    v_fma_f32 v87, -v75, v77, v87
    v_fma_f32 v88, v75, v76, v88
    v_mul_f32 v89, v76, v76
    v_mul_f32 v90, v76, v77
    v_fma_f32 v89, -v77, v77, v89
    v_add_f32 v90, v90, v90
    v_mul_f32 v91, v89, v89
    v_mul_f32 v92, v89, v90
    v_fma_f32 v91, -v90, v90, v91
    v_add_f32 v92, v92, v92
    v_mul_f32 v93, v91, v91
    v_mul_f32 v94, v91, v92
    v_fma_f32 v93, -v92, v92, v93
    v_add_f32 v94, v94, v94
    v_mul_f32 v95, v85, v85
    v_mul_f32 v96, v85, v86
    v_fma_f32 v95, -v86, v86, v95
    v_add_f32 v96, v96, v96
    v_mul_f32 v97, v95, v95
    v_mul_f32 v98, v95, v96
    v_fma_f32 v97, -v96, v96, v97
    v_add_f32 v98, v98, v98
    v_mul_f32 v99, v74, v85
    v_mul_f32 v100, v74, v86
    v_fma_f32 v99, -v75, v86, v99
    v_fma_f32 v100, v75, v85, v100
    v_mul_f32 v101, v99, v89
    v_mul_f32 v102, v99, v90
    v_fma_f32 v101, -v100, v90, v101
    v_fma_f32 v102, v100, v89, v102
    v_mul_f32 v99, v74, v95
    v_mul_f32 v100, v74, v96
    v_fma_f32 v99, -v75, v96, v99
    v_fma_f32 v100, v75, v95, v100
    v_mul_f32 v103, v99, v91
    v_mul_f32 v104, v99, v92
    v_fma_f32 v103, -v100, v92, v103
    v_fma_f32 v104, v100, v91, v104
    v_mul_f32 v99, v74, v97
    v_mul_f32 v100, v74, v98
    v_fma_f32 v99, -v75, v98, v99
    v_fma_f32 v100, v75, v97, v100
    v_mul_f32 v105, v99, v93
    v_mul_f32 v106, v99, v94
    v_fma_f32 v105, -v100, v94, v105
    v_fma_f32 v106, v100, v93, v106
    v_mul_f32 v107, v83, v83
    v_mul_f32 v108, v83, v84
    v_fma_f32 v107, -v84, v84, v107
    v_add_f32 v108, v108, v108
    v_mul_f32 v109, v107, v107
    v_mul_f32 v110, v107, v108
    v_fma_f32 v109, -v108, v108, v109
    v_add_f32 v110, v110, v110
    v_mul_f32 v111, v109, v109
    v_mul_f32 v112, v109, v110
    v_fma_f32 v111, -v110, v110, v111
    v_add_f32 v112, v112, v112
    v_cndmask_b32_e64 v113, v87, -v88, s[20:21]
    v_cndmask_b32_e64 v114, v83, v84, s[20:21]
    v_cndmask_b32_e64 v115, v101, -v102, s[20:21]
    v_cndmask_b32_e64 v116, v107, v108, s[20:21]
    v_cndmask_b32_e64 v117, v103, -v104, s[20:21]
    v_cndmask_b32_e64 v118, v109, v110, s[20:21]
    v_cndmask_b32_e64 v119, v105, -v106, s[20:21]
    v_cndmask_b32_e64 v120, v111, v112, s[20:21]
    s_nop 1
    v_mfma_f32_16x16x4_f32 v[128:131], v113, v114, v[128:131]
    v_mfma_f32_16x16x4_f32 v[132:135], v115, v116, v[132:135]
    v_mfma_f32_16x16x4_f32 v[136:139], v117, v118, v[136:139]
    v_mfma_f32_16x16x4_f32 v[140:143], v119, v120, v[140:143]
    v_lshlrev_b32 v64, 16, v18
    v_lshlrev_b32 v65, 16, v26
    v_lshlrev_b32 v66, 16, v34
    v_lshlrev_b32 v67, 16, v42
    v_lshlrev_b32 v68, 16, v50
    v_lshlrev_b32 v69, 16, v58
    v_mul_f32 v70, v15, v64
    v_mul_f32 v71, v15, v65
    v_mul_f32 v72, v15, v66
    v_mul_f32 v73, v15, v67
    v_mul_f32 v74, v68, v72
    v_mul_f32 v75, v68, v73
    v_fma_f32 v74, -v69, v73, v74
    v_fma_f32 v75, v69, v72, v75
    v_mul_f32 v78, v12, v70
    v_mul_f32 v79, v13, v71
    v_exp_f32 v80, v78
    v_fract_f32 v79, v79
    v_cos_f32 v81, v79
    v_sin_f32 v82, v79
    s_nop 0
    v_mul_f32 v76, v80, v81
    v_mul_f32 v77, v80, v82
    v_mul_f32 v78, v10, v70
    v_mul_f32 v79, v11, v71
    v_exp_f32 v80, v78
    v_fract_f32 v79, v79
    v_cos_f32 v81, v79
    v_sin_f32 v82, v79
    s_nop 0
    v_mul_f32 v83, v80, v81
    v_mul_f32 v84, v80, v82
    v_mul_f32 v78, s25, v70
    v_mul_f32 v79, s26, v71
    v_exp_f32 v80, v78
    v_fract_f32 v79, v79
    v_cos_f32 v81, v79
    v_sin_f32 v82, v79
    s_nop 0
    v_mul_f32 v85, v80, v81
    v_mul_f32 v86, v80, v82
    v_mul_f32 v87, v74, v76
    v_mul_f32 v88, v74, v77
    v_fma_f32 v87, -v75, v77, v87
    v_fma_f32 v88, v75, v76, v88
    v_mul_f32 v89, v76, v76
    v_mul_f32 v90, v76, v77
    v_fma_f32 v89, -v77, v77, v89
    v_add_f32 v90, v90, v90
    v_mul_f32 v91, v89, v89
    v_mul_f32 v92, v89, v90
    v_fma_f32 v91, -v90, v90, v91
    v_add_f32 v92, v92, v92
    v_mul_f32 v93, v91, v91
    v_mul_f32 v94, v91, v92
    v_fma_f32 v93, -v92, v92, v93
    v_add_f32 v94, v94, v94
    v_mul_f32 v95, v85, v85
    v_mul_f32 v96, v85, v86
    v_fma_f32 v95, -v86, v86, v95
    v_add_f32 v96, v96, v96
    v_mul_f32 v97, v95, v95
    v_mul_f32 v98, v95, v96
    v_fma_f32 v97, -v96, v96, v97
    v_add_f32 v98, v98, v98
    v_mul_f32 v99, v74, v85
    v_mul_f32 v100, v74, v86
    v_fma_f32 v99, -v75, v86, v99
    v_fma_f32 v100, v75, v85, v100
    v_mul_f32 v101, v99, v89
    v_mul_f32 v102, v99, v90
    v_fma_f32 v101, -v100, v90, v101
    v_fma_f32 v102, v100, v89, v102
    v_mul_f32 v99, v74, v95
    v_mul_f32 v100, v74, v96
    v_fma_f32 v99, -v75, v96, v99
    v_fma_f32 v100, v75, v95, v100
    v_mul_f32 v103, v99, v91
    v_mul_f32 v104, v99, v92
    v_fma_f32 v103, -v100, v92, v103
    v_fma_f32 v104, v100, v91, v104
    v_mul_f32 v99, v74, v97
    v_mul_f32 v100, v74, v98
    v_fma_f32 v99, -v75, v98, v99
    v_fma_f32 v100, v75, v97, v100
    v_mul_f32 v105, v99, v93
    v_mul_f32 v106, v99, v94
    v_fma_f32 v105, -v100, v94, v105
    v_fma_f32 v106, v100, v93, v106
    v_mul_f32 v107, v83, v83
    v_mul_f32 v108, v83, v84
    v_fma_f32 v107, -v84, v84, v107
    v_add_f32 v108, v108, v108
    v_mul_f32 v109, v107, v107
    v_mul_f32 v110, v107, v108
    v_fma_f32 v109, -v108, v108, v109
    v_add_f32 v110, v110, v110
    v_mul_f32 v111, v109, v109
    v_mul_f32 v112, v109, v110
    v_fma_f32 v111, -v110, v110, v111
    v_add_f32 v112, v112, v112
    v_cndmask_b32_e64 v113, v87, -v88, s[20:21]
    v_cndmask_b32_e64 v114, v83, v84, s[20:21]
    v_cndmask_b32_e64 v115, v101, -v102, s[20:21]
    v_cndmask_b32_e64 v116, v107, v108, s[20:21]
    v_cndmask_b32_e64 v117, v103, -v104, s[20:21]
    v_cndmask_b32_e64 v118, v109, v110, s[20:21]
    v_cndmask_b32_e64 v119, v105, -v106, s[20:21]
    v_cndmask_b32_e64 v120, v111, v112, s[20:21]
    s_nop 1
    v_mfma_f32_16x16x4_f32 v[128:131], v113, v114, v[128:131]
    v_mfma_f32_16x16x4_f32 v[132:135], v115, v116, v[132:135]
    v_mfma_f32_16x16x4_f32 v[136:139], v117, v118, v[136:139]
    v_mfma_f32_16x16x4_f32 v[140:143], v119, v120, v[140:143]
    v_and_b32 v64, 0xffff0000, v18
    v_and_b32 v65, 0xffff0000, v26
    v_and_b32 v66, 0xffff0000, v34
    v_and_b32 v67, 0xffff0000, v42
    v_and_b32 v68, 0xffff0000, v50
    v_and_b32 v69, 0xffff0000, v58
    v_mul_f32 v70, v15, v64
    v_mul_f32 v71, v15, v65
    v_mul_f32 v72, v15, v66
    v_mul_f32 v73, v15, v67
    v_mul_f32 v74, v68, v72
    v_mul_f32 v75, v68, v73
    v_fma_f32 v74, -v69, v73, v74
    v_fma_f32 v75, v69, v72, v75
    v_mul_f32 v78, v12, v70
    v_mul_f32 v79, v13, v71
    v_exp_f32 v80, v78
    v_fract_f32 v79, v79
    v_cos_f32 v81, v79
    v_sin_f32 v82, v79
    s_nop 0
    v_mul_f32 v76, v80, v81
    v_mul_f32 v77, v80, v82
    v_mul_f32 v78, v10, v70
    v_mul_f32 v79, v11, v71
    v_exp_f32 v80, v78
    v_fract_f32 v79, v79
    v_cos_f32 v81, v79
    v_sin_f32 v82, v79
    s_nop 0
    v_mul_f32 v83, v80, v81
    v_mul_f32 v84, v80, v82
    v_mul_f32 v78, s25, v70
    v_mul_f32 v79, s26, v71
    v_exp_f32 v80, v78
    v_fract_f32 v79, v79
    v_cos_f32 v81, v79
    v_sin_f32 v82, v79
    s_nop 0
    v_mul_f32 v85, v80, v81
    v_mul_f32 v86, v80, v82
    v_mul_f32 v87, v74, v76
    v_mul_f32 v88, v74, v77
    v_fma_f32 v87, -v75, v77, v87
    v_fma_f32 v88, v75, v76, v88
    v_mul_f32 v89, v76, v76
    v_mul_f32 v90, v76, v77
    v_fma_f32 v89, -v77, v77, v89
    v_add_f32 v90, v90, v90
    v_mul_f32 v91, v89, v89
    v_mul_f32 v92, v89, v90
    v_fma_f32 v91, -v90, v90, v91
    v_add_f32 v92, v92, v92
    v_mul_f32 v93, v91, v91
    v_mul_f32 v94, v91, v92
    v_fma_f32 v93, -v92, v92, v93
    v_add_f32 v94, v94, v94
    v_mul_f32 v95, v85, v85
    v_mul_f32 v96, v85, v86
    v_fma_f32 v95, -v86, v86, v95
    v_add_f32 v96, v96, v96
    v_mul_f32 v97, v95, v95
    v_mul_f32 v98, v95, v96
    v_fma_f32 v97, -v96, v96, v97
    v_add_f32 v98, v98, v98
    v_mul_f32 v99, v74, v85
    v_mul_f32 v100, v74, v86
    v_fma_f32 v99, -v75, v86, v99
    v_fma_f32 v100, v75, v85, v100
    v_mul_f32 v101, v99, v89
    v_mul_f32 v102, v99, v90
    v_fma_f32 v101, -v100, v90, v101
    v_fma_f32 v102, v100, v89, v102
    v_mul_f32 v99, v74, v95
    v_mul_f32 v100, v74, v96
    v_fma_f32 v99, -v75, v96, v99
    v_fma_f32 v100, v75, v95, v100
    v_mul_f32 v103, v99, v91
    v_mul_f32 v104, v99, v92
    v_fma_f32 v103, -v100, v92, v103
    v_fma_f32 v104, v100, v91, v104
    v_mul_f32 v99, v74, v97
    v_mul_f32 v100, v74, v98
    v_fma_f32 v99, -v75, v98, v99
    v_fma_f32 v100, v75, v97, v100
    v_mul_f32 v105, v99, v93
    v_mul_f32 v106, v99, v94
    v_fma_f32 v105, -v100, v94, v105
    v_fma_f32 v106, v100, v93, v106
    v_mul_f32 v107, v83, v83
    v_mul_f32 v108, v83, v84
    v_fma_f32 v107, -v84, v84, v107
    v_add_f32 v108, v108, v108
    v_mul_f32 v109, v107, v107
    v_mul_f32 v110, v107, v108
    v_fma_f32 v109, -v108, v108, v109
    v_add_f32 v110, v110, v110
    v_mul_f32 v111, v109, v109
    v_mul_f32 v112, v109, v110
    v_fma_f32 v111, -v110, v110, v111
    v_add_f32 v112, v112, v112
    v_cndmask_b32_e64 v113, v87, -v88, s[20:21]
    v_cndmask_b32_e64 v114, v83, v84, s[20:21]
    v_cndmask_b32_e64 v115, v101, -v102, s[20:21]
    v_cndmask_b32_e64 v116, v107, v108, s[20:21]
    v_cndmask_b32_e64 v117, v103, -v104, s[20:21]
    v_cndmask_b32_e64 v118, v109, v110, s[20:21]
    v_cndmask_b32_e64 v119, v105, -v106, s[20:21]
    v_cndmask_b32_e64 v120, v111, v112, s[20:21]
    s_nop 1
    v_mfma_f32_16x16x4_f32 v[128:131], v113, v114, v[128:131]
    v_mfma_f32_16x16x4_f32 v[132:135], v115, v116, v[132:135]
    v_mfma_f32_16x16x4_f32 v[136:139], v117, v118, v[136:139]
    v_mfma_f32_16x16x4_f32 v[140:143], v119, v120, v[140:143]
    v_lshlrev_b32 v64, 16, v19
    v_lshlrev_b32 v65, 16, v27
    v_lshlrev_b32 v66, 16, v35
    v_lshlrev_b32 v67, 16, v43
    v_lshlrev_b32 v68, 16, v51
    v_lshlrev_b32 v69, 16, v59
    v_mul_f32 v70, v15, v64
    v_mul_f32 v71, v15, v65
    v_mul_f32 v72, v15, v66
    v_mul_f32 v73, v15, v67
    v_mul_f32 v74, v68, v72
    v_mul_f32 v75, v68, v73
    v_fma_f32 v74, -v69, v73, v74
    v_fma_f32 v75, v69, v72, v75
    v_mul_f32 v78, v12, v70
    v_mul_f32 v79, v13, v71
    v_exp_f32 v80, v78
    v_fract_f32 v79, v79
    v_cos_f32 v81, v79
    v_sin_f32 v82, v79
    s_nop 0
    v_mul_f32 v76, v80, v81
    v_mul_f32 v77, v80, v82
    v_mul_f32 v78, v10, v70
    v_mul_f32 v79, v11, v71
    v_exp_f32 v80, v78
    v_fract_f32 v79, v79
    v_cos_f32 v81, v79
    v_sin_f32 v82, v79
    s_nop 0
    v_mul_f32 v83, v80, v81
    v_mul_f32 v84, v80, v82
    v_mul_f32 v78, s25, v70
    v_mul_f32 v79, s26, v71
    v_exp_f32 v80, v78
    v_fract_f32 v79, v79
    v_cos_f32 v81, v79
    v_sin_f32 v82, v79
    s_nop 0
    v_mul_f32 v85, v80, v81
    v_mul_f32 v86, v80, v82
    v_mul_f32 v87, v74, v76
    v_mul_f32 v88, v74, v77
    v_fma_f32 v87, -v75, v77, v87
    v_fma_f32 v88, v75, v76, v88
    v_mul_f32 v89, v76, v76
    v_mul_f32 v90, v76, v77
    v_fma_f32 v89, -v77, v77, v89
    v_add_f32 v90, v90, v90
    v_mul_f32 v91, v89, v89
    v_mul_f32 v92, v89, v90
    v_fma_f32 v91, -v90, v90, v91
    v_add_f32 v92, v92, v92
    v_mul_f32 v93, v91, v91
    v_mul_f32 v94, v91, v92
    v_fma_f32 v93, -v92, v92, v93
    v_add_f32 v94, v94, v94
    v_mul_f32 v95, v85, v85
    v_mul_f32 v96, v85, v86
    v_fma_f32 v95, -v86, v86, v95
    v_add_f32 v96, v96, v96
    v_mul_f32 v97, v95, v95
    v_mul_f32 v98, v95, v96
    v_fma_f32 v97, -v96, v96, v97
    v_add_f32 v98, v98, v98
    v_mul_f32 v99, v74, v85
    v_mul_f32 v100, v74, v86
    v_fma_f32 v99, -v75, v86, v99
    v_fma_f32 v100, v75, v85, v100
    v_mul_f32 v101, v99, v89
    v_mul_f32 v102, v99, v90
    v_fma_f32 v101, -v100, v90, v101
    v_fma_f32 v102, v100, v89, v102
    v_mul_f32 v99, v74, v95
    v_mul_f32 v100, v74, v96
    v_fma_f32 v99, -v75, v96, v99
    v_fma_f32 v100, v75, v95, v100
    v_mul_f32 v103, v99, v91
    v_mul_f32 v104, v99, v92
    v_fma_f32 v103, -v100, v92, v103
    v_fma_f32 v104, v100, v91, v104
    v_mul_f32 v99, v74, v97
    v_mul_f32 v100, v74, v98
    v_fma_f32 v99, -v75, v98, v99
    v_fma_f32 v100, v75, v97, v100
    v_mul_f32 v105, v99, v93
    v_mul_f32 v106, v99, v94
    v_fma_f32 v105, -v100, v94, v105
    v_fma_f32 v106, v100, v93, v106
    v_mul_f32 v107, v83, v83
    v_mul_f32 v108, v83, v84
    v_fma_f32 v107, -v84, v84, v107
    v_add_f32 v108, v108, v108
    v_mul_f32 v109, v107, v107
    v_mul_f32 v110, v107, v108
    v_fma_f32 v109, -v108, v108, v109
    v_add_f32 v110, v110, v110
    v_mul_f32 v111, v109, v109
    v_mul_f32 v112, v109, v110
    v_fma_f32 v111, -v110, v110, v111
    v_add_f32 v112, v112, v112
    v_cndmask_b32_e64 v113, v87, -v88, s[20:21]
    v_cndmask_b32_e64 v114, v83, v84, s[20:21]
    v_cndmask_b32_e64 v115, v101, -v102, s[20:21]
    v_cndmask_b32_e64 v116, v107, v108, s[20:21]
    v_cndmask_b32_e64 v117, v103, -v104, s[20:21]
    v_cndmask_b32_e64 v118, v109, v110, s[20:21]
    v_cndmask_b32_e64 v119, v105, -v106, s[20:21]
    v_cndmask_b32_e64 v120, v111, v112, s[20:21]
    s_nop 1
    v_mfma_f32_16x16x4_f32 v[128:131], v113, v114, v[128:131]
    v_mfma_f32_16x16x4_f32 v[132:135], v115, v116, v[132:135]
    v_mfma_f32_16x16x4_f32 v[136:139], v117, v118, v[136:139]
    v_mfma_f32_16x16x4_f32 v[140:143], v119, v120, v[140:143]
    v_and_b32 v64, 0xffff0000, v19
    v_and_b32 v65, 0xffff0000, v27
    v_and_b32 v66, 0xffff0000, v35
    v_and_b32 v67, 0xffff0000, v43
    v_and_b32 v68, 0xffff0000, v51
    v_and_b32 v69, 0xffff0000, v59
    v_mul_f32 v70, v15, v64
    v_mul_f32 v71, v15, v65
    v_mul_f32 v72, v15, v66
    v_mul_f32 v73, v15, v67
    v_mul_f32 v74, v68, v72
    v_mul_f32 v75, v68, v73
    v_fma_f32 v74, -v69, v73, v74
    v_fma_f32 v75, v69, v72, v75
    v_mul_f32 v78, v12, v70
    v_mul_f32 v79, v13, v71
    v_exp_f32 v80, v78
    v_fract_f32 v79, v79
    v_cos_f32 v81, v79
    v_sin_f32 v82, v79
    s_nop 0
    v_mul_f32 v76, v80, v81
    v_mul_f32 v77, v80, v82
    v_mul_f32 v78, v10, v70
    v_mul_f32 v79, v11, v71
    v_exp_f32 v80, v78
    v_fract_f32 v79, v79
    v_cos_f32 v81, v79
    v_sin_f32 v82, v79
    s_nop 0
    v_mul_f32 v83, v80, v81
    v_mul_f32 v84, v80, v82
    v_mul_f32 v78, s25, v70
    v_mul_f32 v79, s26, v71
    v_exp_f32 v80, v78
    v_fract_f32 v79, v79
    v_cos_f32 v81, v79
    v_sin_f32 v82, v79
    s_nop 0
    v_mul_f32 v85, v80, v81
    v_mul_f32 v86, v80, v82
    v_mul_f32 v87, v74, v76
    v_mul_f32 v88, v74, v77
    v_fma_f32 v87, -v75, v77, v87
    v_fma_f32 v88, v75, v76, v88
    v_mul_f32 v89, v76, v76
    v_mul_f32 v90, v76, v77
    v_fma_f32 v89, -v77, v77, v89
    v_add_f32 v90, v90, v90
    v_mul_f32 v91, v89, v89
    v_mul_f32 v92, v89, v90
    v_fma_f32 v91, -v90, v90, v91
    v_add_f32 v92, v92, v92
    v_mul_f32 v93, v91, v91
    v_mul_f32 v94, v91, v92
    v_fma_f32 v93, -v92, v92, v93
    v_add_f32 v94, v94, v94
    v_mul_f32 v95, v85, v85
    v_mul_f32 v96, v85, v86
    v_fma_f32 v95, -v86, v86, v95
    v_add_f32 v96, v96, v96
    v_mul_f32 v97, v95, v95
    v_mul_f32 v98, v95, v96
    v_fma_f32 v97, -v96, v96, v97
    v_add_f32 v98, v98, v98
    v_mul_f32 v99, v74, v85
    v_mul_f32 v100, v74, v86
    v_fma_f32 v99, -v75, v86, v99
    v_fma_f32 v100, v75, v85, v100
    v_mul_f32 v101, v99, v89
    v_mul_f32 v102, v99, v90
    v_fma_f32 v101, -v100, v90, v101
    v_fma_f32 v102, v100, v89, v102
    v_mul_f32 v99, v74, v95
    v_mul_f32 v100, v74, v96
    v_fma_f32 v99, -v75, v96, v99
    v_fma_f32 v100, v75, v95, v100
    v_mul_f32 v103, v99, v91
    v_mul_f32 v104, v99, v92
    v_fma_f32 v103, -v100, v92, v103
    v_fma_f32 v104, v100, v91, v104
    v_mul_f32 v99, v74, v97
    v_mul_f32 v100, v74, v98
    v_fma_f32 v99, -v75, v98, v99
    v_fma_f32 v100, v75, v97, v100
    v_mul_f32 v105, v99, v93
    v_mul_f32 v106, v99, v94
    v_fma_f32 v105, -v100, v94, v105
    v_fma_f32 v106, v100, v93, v106
    v_mul_f32 v107, v83, v83
    v_mul_f32 v108, v83, v84
    v_fma_f32 v107, -v84, v84, v107
    v_add_f32 v108, v108, v108
    v_mul_f32 v109, v107, v107
    v_mul_f32 v110, v107, v108
    v_fma_f32 v109, -v108, v108, v109
    v_add_f32 v110, v110, v110
    v_mul_f32 v111, v109, v109
    v_mul_f32 v112, v109, v110
    v_fma_f32 v111, -v110, v110, v111
    v_add_f32 v112, v112, v112
    v_cndmask_b32_e64 v113, v87, -v88, s[20:21]
    v_cndmask_b32_e64 v114, v83, v84, s[20:21]
    v_cndmask_b32_e64 v115, v101, -v102, s[20:21]
    v_cndmask_b32_e64 v116, v107, v108, s[20:21]
    v_cndmask_b32_e64 v117, v103, -v104, s[20:21]
    v_cndmask_b32_e64 v118, v109, v110, s[20:21]
    v_cndmask_b32_e64 v119, v105, -v106, s[20:21]
    v_cndmask_b32_e64 v120, v111, v112, s[20:21]
    s_nop 1
    v_mfma_f32_16x16x4_f32 v[128:131], v113, v114, v[128:131]
    v_mfma_f32_16x16x4_f32 v[132:135], v115, v116, v[132:135]
    v_mfma_f32_16x16x4_f32 v[136:139], v117, v118, v[136:139]
    v_mfma_f32_16x16x4_f32 v[140:143], v119, v120, v[140:143]
    v_lshlrev_b32 v64, 16, v20
    v_lshlrev_b32 v65, 16, v28
    v_lshlrev_b32 v66, 16, v36
    v_lshlrev_b32 v67, 16, v44
    v_lshlrev_b32 v68, 16, v52
    v_lshlrev_b32 v69, 16, v60
    v_mul_f32 v70, v15, v64
    v_mul_f32 v71, v15, v65
    v_mul_f32 v72, v15, v66
    v_mul_f32 v73, v15, v67
    v_mul_f32 v74, v68, v72
    v_mul_f32 v75, v68, v73
    v_fma_f32 v74, -v69, v73, v74
    v_fma_f32 v75, v69, v72, v75
    v_mul_f32 v78, v12, v70
    v_mul_f32 v79, v13, v71
    v_exp_f32 v80, v78
    v_fract_f32 v79, v79
    v_cos_f32 v81, v79
    v_sin_f32 v82, v79
    s_nop 0
    v_mul_f32 v76, v80, v81
    v_mul_f32 v77, v80, v82
    v_mul_f32 v78, v10, v70
    v_mul_f32 v79, v11, v71
    v_exp_f32 v80, v78
    v_fract_f32 v79, v79
    v_cos_f32 v81, v79
    v_sin_f32 v82, v79
    s_nop 0
    v_mul_f32 v83, v80, v81
    v_mul_f32 v84, v80, v82
    v_mul_f32 v78, s25, v70
    v_mul_f32 v79, s26, v71
    v_exp_f32 v80, v78
    v_fract_f32 v79, v79
    v_cos_f32 v81, v79
    v_sin_f32 v82, v79
    s_nop 0
    v_mul_f32 v85, v80, v81
    v_mul_f32 v86, v80, v82
    v_mul_f32 v87, v74, v76
    v_mul_f32 v88, v74, v77
    v_fma_f32 v87, -v75, v77, v87
    v_fma_f32 v88, v75, v76, v88
    v_mul_f32 v89, v76, v76
    v_mul_f32 v90, v76, v77
    v_fma_f32 v89, -v77, v77, v89
    v_add_f32 v90, v90, v90
    v_mul_f32 v91, v89, v89
    v_mul_f32 v92, v89, v90
    v_fma_f32 v91, -v90, v90, v91
    v_add_f32 v92, v92, v92
    v_mul_f32 v93, v91, v91
    v_mul_f32 v94, v91, v92
    v_fma_f32 v93, -v92, v92, v93
    v_add_f32 v94, v94, v94
    v_mul_f32 v95, v85, v85
    v_mul_f32 v96, v85, v86
    v_fma_f32 v95, -v86, v86, v95
    v_add_f32 v96, v96, v96
    v_mul_f32 v97, v95, v95
    v_mul_f32 v98, v95, v96
    v_fma_f32 v97, -v96, v96, v97
    v_add_f32 v98, v98, v98
    v_mul_f32 v99, v74, v85
    v_mul_f32 v100, v74, v86
    v_fma_f32 v99, -v75, v86, v99
    v_fma_f32 v100, v75, v85, v100
    v_mul_f32 v101, v99, v89
    v_mul_f32 v102, v99, v90
    v_fma_f32 v101, -v100, v90, v101
    v_fma_f32 v102, v100, v89, v102
    v_mul_f32 v99, v74, v95
    v_mul_f32 v100, v74, v96
    v_fma_f32 v99, -v75, v96, v99
    v_fma_f32 v100, v75, v95, v100
    v_mul_f32 v103, v99, v91
    v_mul_f32 v104, v99, v92
    v_fma_f32 v103, -v100, v92, v103
    v_fma_f32 v104, v100, v91, v104
    v_mul_f32 v99, v74, v97
    v_mul_f32 v100, v74, v98
    v_fma_f32 v99, -v75, v98, v99
    v_fma_f32 v100, v75, v97, v100
    v_mul_f32 v105, v99, v93
    v_mul_f32 v106, v99, v94
    v_fma_f32 v105, -v100, v94, v105
    v_fma_f32 v106, v100, v93, v106
    v_mul_f32 v107, v83, v83
    v_mul_f32 v108, v83, v84
    v_fma_f32 v107, -v84, v84, v107
    v_add_f32 v108, v108, v108
    v_mul_f32 v109, v107, v107
    v_mul_f32 v110, v107, v108
    v_fma_f32 v109, -v108, v108, v109
    v_add_f32 v110, v110, v110
    v_mul_f32 v111, v109, v109
    v_mul_f32 v112, v109, v110
    v_fma_f32 v111, -v110, v110, v111
    v_add_f32 v112, v112, v112
    v_cndmask_b32_e64 v113, v87, -v88, s[20:21]
    v_cndmask_b32_e64 v114, v83, v84, s[20:21]
    v_cndmask_b32_e64 v115, v101, -v102, s[20:21]
    v_cndmask_b32_e64 v116, v107, v108, s[20:21]
    v_cndmask_b32_e64 v117, v103, -v104, s[20:21]
    v_cndmask_b32_e64 v118, v109, v110, s[20:21]
    v_cndmask_b32_e64 v119, v105, -v106, s[20:21]
    v_cndmask_b32_e64 v120, v111, v112, s[20:21]
    s_nop 1
    v_mfma_f32_16x16x4_f32 v[128:131], v113, v114, v[128:131]
    v_mfma_f32_16x16x4_f32 v[132:135], v115, v116, v[132:135]
    v_mfma_f32_16x16x4_f32 v[136:139], v117, v118, v[136:139]
    v_mfma_f32_16x16x4_f32 v[140:143], v119, v120, v[140:143]
    v_and_b32 v64, 0xffff0000, v20
    v_and_b32 v65, 0xffff0000, v28
    v_and_b32 v66, 0xffff0000, v36
    v_and_b32 v67, 0xffff0000, v44
    v_and_b32 v68, 0xffff0000, v52
    v_and_b32 v69, 0xffff0000, v60
    v_mul_f32 v70, v15, v64
    v_mul_f32 v71, v15, v65
    v_mul_f32 v72, v15, v66
    v_mul_f32 v73, v15, v67
    v_mul_f32 v74, v68, v72
    v_mul_f32 v75, v68, v73
    v_fma_f32 v74, -v69, v73, v74
    v_fma_f32 v75, v69, v72, v75
    v_mul_f32 v78, v12, v70
    v_mul_f32 v79, v13, v71
    v_exp_f32 v80, v78
    v_fract_f32 v79, v79
    v_cos_f32 v81, v79
    v_sin_f32 v82, v79
    s_nop 0
    v_mul_f32 v76, v80, v81
    v_mul_f32 v77, v80, v82
    v_mul_f32 v78, v10, v70
    v_mul_f32 v79, v11, v71
    v_exp_f32 v80, v78
    v_fract_f32 v79, v79
    v_cos_f32 v81, v79
    v_sin_f32 v82, v79
    s_nop 0
    v_mul_f32 v83, v80, v81
    v_mul_f32 v84, v80, v82
    v_mul_f32 v78, s25, v70
    v_mul_f32 v79, s26, v71
    v_exp_f32 v80, v78
    v_fract_f32 v79, v79
    v_cos_f32 v81, v79
    v_sin_f32 v82, v79
    s_nop 0
    v_mul_f32 v85, v80, v81
    v_mul_f32 v86, v80, v82
    v_mul_f32 v87, v74, v76
    v_mul_f32 v88, v74, v77
    v_fma_f32 v87, -v75, v77, v87
    v_fma_f32 v88, v75, v76, v88
    v_mul_f32 v89, v76, v76
    v_mul_f32 v90, v76, v77
    v_fma_f32 v89, -v77, v77, v89
    v_add_f32 v90, v90, v90
    v_mul_f32 v91, v89, v89
    v_mul_f32 v92, v89, v90
    v_fma_f32 v91, -v90, v90, v91
    v_add_f32 v92, v92, v92
    v_mul_f32 v93, v91, v91
    v_mul_f32 v94, v91, v92
    v_fma_f32 v93, -v92, v92, v93
    v_add_f32 v94, v94, v94
    v_mul_f32 v95, v85, v85
    v_mul_f32 v96, v85, v86
    v_fma_f32 v95, -v86, v86, v95
    v_add_f32 v96, v96, v96
    v_mul_f32 v97, v95, v95
    v_mul_f32 v98, v95, v96
    v_fma_f32 v97, -v96, v96, v97
    v_add_f32 v98, v98, v98
    v_mul_f32 v99, v74, v85
    v_mul_f32 v100, v74, v86
    v_fma_f32 v99, -v75, v86, v99
    v_fma_f32 v100, v75, v85, v100
    v_mul_f32 v101, v99, v89
    v_mul_f32 v102, v99, v90
    v_fma_f32 v101, -v100, v90, v101
    v_fma_f32 v102, v100, v89, v102
    v_mul_f32 v99, v74, v95
    v_mul_f32 v100, v74, v96
    v_fma_f32 v99, -v75, v96, v99
    v_fma_f32 v100, v75, v95, v100
    v_mul_f32 v103, v99, v91
    v_mul_f32 v104, v99, v92
    v_fma_f32 v103, -v100, v92, v103
    v_fma_f32 v104, v100, v91, v104
    v_mul_f32 v99, v74, v97
    v_mul_f32 v100, v74, v98
    v_fma_f32 v99, -v75, v98, v99
    v_fma_f32 v100, v75, v97, v100
    v_mul_f32 v105, v99, v93
    v_mul_f32 v106, v99, v94
    v_fma_f32 v105, -v100, v94, v105
    v_fma_f32 v106, v100, v93, v106
    v_mul_f32 v107, v83, v83
    v_mul_f32 v108, v83, v84
    v_fma_f32 v107, -v84, v84, v107
    v_add_f32 v108, v108, v108
    v_mul_f32 v109, v107, v107
    v_mul_f32 v110, v107, v108
    v_fma_f32 v109, -v108, v108, v109
    v_add_f32 v110, v110, v110
    v_mul_f32 v111, v109, v109
    v_mul_f32 v112, v109, v110
    v_fma_f32 v111, -v110, v110, v111
    v_add_f32 v112, v112, v112
    v_cndmask_b32_e64 v113, v87, -v88, s[20:21]
    v_cndmask_b32_e64 v114, v83, v84, s[20:21]
    v_cndmask_b32_e64 v115, v101, -v102, s[20:21]
    v_cndmask_b32_e64 v116, v107, v108, s[20:21]
    v_cndmask_b32_e64 v117, v103, -v104, s[20:21]
    v_cndmask_b32_e64 v118, v109, v110, s[20:21]
    v_cndmask_b32_e64 v119, v105, -v106, s[20:21]
    v_cndmask_b32_e64 v120, v111, v112, s[20:21]
    s_nop 1
    v_mfma_f32_16x16x4_f32 v[128:131], v113, v114, v[128:131]
    v_mfma_f32_16x16x4_f32 v[132:135], v115, v116, v[132:135]
    v_mfma_f32_16x16x4_f32 v[136:139], v117, v118, v[136:139]
    v_mfma_f32_16x16x4_f32 v[140:143], v119, v120, v[140:143]
    v_lshlrev_b32 v64, 16, v21
    v_lshlrev_b32 v65, 16, v29
    v_lshlrev_b32 v66, 16, v37
    v_lshlrev_b32 v67, 16, v45
    v_lshlrev_b32 v68, 16, v53
    v_lshlrev_b32 v69, 16, v61
    v_mul_f32 v70, v15, v64
    v_mul_f32 v71, v15, v65
    v_mul_f32 v72, v15, v66
    v_mul_f32 v73, v15, v67
    v_mul_f32 v74, v68, v72
    v_mul_f32 v75, v68, v73
    v_fma_f32 v74, -v69, v73, v74
    v_fma_f32 v75, v69, v72, v75
    v_mul_f32 v78, v12, v70
    v_mul_f32 v79, v13, v71
    v_exp_f32 v80, v78
    v_fract_f32 v79, v79
    v_cos_f32 v81, v79
    v_sin_f32 v82, v79
    s_nop 0
    v_mul_f32 v76, v80, v81
    v_mul_f32 v77, v80, v82
    v_mul_f32 v78, v10, v70
    v_mul_f32 v79, v11, v71
    v_exp_f32 v80, v78
    v_fract_f32 v79, v79
    v_cos_f32 v81, v79
    v_sin_f32 v82, v79
    s_nop 0
    v_mul_f32 v83, v80, v81
    v_mul_f32 v84, v80, v82
    v_mul_f32 v78, s25, v70
    v_mul_f32 v79, s26, v71
    v_exp_f32 v80, v78
    v_fract_f32 v79, v79
    v_cos_f32 v81, v79
    v_sin_f32 v82, v79
    s_nop 0
    v_mul_f32 v85, v80, v81
    v_mul_f32 v86, v80, v82
    v_mul_f32 v87, v74, v76
    v_mul_f32 v88, v74, v77
    v_fma_f32 v87, -v75, v77, v87
    v_fma_f32 v88, v75, v76, v88
    v_mul_f32 v89, v76, v76
    v_mul_f32 v90, v76, v77
    v_fma_f32 v89, -v77, v77, v89
    v_add_f32 v90, v90, v90
    v_mul_f32 v91, v89, v89
    v_mul_f32 v92, v89, v90
    v_fma_f32 v91, -v90, v90, v91
    v_add_f32 v92, v92, v92
    v_mul_f32 v93, v91, v91
    v_mul_f32 v94, v91, v92
    v_fma_f32 v93, -v92, v92, v93
    v_add_f32 v94, v94, v94
    v_mul_f32 v95, v85, v85
    v_mul_f32 v96, v85, v86
    v_fma_f32 v95, -v86, v86, v95
    v_add_f32 v96, v96, v96
    v_mul_f32 v97, v95, v95
    v_mul_f32 v98, v95, v96
    v_fma_f32 v97, -v96, v96, v97
    v_add_f32 v98, v98, v98
    v_mul_f32 v99, v74, v85
    v_mul_f32 v100, v74, v86
    v_fma_f32 v99, -v75, v86, v99
    v_fma_f32 v100, v75, v85, v100
    v_mul_f32 v101, v99, v89
    v_mul_f32 v102, v99, v90
    v_fma_f32 v101, -v100, v90, v101
    v_fma_f32 v102, v100, v89, v102
    v_mul_f32 v99, v74, v95
    v_mul_f32 v100, v74, v96
    v_fma_f32 v99, -v75, v96, v99
    v_fma_f32 v100, v75, v95, v100
    v_mul_f32 v103, v99, v91
    v_mul_f32 v104, v99, v92
    v_fma_f32 v103, -v100, v92, v103
    v_fma_f32 v104, v100, v91, v104
    v_mul_f32 v99, v74, v97
    v_mul_f32 v100, v74, v98
    v_fma_f32 v99, -v75, v98, v99
    v_fma_f32 v100, v75, v97, v100
    v_mul_f32 v105, v99, v93
    v_mul_f32 v106, v99, v94
    v_fma_f32 v105, -v100, v94, v105
    v_fma_f32 v106, v100, v93, v106
    v_mul_f32 v107, v83, v83
    v_mul_f32 v108, v83, v84
    v_fma_f32 v107, -v84, v84, v107
    v_add_f32 v108, v108, v108
    v_mul_f32 v109, v107, v107
    v_mul_f32 v110, v107, v108
    v_fma_f32 v109, -v108, v108, v109
    v_add_f32 v110, v110, v110
    v_mul_f32 v111, v109, v109
    v_mul_f32 v112, v109, v110
    v_fma_f32 v111, -v110, v110, v111
    v_add_f32 v112, v112, v112
    v_cndmask_b32_e64 v113, v87, -v88, s[20:21]
    v_cndmask_b32_e64 v114, v83, v84, s[20:21]
    v_cndmask_b32_e64 v115, v101, -v102, s[20:21]
    v_cndmask_b32_e64 v116, v107, v108, s[20:21]
    v_cndmask_b32_e64 v117, v103, -v104, s[20:21]
    v_cndmask_b32_e64 v118, v109, v110, s[20:21]
    v_cndmask_b32_e64 v119, v105, -v106, s[20:21]
    v_cndmask_b32_e64 v120, v111, v112, s[20:21]
    s_nop 1
    v_mfma_f32_16x16x4_f32 v[128:131], v113, v114, v[128:131]
    v_mfma_f32_16x16x4_f32 v[132:135], v115, v116, v[132:135]
    v_mfma_f32_16x16x4_f32 v[136:139], v117, v118, v[136:139]
    v_mfma_f32_16x16x4_f32 v[140:143], v119, v120, v[140:143]
    v_and_b32 v64, 0xffff0000, v21
    v_and_b32 v65, 0xffff0000, v29
    v_and_b32 v66, 0xffff0000, v37
    v_and_b32 v67, 0xffff0000, v45
    v_and_b32 v68, 0xffff0000, v53
    v_and_b32 v69, 0xffff0000, v61
    v_mul_f32 v70, v15, v64
    v_mul_f32 v71, v15, v65
    v_mul_f32 v72, v15, v66
    v_mul_f32 v73, v15, v67
    v_mul_f32 v74, v68, v72
    v_mul_f32 v75, v68, v73
    v_fma_f32 v74, -v69, v73, v74
    v_fma_f32 v75, v69, v72, v75
    v_mul_f32 v78, v12, v70
    v_mul_f32 v79, v13, v71
    v_exp_f32 v80, v78
    v_fract_f32 v79, v79
    v_cos_f32 v81, v79
    v_sin_f32 v82, v79
    s_nop 0
    v_mul_f32 v76, v80, v81
    v_mul_f32 v77, v80, v82
    v_mul_f32 v78, v10, v70
    v_mul_f32 v79, v11, v71
    v_exp_f32 v80, v78
    v_fract_f32 v79, v79
    v_cos_f32 v81, v79
    v_sin_f32 v82, v79
    s_nop 0
    v_mul_f32 v83, v80, v81
    v_mul_f32 v84, v80, v82
    v_mul_f32 v78, s25, v70
    v_mul_f32 v79, s26, v71
    v_exp_f32 v80, v78
    v_fract_f32 v79, v79
    v_cos_f32 v81, v79
    v_sin_f32 v82, v79
    s_nop 0
    v_mul_f32 v85, v80, v81
    v_mul_f32 v86, v80, v82
    v_mul_f32 v87, v74, v76
    v_mul_f32 v88, v74, v77
    v_fma_f32 v87, -v75, v77, v87
    v_fma_f32 v88, v75, v76, v88
    v_mul_f32 v89, v76, v76
    v_mul_f32 v90, v76, v77
    v_fma_f32 v89, -v77, v77, v89
    v_add_f32 v90, v90, v90
    v_mul_f32 v91, v89, v89
    v_mul_f32 v92, v89, v90
    v_fma_f32 v91, -v90, v90, v91
    v_add_f32 v92, v92, v92
    v_mul_f32 v93, v91, v91
    v_mul_f32 v94, v91, v92
    v_fma_f32 v93, -v92, v92, v93
    v_add_f32 v94, v94, v94
    v_mul_f32 v95, v85, v85
    v_mul_f32 v96, v85, v86
    v_fma_f32 v95, -v86, v86, v95
    v_add_f32 v96, v96, v96
    v_mul_f32 v97, v95, v95
    v_mul_f32 v98, v95, v96
    v_fma_f32 v97, -v96, v96, v97
    v_add_f32 v98, v98, v98
    v_mul_f32 v99, v74, v85
    v_mul_f32 v100, v74, v86
    v_fma_f32 v99, -v75, v86, v99
    v_fma_f32 v100, v75, v85, v100
    v_mul_f32 v101, v99, v89
    v_mul_f32 v102, v99, v90
    v_fma_f32 v101, -v100, v90, v101
    v_fma_f32 v102, v100, v89, v102
    v_mul_f32 v99, v74, v95
    v_mul_f32 v100, v74, v96
    v_fma_f32 v99, -v75, v96, v99
    v_fma_f32 v100, v75, v95, v100
    v_mul_f32 v103, v99, v91
    v_mul_f32 v104, v99, v92
    v_fma_f32 v103, -v100, v92, v103
    v_fma_f32 v104, v100, v91, v104
    v_mul_f32 v99, v74, v97
    v_mul_f32 v100, v74, v98
    v_fma_f32 v99, -v75, v98, v99
    v_fma_f32 v100, v75, v97, v100
    v_mul_f32 v105, v99, v93
    v_mul_f32 v106, v99, v94
    v_fma_f32 v105, -v100, v94, v105
    v_fma_f32 v106, v100, v93, v106
    v_mul_f32 v107, v83, v83
    v_mul_f32 v108, v83, v84
    v_fma_f32 v107, -v84, v84, v107
    v_add_f32 v108, v108, v108
    v_mul_f32 v109, v107, v107
    v_mul_f32 v110, v107, v108
    v_fma_f32 v109, -v108, v108, v109
    v_add_f32 v110, v110, v110
    v_mul_f32 v111, v109, v109
    v_mul_f32 v112, v109, v110
    v_fma_f32 v111, -v110, v110, v111
    v_add_f32 v112, v112, v112
    v_cndmask_b32_e64 v113, v87, -v88, s[20:21]
    v_cndmask_b32_e64 v114, v83, v84, s[20:21]
    v_cndmask_b32_e64 v115, v101, -v102, s[20:21]
    v_cndmask_b32_e64 v116, v107, v108, s[20:21]
    v_cndmask_b32_e64 v117, v103, -v104, s[20:21]
    v_cndmask_b32_e64 v118, v109, v110, s[20:21]
    v_cndmask_b32_e64 v119, v105, -v106, s[20:21]
    v_cndmask_b32_e64 v120, v111, v112, s[20:21]
    s_nop 1
    v_mfma_f32_16x16x4_f32 v[128:131], v113, v114, v[128:131]
    v_mfma_f32_16x16x4_f32 v[132:135], v115, v116, v[132:135]
    v_mfma_f32_16x16x4_f32 v[136:139], v117, v118, v[136:139]
    v_mfma_f32_16x16x4_f32 v[140:143], v119, v120, v[140:143]
    v_lshlrev_b32 v64, 16, v22
    v_lshlrev_b32 v65, 16, v30
    v_lshlrev_b32 v66, 16, v38
    v_lshlrev_b32 v67, 16, v46
    v_lshlrev_b32 v68, 16, v54
    v_lshlrev_b32 v69, 16, v62
    v_mul_f32 v70, v15, v64
    v_mul_f32 v71, v15, v65
    v_mul_f32 v72, v15, v66
    v_mul_f32 v73, v15, v67
    v_mul_f32 v74, v68, v72
    v_mul_f32 v75, v68, v73
    v_fma_f32 v74, -v69, v73, v74
    v_fma_f32 v75, v69, v72, v75
    v_mul_f32 v78, v12, v70
    v_mul_f32 v79, v13, v71
    v_exp_f32 v80, v78
    v_fract_f32 v79, v79
    v_cos_f32 v81, v79
    v_sin_f32 v82, v79
    s_nop 0
    v_mul_f32 v76, v80, v81
    v_mul_f32 v77, v80, v82
    v_mul_f32 v78, v10, v70
    v_mul_f32 v79, v11, v71
    v_exp_f32 v80, v78
    v_fract_f32 v79, v79
    v_cos_f32 v81, v79
    v_sin_f32 v82, v79
    s_nop 0
    v_mul_f32 v83, v80, v81
    v_mul_f32 v84, v80, v82
    v_mul_f32 v78, s25, v70
    v_mul_f32 v79, s26, v71
    v_exp_f32 v80, v78
    v_fract_f32 v79, v79
    v_cos_f32 v81, v79
    v_sin_f32 v82, v79
    s_nop 0
    v_mul_f32 v85, v80, v81
    v_mul_f32 v86, v80, v82
    v_mul_f32 v87, v74, v76
    v_mul_f32 v88, v74, v77
    v_fma_f32 v87, -v75, v77, v87
    v_fma_f32 v88, v75, v76, v88
    v_mul_f32 v89, v76, v76
    v_mul_f32 v90, v76, v77
    v_fma_f32 v89, -v77, v77, v89
    v_add_f32 v90, v90, v90
    v_mul_f32 v91, v89, v89
    v_mul_f32 v92, v89, v90
    v_fma_f32 v91, -v90, v90, v91
    v_add_f32 v92, v92, v92
    v_mul_f32 v93, v91, v91
    v_mul_f32 v94, v91, v92
    v_fma_f32 v93, -v92, v92, v93
    v_add_f32 v94, v94, v94
    v_mul_f32 v95, v85, v85
    v_mul_f32 v96, v85, v86
    v_fma_f32 v95, -v86, v86, v95
    v_add_f32 v96, v96, v96
    v_mul_f32 v97, v95, v95
    v_mul_f32 v98, v95, v96
    v_fma_f32 v97, -v96, v96, v97
    v_add_f32 v98, v98, v98
    v_mul_f32 v99, v74, v85
    v_mul_f32 v100, v74, v86
    v_fma_f32 v99, -v75, v86, v99
    v_fma_f32 v100, v75, v85, v100
    v_mul_f32 v101, v99, v89
    v_mul_f32 v102, v99, v90
    v_fma_f32 v101, -v100, v90, v101
    v_fma_f32 v102, v100, v89, v102
    v_mul_f32 v99, v74, v95
    v_mul_f32 v100, v74, v96
    v_fma_f32 v99, -v75, v96, v99
    v_fma_f32 v100, v75, v95, v100
    v_mul_f32 v103, v99, v91
    v_mul_f32 v104, v99, v92
    v_fma_f32 v103, -v100, v92, v103
    v_fma_f32 v104, v100, v91, v104
    v_mul_f32 v99, v74, v97
    v_mul_f32 v100, v74, v98
    v_fma_f32 v99, -v75, v98, v99
    v_fma_f32 v100, v75, v97, v100
    v_mul_f32 v105, v99, v93
    v_mul_f32 v106, v99, v94
    v_fma_f32 v105, -v100, v94, v105
    v_fma_f32 v106, v100, v93, v106
    v_mul_f32 v107, v83, v83
    v_mul_f32 v108, v83, v84
    v_fma_f32 v107, -v84, v84, v107
    v_add_f32 v108, v108, v108
    v_mul_f32 v109, v107, v107
    v_mul_f32 v110, v107, v108
    v_fma_f32 v109, -v108, v108, v109
    v_add_f32 v110, v110, v110
    v_mul_f32 v111, v109, v109
    v_mul_f32 v112, v109, v110
    v_fma_f32 v111, -v110, v110, v111
    v_add_f32 v112, v112, v112
    v_cndmask_b32_e64 v113, v87, -v88, s[20:21]
    v_cndmask_b32_e64 v114, v83, v84, s[20:21]
    v_cndmask_b32_e64 v115, v101, -v102, s[20:21]
    v_cndmask_b32_e64 v116, v107, v108, s[20:21]
    v_cndmask_b32_e64 v117, v103, -v104, s[20:21]
    v_cndmask_b32_e64 v118, v109, v110, s[20:21]
    v_cndmask_b32_e64 v119, v105, -v106, s[20:21]
    v_cndmask_b32_e64 v120, v111, v112, s[20:21]
    s_nop 1
    v_mfma_f32_16x16x4_f32 v[128:131], v113, v114, v[128:131]
    v_mfma_f32_16x16x4_f32 v[132:135], v115, v116, v[132:135]
    v_mfma_f32_16x16x4_f32 v[136:139], v117, v118, v[136:139]
    v_mfma_f32_16x16x4_f32 v[140:143], v119, v120, v[140:143]
    v_and_b32 v64, 0xffff0000, v22
    v_and_b32 v65, 0xffff0000, v30
    v_and_b32 v66, 0xffff0000, v38
    v_and_b32 v67, 0xffff0000, v46
    v_and_b32 v68, 0xffff0000, v54
    v_and_b32 v69, 0xffff0000, v62
    v_mul_f32 v70, v15, v64
    v_mul_f32 v71, v15, v65
    v_mul_f32 v72, v15, v66
    v_mul_f32 v73, v15, v67
    v_mul_f32 v74, v68, v72
    v_mul_f32 v75, v68, v73
    v_fma_f32 v74, -v69, v73, v74
    v_fma_f32 v75, v69, v72, v75
    v_mul_f32 v78, v12, v70
    v_mul_f32 v79, v13, v71
    v_exp_f32 v80, v78
    v_fract_f32 v79, v79
    v_cos_f32 v81, v79
    v_sin_f32 v82, v79
    s_nop 0
    v_mul_f32 v76, v80, v81
    v_mul_f32 v77, v80, v82
    v_mul_f32 v78, v10, v70
    v_mul_f32 v79, v11, v71
    v_exp_f32 v80, v78
    v_fract_f32 v79, v79
    v_cos_f32 v81, v79
    v_sin_f32 v82, v79
    s_nop 0
    v_mul_f32 v83, v80, v81
    v_mul_f32 v84, v80, v82
    v_mul_f32 v78, s25, v70
    v_mul_f32 v79, s26, v71
    v_exp_f32 v80, v78
    v_fract_f32 v79, v79
    v_cos_f32 v81, v79
    v_sin_f32 v82, v79
    s_nop 0
    v_mul_f32 v85, v80, v81
    v_mul_f32 v86, v80, v82
    v_mul_f32 v87, v74, v76
    v_mul_f32 v88, v74, v77
    v_fma_f32 v87, -v75, v77, v87
    v_fma_f32 v88, v75, v76, v88
    v_mul_f32 v89, v76, v76
    v_mul_f32 v90, v76, v77
    v_fma_f32 v89, -v77, v77, v89
    v_add_f32 v90, v90, v90
    v_mul_f32 v91, v89, v89
    v_mul_f32 v92, v89, v90
    v_fma_f32 v91, -v90, v90, v91
    v_add_f32 v92, v92, v92
    v_mul_f32 v93, v91, v91
    v_mul_f32 v94, v91, v92
    v_fma_f32 v93, -v92, v92, v93
    v_add_f32 v94, v94, v94
    v_mul_f32 v95, v85, v85
    v_mul_f32 v96, v85, v86
    v_fma_f32 v95, -v86, v86, v95
    v_add_f32 v96, v96, v96
    v_mul_f32 v97, v95, v95
    v_mul_f32 v98, v95, v96
    v_fma_f32 v97, -v96, v96, v97
    v_add_f32 v98, v98, v98
    v_mul_f32 v99, v74, v85
    v_mul_f32 v100, v74, v86
    v_fma_f32 v99, -v75, v86, v99
    v_fma_f32 v100, v75, v85, v100
    v_mul_f32 v101, v99, v89
    v_mul_f32 v102, v99, v90
    v_fma_f32 v101, -v100, v90, v101
    v_fma_f32 v102, v100, v89, v102
    v_mul_f32 v99, v74, v95
    v_mul_f32 v100, v74, v96
    v_fma_f32 v99, -v75, v96, v99
    v_fma_f32 v100, v75, v95, v100
    v_mul_f32 v103, v99, v91
    v_mul_f32 v104, v99, v92
    v_fma_f32 v103, -v100, v92, v103
    v_fma_f32 v104, v100, v91, v104
    v_mul_f32 v99, v74, v97
    v_mul_f32 v100, v74, v98
    v_fma_f32 v99, -v75, v98, v99
    v_fma_f32 v100, v75, v97, v100
    v_mul_f32 v105, v99, v93
    v_mul_f32 v106, v99, v94
    v_fma_f32 v105, -v100, v94, v105
    v_fma_f32 v106, v100, v93, v106
    v_mul_f32 v107, v83, v83
    v_mul_f32 v108, v83, v84
    v_fma_f32 v107, -v84, v84, v107
    v_add_f32 v108, v108, v108
    v_mul_f32 v109, v107, v107
    v_mul_f32 v110, v107, v108
    v_fma_f32 v109, -v108, v108, v109
    v_add_f32 v110, v110, v110
    v_mul_f32 v111, v109, v109
    v_mul_f32 v112, v109, v110
    v_fma_f32 v111, -v110, v110, v111
    v_add_f32 v112, v112, v112
    v_cndmask_b32_e64 v113, v87, -v88, s[20:21]
    v_cndmask_b32_e64 v114, v83, v84, s[20:21]
    v_cndmask_b32_e64 v115, v101, -v102, s[20:21]
    v_cndmask_b32_e64 v116, v107, v108, s[20:21]
    v_cndmask_b32_e64 v117, v103, -v104, s[20:21]
    v_cndmask_b32_e64 v118, v109, v110, s[20:21]
    v_cndmask_b32_e64 v119, v105, -v106, s[20:21]
    v_cndmask_b32_e64 v120, v111, v112, s[20:21]
    s_nop 1
    v_mfma_f32_16x16x4_f32 v[128:131], v113, v114, v[128:131]
    v_mfma_f32_16x16x4_f32 v[132:135], v115, v116, v[132:135]
    v_mfma_f32_16x16x4_f32 v[136:139], v117, v118, v[136:139]
    v_mfma_f32_16x16x4_f32 v[140:143], v119, v120, v[140:143]
    v_lshlrev_b32 v64, 16, v23
    v_lshlrev_b32 v65, 16, v31
    v_lshlrev_b32 v66, 16, v39
    v_lshlrev_b32 v67, 16, v47
    v_lshlrev_b32 v68, 16, v55
    v_lshlrev_b32 v69, 16, v63
    v_mul_f32 v70, v15, v64
    v_mul_f32 v71, v15, v65
    v_mul_f32 v72, v15, v66
    v_mul_f32 v73, v15, v67
    v_mul_f32 v74, v68, v72
    v_mul_f32 v75, v68, v73
    v_fma_f32 v74, -v69, v73, v74
    v_fma_f32 v75, v69, v72, v75
    v_mul_f32 v78, v12, v70
    v_mul_f32 v79, v13, v71
    v_exp_f32 v80, v78
    v_fract_f32 v79, v79
    v_cos_f32 v81, v79
    v_sin_f32 v82, v79
    s_nop 0
    v_mul_f32 v76, v80, v81
    v_mul_f32 v77, v80, v82
    v_mul_f32 v78, v10, v70
    v_mul_f32 v79, v11, v71
    v_exp_f32 v80, v78
    v_fract_f32 v79, v79
    v_cos_f32 v81, v79
    v_sin_f32 v82, v79
    s_nop 0
    v_mul_f32 v83, v80, v81
    v_mul_f32 v84, v80, v82
    v_mul_f32 v78, s25, v70
    v_mul_f32 v79, s26, v71
    v_exp_f32 v80, v78
    v_fract_f32 v79, v79
    v_cos_f32 v81, v79
    v_sin_f32 v82, v79
    s_nop 0
    v_mul_f32 v85, v80, v81
    v_mul_f32 v86, v80, v82
    v_mul_f32 v87, v74, v76
    v_mul_f32 v88, v74, v77
    v_fma_f32 v87, -v75, v77, v87
    v_fma_f32 v88, v75, v76, v88
    v_mul_f32 v89, v76, v76
    v_mul_f32 v90, v76, v77
    v_fma_f32 v89, -v77, v77, v89
    v_add_f32 v90, v90, v90
    v_mul_f32 v91, v89, v89
    v_mul_f32 v92, v89, v90
    v_fma_f32 v91, -v90, v90, v91
    v_add_f32 v92, v92, v92
    v_mul_f32 v93, v91, v91
    v_mul_f32 v94, v91, v92
    v_fma_f32 v93, -v92, v92, v93
    v_add_f32 v94, v94, v94
    v_mul_f32 v95, v85, v85
    v_mul_f32 v96, v85, v86
    v_fma_f32 v95, -v86, v86, v95
    v_add_f32 v96, v96, v96
    v_mul_f32 v97, v95, v95
    v_mul_f32 v98, v95, v96
    v_fma_f32 v97, -v96, v96, v97
    v_add_f32 v98, v98, v98
    v_mul_f32 v99, v74, v85
    v_mul_f32 v100, v74, v86
    v_fma_f32 v99, -v75, v86, v99
    v_fma_f32 v100, v75, v85, v100
    v_mul_f32 v101, v99, v89
    v_mul_f32 v102, v99, v90
    v_fma_f32 v101, -v100, v90, v101
    v_fma_f32 v102, v100, v89, v102
    v_mul_f32 v99, v74, v95
    v_mul_f32 v100, v74, v96
    v_fma_f32 v99, -v75, v96, v99
    v_fma_f32 v100, v75, v95, v100
    v_mul_f32 v103, v99, v91
    v_mul_f32 v104, v99, v92
    v_fma_f32 v103, -v100, v92, v103
    v_fma_f32 v104, v100, v91, v104
    v_mul_f32 v99, v74, v97
    v_mul_f32 v100, v74, v98
    v_fma_f32 v99, -v75, v98, v99
    v_fma_f32 v100, v75, v97, v100
    v_mul_f32 v105, v99, v93
    v_mul_f32 v106, v99, v94
    v_fma_f32 v105, -v100, v94, v105
    v_fma_f32 v106, v100, v93, v106
    v_mul_f32 v107, v83, v83
    v_mul_f32 v108, v83, v84
    v_fma_f32 v107, -v84, v84, v107
    v_add_f32 v108, v108, v108
    v_mul_f32 v109, v107, v107
    v_mul_f32 v110, v107, v108
    v_fma_f32 v109, -v108, v108, v109
    v_add_f32 v110, v110, v110
    v_mul_f32 v111, v109, v109
    v_mul_f32 v112, v109, v110
    v_fma_f32 v111, -v110, v110, v111
    v_add_f32 v112, v112, v112
    v_cndmask_b32_e64 v113, v87, -v88, s[20:21]
    v_cndmask_b32_e64 v114, v83, v84, s[20:21]
    v_cndmask_b32_e64 v115, v101, -v102, s[20:21]
    v_cndmask_b32_e64 v116, v107, v108, s[20:21]
    v_cndmask_b32_e64 v117, v103, -v104, s[20:21]
    v_cndmask_b32_e64 v118, v109, v110, s[20:21]
    v_cndmask_b32_e64 v119, v105, -v106, s[20:21]
    v_cndmask_b32_e64 v120, v111, v112, s[20:21]
    s_nop 1
    v_mfma_f32_16x16x4_f32 v[128:131], v113, v114, v[128:131]
    v_mfma_f32_16x16x4_f32 v[132:135], v115, v116, v[132:135]
    v_mfma_f32_16x16x4_f32 v[136:139], v117, v118, v[136:139]
    v_mfma_f32_16x16x4_f32 v[140:143], v119, v120, v[140:143]
    v_and_b32 v64, 0xffff0000, v23
    v_and_b32 v65, 0xffff0000, v31
    v_and_b32 v66, 0xffff0000, v39
    v_and_b32 v67, 0xffff0000, v47
    v_and_b32 v68, 0xffff0000, v55
    v_and_b32 v69, 0xffff0000, v63
    v_mul_f32 v70, v15, v64
    v_mul_f32 v71, v15, v65
    v_mul_f32 v72, v15, v66
    v_mul_f32 v73, v15, v67
    v_mul_f32 v74, v68, v72
    v_mul_f32 v75, v68, v73
    v_fma_f32 v74, -v69, v73, v74
    v_fma_f32 v75, v69, v72, v75
    v_mul_f32 v78, v12, v70
    v_mul_f32 v79, v13, v71
    v_exp_f32 v80, v78
    v_fract_f32 v79, v79
    v_cos_f32 v81, v79
    v_sin_f32 v82, v79
    s_nop 0
    v_mul_f32 v76, v80, v81
    v_mul_f32 v77, v80, v82
    v_mul_f32 v78, v10, v70
    v_mul_f32 v79, v11, v71
    v_exp_f32 v80, v78
    v_fract_f32 v79, v79
    v_cos_f32 v81, v79
    v_sin_f32 v82, v79
    s_nop 0
    v_mul_f32 v83, v80, v81
    v_mul_f32 v84, v80, v82
    v_mul_f32 v78, s25, v70
    v_mul_f32 v79, s26, v71
    v_exp_f32 v80, v78
    v_fract_f32 v79, v79
    v_cos_f32 v81, v79
    v_sin_f32 v82, v79
    s_nop 0
    v_mul_f32 v85, v80, v81
    v_mul_f32 v86, v80, v82
    v_mul_f32 v87, v74, v76
    v_mul_f32 v88, v74, v77
    v_fma_f32 v87, -v75, v77, v87
    v_fma_f32 v88, v75, v76, v88
    v_mul_f32 v89, v76, v76
    v_mul_f32 v90, v76, v77
    v_fma_f32 v89, -v77, v77, v89
    v_add_f32 v90, v90, v90
    v_mul_f32 v91, v89, v89
    v_mul_f32 v92, v89, v90
    v_fma_f32 v91, -v90, v90, v91
    v_add_f32 v92, v92, v92
    v_mul_f32 v93, v91, v91
    v_mul_f32 v94, v91, v92
    v_fma_f32 v93, -v92, v92, v93
    v_add_f32 v94, v94, v94
    v_mul_f32 v95, v85, v85
    v_mul_f32 v96, v85, v86
    v_fma_f32 v95, -v86, v86, v95
    v_add_f32 v96, v96, v96
    v_mul_f32 v97, v95, v95
    v_mul_f32 v98, v95, v96
    v_fma_f32 v97, -v96, v96, v97
    v_add_f32 v98, v98, v98
    v_mul_f32 v99, v74, v85
    v_mul_f32 v100, v74, v86
    v_fma_f32 v99, -v75, v86, v99
    v_fma_f32 v100, v75, v85, v100
    v_mul_f32 v101, v99, v89
    v_mul_f32 v102, v99, v90
    v_fma_f32 v101, -v100, v90, v101
    v_fma_f32 v102, v100, v89, v102
    v_mul_f32 v99, v74, v95
    v_mul_f32 v100, v74, v96
    v_fma_f32 v99, -v75, v96, v99
    v_fma_f32 v100, v75, v95, v100
    v_mul_f32 v103, v99, v91
    v_mul_f32 v104, v99, v92
    v_fma_f32 v103, -v100, v92, v103
    v_fma_f32 v104, v100, v91, v104
    v_mul_f32 v99, v74, v97
    v_mul_f32 v100, v74, v98
    v_fma_f32 v99, -v75, v98, v99
    v_fma_f32 v100, v75, v97, v100
    v_mul_f32 v105, v99, v93
    v_mul_f32 v106, v99, v94
    v_fma_f32 v105, -v100, v94, v105
    v_fma_f32 v106, v100, v93, v106
    v_mul_f32 v107, v83, v83
    v_mul_f32 v108, v83, v84
    v_fma_f32 v107, -v84, v84, v107
    v_add_f32 v108, v108, v108
    v_mul_f32 v109, v107, v107
    v_mul_f32 v110, v107, v108
    v_fma_f32 v109, -v108, v108, v109
    v_add_f32 v110, v110, v110
    v_mul_f32 v111, v109, v109
    v_mul_f32 v112, v109, v110
    v_fma_f32 v111, -v110, v110, v111
    v_add_f32 v112, v112, v112
    v_cndmask_b32_e64 v113, v87, -v88, s[20:21]
    v_cndmask_b32_e64 v114, v83, v84, s[20:21]
    v_cndmask_b32_e64 v115, v101, -v102, s[20:21]
    v_cndmask_b32_e64 v116, v107, v108, s[20:21]
    v_cndmask_b32_e64 v117, v103, -v104, s[20:21]
    v_cndmask_b32_e64 v118, v109, v110, s[20:21]
    v_cndmask_b32_e64 v119, v105, -v106, s[20:21]
    v_cndmask_b32_e64 v120, v111, v112, s[20:21]
    s_nop 1
    v_mfma_f32_16x16x4_f32 v[128:131], v113, v114, v[128:131]
    v_mfma_f32_16x16x4_f32 v[132:135], v115, v116, v[132:135]
    v_mfma_f32_16x16x4_f32 v[136:139], v117, v118, v[136:139]
    v_mfma_f32_16x16x4_f32 v[140:143], v119, v120, v[140:143]
    s_nop 15
    v_lshlrev_b32 v64, 12, v2
    v_lshlrev_b32 v65, 8, v4
    v_lshlrev_b32 v66, 2, v3
    v_add3_u32 v64, v64, v65, v66
    ds_write_b32 v64, v128 offset:0
    ds_write_b32 v64, v129 offset:64
    ds_write_b32 v64, v130 offset:128
    ds_write_b32 v64, v131 offset:192
    ds_write_b32 v64, v132 offset:1024
    ds_write_b32 v64, v133 offset:1088
    ds_write_b32 v64, v134 offset:1152
    ds_write_b32 v64, v135 offset:1216
    ds_write_b32 v64, v136 offset:2048
    ds_write_b32 v64, v137 offset:2112
    ds_write_b32 v64, v138 offset:2176
    ds_write_b32 v64, v139 offset:2240
    ds_write_b32 v64, v140 offset:3072
    ds_write_b32 v64, v141 offset:3136
    ds_write_b32 v64, v142 offset:3200
    ds_write_b32 v64, v143 offset:3264
    s_waitcnt lgkmcnt(0)
    s_barrier
    v_lshlrev_b32 v64, 3, v0
    v_add_u32 v65, 0, v64
    v_cvt_f32_u32 v65, v65
    v_cvt_pk_bf16_f32 v65, v65, v65
    v_lshlrev_b32 v65, 16, v65
    v_cvt_u32_f32 v65, v65
    v_subrev_u32 v66, 0x100, v65
    v_lshrrev_b32 v66, 1, v66
    v_add_u32 v66, 0x100, v66
    v_subrev_u32 v67, 0x200, v65
    v_lshrrev_b32 v67, 2, v67
    v_add_u32 v67, 0x200, v67
    v_subrev_u32 v68, 0x400, v65
    v_lshrrev_b32 v68, 3, v68
    v_add_u32 v68, 0x300, v68
    v_cmp_le_u32 vcc, 0x100, v65
    s_nop 1
    v_cndmask_b32 v69, v65, v66, vcc
    v_cmp_le_u32 vcc, 0x200, v65
    s_nop 1
    v_cndmask_b32 v69, v69, v67, vcc
    v_cmp_le_u32 vcc, 0x400, v65
    s_nop 1
    v_cndmask_b32 v69, v69, v68, vcc
    v_lshlrev_b32 v69, 2, v69
    ds_read_b32 v70, v69 offset:0
    ds_read_b32 v71, v69 offset:4096
    ds_read_b32 v72, v69 offset:8192
    ds_read_b32 v73, v69 offset:12288
    s_waitcnt lgkmcnt(0)
    v_add_f32 v70, v70, v71
    v_add_f32 v72, v72, v73
    v_add_f32 v80, v70, v72
    v_add_u32 v65, 1, v64
    v_cvt_f32_u32 v65, v65
    v_cvt_pk_bf16_f32 v65, v65, v65
    v_lshlrev_b32 v65, 16, v65
    v_cvt_u32_f32 v65, v65
    v_subrev_u32 v66, 0x100, v65
    v_lshrrev_b32 v66, 1, v66
    v_add_u32 v66, 0x100, v66
    v_subrev_u32 v67, 0x200, v65
    v_lshrrev_b32 v67, 2, v67
    v_add_u32 v67, 0x200, v67
    v_subrev_u32 v68, 0x400, v65
    v_lshrrev_b32 v68, 3, v68
    v_add_u32 v68, 0x300, v68
    v_cmp_le_u32 vcc, 0x100, v65
    s_nop 1
    v_cndmask_b32 v69, v65, v66, vcc
    v_cmp_le_u32 vcc, 0x200, v65
    s_nop 1
    v_cndmask_b32 v69, v69, v67, vcc
    v_cmp_le_u32 vcc, 0x400, v65
    s_nop 1
    v_cndmask_b32 v69, v69, v68, vcc
    v_lshlrev_b32 v69, 2, v69
    ds_read_b32 v70, v69 offset:0
    ds_read_b32 v71, v69 offset:4096
    ds_read_b32 v72, v69 offset:8192
    ds_read_b32 v73, v69 offset:12288
    s_waitcnt lgkmcnt(0)
    v_add_f32 v70, v70, v71
    v_add_f32 v72, v72, v73
    v_add_f32 v81, v70, v72
    v_add_u32 v65, 2, v64
    v_cvt_f32_u32 v65, v65
    v_cvt_pk_bf16_f32 v65, v65, v65
    v_lshlrev_b32 v65, 16, v65
    v_cvt_u32_f32 v65, v65
    v_subrev_u32 v66, 0x100, v65
    v_lshrrev_b32 v66, 1, v66
    v_add_u32 v66, 0x100, v66
    v_subrev_u32 v67, 0x200, v65
    v_lshrrev_b32 v67, 2, v67
    v_add_u32 v67, 0x200, v67
    v_subrev_u32 v68, 0x400, v65
    v_lshrrev_b32 v68, 3, v68
    v_add_u32 v68, 0x300, v68
    v_cmp_le_u32 vcc, 0x100, v65
    s_nop 1
    v_cndmask_b32 v69, v65, v66, vcc
    v_cmp_le_u32 vcc, 0x200, v65
    s_nop 1
    v_cndmask_b32 v69, v69, v67, vcc
    v_cmp_le_u32 vcc, 0x400, v65
    s_nop 1
    v_cndmask_b32 v69, v69, v68, vcc
    v_lshlrev_b32 v69, 2, v69
    ds_read_b32 v70, v69 offset:0
    ds_read_b32 v71, v69 offset:4096
    ds_read_b32 v72, v69 offset:8192
    ds_read_b32 v73, v69 offset:12288
    s_waitcnt lgkmcnt(0)
    v_add_f32 v70, v70, v71
    v_add_f32 v72, v72, v73
    v_add_f32 v82, v70, v72
    v_add_u32 v65, 3, v64
    v_cvt_f32_u32 v65, v65
    v_cvt_pk_bf16_f32 v65, v65, v65
    v_lshlrev_b32 v65, 16, v65
    v_cvt_u32_f32 v65, v65
    v_subrev_u32 v66, 0x100, v65
    v_lshrrev_b32 v66, 1, v66
    v_add_u32 v66, 0x100, v66
    v_subrev_u32 v67, 0x200, v65
    v_lshrrev_b32 v67, 2, v67
    v_add_u32 v67, 0x200, v67
    v_subrev_u32 v68, 0x400, v65
    v_lshrrev_b32 v68, 3, v68
    v_add_u32 v68, 0x300, v68
    v_cmp_le_u32 vcc, 0x100, v65
    s_nop 1
    v_cndmask_b32 v69, v65, v66, vcc
    v_cmp_le_u32 vcc, 0x200, v65
    s_nop 1
    v_cndmask_b32 v69, v69, v67, vcc
    v_cmp_le_u32 vcc, 0x400, v65
    s_nop 1
    v_cndmask_b32 v69, v69, v68, vcc
    v_lshlrev_b32 v69, 2, v69
    ds_read_b32 v70, v69 offset:0
    ds_read_b32 v71, v69 offset:4096
    ds_read_b32 v72, v69 offset:8192
    ds_read_b32 v73, v69 offset:12288
    s_waitcnt lgkmcnt(0)
    v_add_f32 v70, v70, v71
    v_add_f32 v72, v72, v73
    v_add_f32 v83, v70, v72
    v_add_u32 v65, 4, v64
    v_cvt_f32_u32 v65, v65
    v_cvt_pk_bf16_f32 v65, v65, v65
    v_lshlrev_b32 v65, 16, v65
    v_cvt_u32_f32 v65, v65
    v_subrev_u32 v66, 0x100, v65
    v_lshrrev_b32 v66, 1, v66
    v_add_u32 v66, 0x100, v66
    v_subrev_u32 v67, 0x200, v65
    v_lshrrev_b32 v67, 2, v67
    v_add_u32 v67, 0x200, v67
    v_subrev_u32 v68, 0x400, v65
    v_lshrrev_b32 v68, 3, v68
    v_add_u32 v68, 0x300, v68
    v_cmp_le_u32 vcc, 0x100, v65
    s_nop 1
    v_cndmask_b32 v69, v65, v66, vcc
    v_cmp_le_u32 vcc, 0x200, v65
    s_nop 1
    v_cndmask_b32 v69, v69, v67, vcc
    v_cmp_le_u32 vcc, 0x400, v65
    s_nop 1
    v_cndmask_b32 v69, v69, v68, vcc
    v_lshlrev_b32 v69, 2, v69
    ds_read_b32 v70, v69 offset:0
    ds_read_b32 v71, v69 offset:4096
    ds_read_b32 v72, v69 offset:8192
    ds_read_b32 v73, v69 offset:12288
    s_waitcnt lgkmcnt(0)
    v_add_f32 v70, v70, v71
    v_add_f32 v72, v72, v73
    v_add_f32 v84, v70, v72
    v_add_u32 v65, 5, v64
    v_cvt_f32_u32 v65, v65
    v_cvt_pk_bf16_f32 v65, v65, v65
    v_lshlrev_b32 v65, 16, v65
    v_cvt_u32_f32 v65, v65
    v_subrev_u32 v66, 0x100, v65
    v_lshrrev_b32 v66, 1, v66
    v_add_u32 v66, 0x100, v66
    v_subrev_u32 v67, 0x200, v65
    v_lshrrev_b32 v67, 2, v67
    v_add_u32 v67, 0x200, v67
    v_subrev_u32 v68, 0x400, v65
    v_lshrrev_b32 v68, 3, v68
    v_add_u32 v68, 0x300, v68
    v_cmp_le_u32 vcc, 0x100, v65
    s_nop 1
    v_cndmask_b32 v69, v65, v66, vcc
    v_cmp_le_u32 vcc, 0x200, v65
    s_nop 1
    v_cndmask_b32 v69, v69, v67, vcc
    v_cmp_le_u32 vcc, 0x400, v65
    s_nop 1
    v_cndmask_b32 v69, v69, v68, vcc
    v_lshlrev_b32 v69, 2, v69
    ds_read_b32 v70, v69 offset:0
    ds_read_b32 v71, v69 offset:4096
    ds_read_b32 v72, v69 offset:8192
    ds_read_b32 v73, v69 offset:12288
    s_waitcnt lgkmcnt(0)
    v_add_f32 v70, v70, v71
    v_add_f32 v72, v72, v73
    v_add_f32 v85, v70, v72
    v_add_u32 v65, 6, v64
    v_cvt_f32_u32 v65, v65
    v_cvt_pk_bf16_f32 v65, v65, v65
    v_lshlrev_b32 v65, 16, v65
    v_cvt_u32_f32 v65, v65
    v_subrev_u32 v66, 0x100, v65
    v_lshrrev_b32 v66, 1, v66
    v_add_u32 v66, 0x100, v66
    v_subrev_u32 v67, 0x200, v65
    v_lshrrev_b32 v67, 2, v67
    v_add_u32 v67, 0x200, v67
    v_subrev_u32 v68, 0x400, v65
    v_lshrrev_b32 v68, 3, v68
    v_add_u32 v68, 0x300, v68
    v_cmp_le_u32 vcc, 0x100, v65
    s_nop 1
    v_cndmask_b32 v69, v65, v66, vcc
    v_cmp_le_u32 vcc, 0x200, v65
    s_nop 1
    v_cndmask_b32 v69, v69, v67, vcc
    v_cmp_le_u32 vcc, 0x400, v65
    s_nop 1
    v_cndmask_b32 v69, v69, v68, vcc
    v_lshlrev_b32 v69, 2, v69
    ds_read_b32 v70, v69 offset:0
    ds_read_b32 v71, v69 offset:4096
    ds_read_b32 v72, v69 offset:8192
    ds_read_b32 v73, v69 offset:12288
    s_waitcnt lgkmcnt(0)
    v_add_f32 v70, v70, v71
    v_add_f32 v72, v72, v73
    v_add_f32 v86, v70, v72
    v_add_u32 v65, 7, v64
    v_cvt_f32_u32 v65, v65
    v_cvt_pk_bf16_f32 v65, v65, v65
    v_lshlrev_b32 v65, 16, v65
    v_cvt_u32_f32 v65, v65
    v_subrev_u32 v66, 0x100, v65
    v_lshrrev_b32 v66, 1, v66
    v_add_u32 v66, 0x100, v66
    v_subrev_u32 v67, 0x200, v65
    v_lshrrev_b32 v67, 2, v67
    v_add_u32 v67, 0x200, v67
    v_subrev_u32 v68, 0x400, v65
    v_lshrrev_b32 v68, 3, v68
    v_add_u32 v68, 0x300, v68
    v_cmp_le_u32 vcc, 0x100, v65
    s_nop 1
    v_cndmask_b32 v69, v65, v66, vcc
    v_cmp_le_u32 vcc, 0x200, v65
    s_nop 1
    v_cndmask_b32 v69, v69, v67, vcc
    v_cmp_le_u32 vcc, 0x400, v65
    s_nop 1
    v_cndmask_b32 v69, v69, v68, vcc
    v_lshlrev_b32 v69, 2, v69
    ds_read_b32 v70, v69 offset:0
    ds_read_b32 v71, v69 offset:4096
    ds_read_b32 v72, v69 offset:8192
    ds_read_b32 v73, v69 offset:12288
    s_waitcnt lgkmcnt(0)
    v_add_f32 v70, v70, v71
    v_add_f32 v72, v72, v73
    v_add_f32 v87, v70, v72
    s_lshl_b32 s22, s2, 13
    s_add_u32 s22, s22, 11812864
    v_lshlrev_b32 v64, 5, v0
    v_add_u32 v64, s22, v64
    global_store_dwordx4 v64, v[80:83], s[18:19]
    global_store_dwordx4 v64, v[84:87], s[18:19] offset:16
    s_branch prep_end
prep_pack:
    s_load_dwordx4 s[4:7], s[0:1], 80
    v_readfirstlane_b32 s20, v2
    s_waitcnt lgkmcnt(0)
    s_sub_u32 s21, s2, 576
    s_lshl_b32 s21, s21, 2
    s_add_u32 s21, s21, s20
    s_cmp_lt_u32 s21, 1296
    s_cbranch_scc0 prep_pack_w2
    s_mul_hi_u32 s22, s21, 59652324
    s_mul_i32 s23, s22, 72
    s_sub_u32 s23, s21, s23
    s_mul_i32 s24, s22, 294912
    s_lshl_b32 s25, s23, 7
    s_add_u32 s24, s24, s25
    s_mov_b32 s26, 9216
    s_mul_i32 s27, s23, 72
    s_add_u32 s27, s27, s22
    s_lshl_b32 s27, s27, 10
    s_add_u32 s27, s27, 16531456
    s_mov_b32 s28, 18432
    s_mov_b64 s[30:31], s[4:5]
    s_branch prep_pack_go
prep_pack_w2:
    s_sub_u32 s21, s21, 1296
    s_mul_hi_u32 s22, s21, 477218589
    s_mul_i32 s23, s22, 9
    s_sub_u32 s23, s21, s23
    s_mul_i32 s24, s22, 36864
    s_lshl_b32 s25, s23, 7
    s_add_u32 s24, s24, s25
    s_mov_b32 s26, 1152
    s_mul_i32 s27, s23, 576
    s_add_u32 s27, s27, s22
    s_lshl_b32 s27, s27, 10
    s_add_u32 s27, s27, 21839872
    s_mov_b32 s28, 147456
    s_mov_b64 s[30:31], s[6:7]
prep_pack_go:
    v_lshrrev_b32 v3, 3, v1
    v_and_b32 v4, 7, v1
    v_mul_lo_u32 v5, v3, s26
    v_lshl_add_u32 v5, v4, 4, v5
    v_add_u32 v5, s24, v5
    s_lshl_b32 s29, s26, 3
    global_load_dwordx4 v[16:19], v5, s[30:31]
    v_add_u32 v5, s29, v5
    global_load_dwordx4 v[20:23], v5, s[30:31]
    v_add_u32 v5, s29, v5
    global_load_dwordx4 v[24:27], v5, s[30:31]
    v_add_u32 v5, s29, v5
    global_load_dwordx4 v[28:31], v5, s[30:31]
    v_mul_u32_u24 v6, 4608, v2
    v_mul_u32_u24 v7, 144, v3
    v_lshl_add_u32 v7, v4, 4, v7
    v_add_u32 v7, v7, v6
    s_waitcnt vmcnt(0)
    ds_write_b128 v7, v[16:19] offset:0
    ds_write_b128 v7, v[20:23] offset:1152
    ds_write_b128 v7, v[24:27] offset:2304
    ds_write_b128 v7, v[28:31] offset:3456
    v_and_b32 v8, 15, v1
    v_lshrrev_b32 v9, 4, v1
    v_mul_u32_u24 v9, 1152, v9
    v_lshl_add_u32 v9, v8, 1, v9
    v_add_u32 v9, v9, v6
    s_waitcnt lgkmcnt(0)
    ds_read_u16 v64, v9 offset:0
    ds_read_u16 v65, v9 offset:144
    ds_read_u16 v66, v9 offset:288
    ds_read_u16 v67, v9 offset:432
    ds_read_u16 v68, v9 offset:576
    ds_read_u16 v69, v9 offset:720
    ds_read_u16 v70, v9 offset:864
    ds_read_u16 v71, v9 offset:1008
    ds_read_u16 v72, v9 offset:32
    ds_read_u16 v73, v9 offset:176
    ds_read_u16 v74, v9 offset:320
    ds_read_u16 v75, v9 offset:464
    ds_read_u16 v76, v9 offset:608
    ds_read_u16 v77, v9 offset:752
    ds_read_u16 v78, v9 offset:896
    ds_read_u16 v79, v9 offset:1040
    ds_read_u16 v80, v9 offset:64
    ds_read_u16 v81, v9 offset:208
    ds_read_u16 v82, v9 offset:352
    ds_read_u16 v83, v9 offset:496
    ds_read_u16 v84, v9 offset:640
    ds_read_u16 v85, v9 offset:784
    ds_read_u16 v86, v9 offset:928
    ds_read_u16 v87, v9 offset:1072
    ds_read_u16 v88, v9 offset:96
    ds_read_u16 v89, v9 offset:240
    ds_read_u16 v90, v9 offset:384
    ds_read_u16 v91, v9 offset:528
    ds_read_u16 v92, v9 offset:672
    ds_read_u16 v93, v9 offset:816
    ds_read_u16 v94, v9 offset:960
    ds_read_u16 v95, v9 offset:1104
    v_lshlrev_b32 v10, 4, v1
    v_add_u32 v10, s27, v10
    s_waitcnt lgkmcnt(0)
    v_lshl_or_b32 v32, v65, 16, v64
    v_lshl_or_b32 v33, v67, 16, v66
    v_lshl_or_b32 v34, v69, 16, v68
    v_lshl_or_b32 v35, v71, 16, v70
    v_lshl_or_b32 v36, v73, 16, v72
    v_lshl_or_b32 v37, v75, 16, v74
    v_lshl_or_b32 v38, v77, 16, v76
    v_lshl_or_b32 v39, v79, 16, v78
    v_lshl_or_b32 v40, v81, 16, v80
    v_lshl_or_b32 v41, v83, 16, v82
    v_lshl_or_b32 v42, v85, 16, v84
    v_lshl_or_b32 v43, v87, 16, v86
    v_lshl_or_b32 v44, v89, 16, v88
    v_lshl_or_b32 v45, v91, 16, v90
    v_lshl_or_b32 v46, v93, 16, v92
    v_lshl_or_b32 v47, v95, 16, v94
    global_store_dwordx4 v10, v[32:35], s[18:19]
    v_add_u32 v10, s28, v10
    global_store_dwordx4 v10, v[36:39], s[18:19]
    v_add_u32 v10, s28, v10
    global_store_dwordx4 v10, v[40:43], s[18:19]
    v_add_u32 v10, s28, v10
    global_store_dwordx4 v10, v[44:47], s[18:19]
    s_branch prep_end
prep_ln1:
    s_load_dwordx2 s[4:5], s[0:1], 0
    s_mov_b32 s20, s2
    s_lshl_b32 s20, s20, 6
    v_add_u32 v3, s20, v1
    v_mul_u32_u24 v5, 1152, v3
    v_mul_u32_u24 v6, 288, v2
    v_add_u32 v5, v5, v6
    s_waitcnt lgkmcnt(0)
    global_load_dwordx4 v[16:19], v5, s[4:5] offset:0
    global_load_dwordx4 v[20:23], v5, s[4:5] offset:16
    global_load_dwordx4 v[24:27], v5, s[4:5] offset:32
    global_load_dwordx4 v[28:31], v5, s[4:5] offset:48
    global_load_dwordx4 v[32:35], v5, s[4:5] offset:64
    global_load_dwordx4 v[36:39], v5, s[4:5] offset:80
    global_load_dwordx4 v[40:43], v5, s[4:5] offset:96
    global_load_dwordx4 v[44:47], v5, s[4:5] offset:112
    global_load_dwordx4 v[48:51], v5, s[4:5] offset:128
    global_load_dwordx4 v[52:55], v5, s[4:5] offset:144
    global_load_dwordx4 v[56:59], v5, s[4:5] offset:160
    global_load_dwordx4 v[60:63], v5, s[4:5] offset:176
    global_load_dwordx4 v[64:67], v5, s[4:5] offset:192
    global_load_dwordx4 v[68:71], v5, s[4:5] offset:208
    global_load_dwordx4 v[72:75], v5, s[4:5] offset:224
    global_load_dwordx4 v[76:79], v5, s[4:5] offset:240
    global_load_dwordx4 v[80:83], v5, s[4:5] offset:256
    global_load_dwordx4 v[84:87], v5, s[4:5] offset:272
    s_add_u32 s6, s18, 2375680
    s_addc_u32 s7, s19, 0
    s_add_u32 s8, s18, 16384
    s_addc_u32 s9, s19, 0
    v_mov_b32 v7, 0
    s_waitcnt vmcnt(0)
    v_lshlrev_b32 v8, 16, v16
    v_and_b32 v9, 0xffff0000, v16
    v_add_f32 v7, v7, v8
    v_add_f32 v7, v7, v9
    v_lshlrev_b32 v8, 16, v17
    v_and_b32 v9, 0xffff0000, v17
    v_add_f32 v7, v7, v8
    v_add_f32 v7, v7, v9
    v_lshlrev_b32 v8, 16, v18
    v_and_b32 v9, 0xffff0000, v18
    v_add_f32 v7, v7, v8
    v_add_f32 v7, v7, v9
    v_lshlrev_b32 v8, 16, v19
    v_and_b32 v9, 0xffff0000, v19
    v_add_f32 v7, v7, v8
    v_add_f32 v7, v7, v9
    v_lshlrev_b32 v8, 16, v20
    v_and_b32 v9, 0xffff0000, v20
    v_add_f32 v7, v7, v8
    v_add_f32 v7, v7, v9
    v_lshlrev_b32 v8, 16, v21
    v_and_b32 v9, 0xffff0000, v21
    v_add_f32 v7, v7, v8
    v_add_f32 v7, v7, v9
    v_lshlrev_b32 v8, 16, v22
    v_and_b32 v9, 0xffff0000, v22
    v_add_f32 v7, v7, v8
    v_add_f32 v7, v7, v9
    v_lshlrev_b32 v8, 16, v23
    v_and_b32 v9, 0xffff0000, v23
    v_add_f32 v7, v7, v8
    v_add_f32 v7, v7, v9
    v_lshlrev_b32 v8, 16, v24
    v_and_b32 v9, 0xffff0000, v24
    v_add_f32 v7, v7, v8
    v_add_f32 v7, v7, v9
    v_lshlrev_b32 v8, 16, v25
    v_and_b32 v9, 0xffff0000, v25
    v_add_f32 v7, v7, v8
    v_add_f32 v7, v7, v9
    v_lshlrev_b32 v8, 16, v26
    v_and_b32 v9, 0xffff0000, v26
    v_add_f32 v7, v7, v8
    v_add_f32 v7, v7, v9
    v_lshlrev_b32 v8, 16, v27
    v_and_b32 v9, 0xffff0000, v27
    v_add_f32 v7, v7, v8
    v_add_f32 v7, v7, v9
    v_lshlrev_b32 v8, 16, v28
    v_and_b32 v9, 0xffff0000, v28
    v_add_f32 v7, v7, v8
    v_add_f32 v7, v7, v9
    v_lshlrev_b32 v8, 16, v29
    v_and_b32 v9, 0xffff0000, v29
    v_add_f32 v7, v7, v8
    v_add_f32 v7, v7, v9
    v_lshlrev_b32 v8, 16, v30
    v_and_b32 v9, 0xffff0000, v30
    v_add_f32 v7, v7, v8
    v_add_f32 v7, v7, v9
    v_lshlrev_b32 v8, 16, v31
    v_and_b32 v9, 0xffff0000, v31
    v_add_f32 v7, v7, v8
    v_add_f32 v7, v7, v9
    v_lshlrev_b32 v8, 16, v32
    v_and_b32 v9, 0xffff0000, v32
    v_add_f32 v7, v7, v8
    v_add_f32 v7, v7, v9
    v_lshlrev_b32 v8, 16, v33
    v_and_b32 v9, 0xffff0000, v33
    v_add_f32 v7, v7, v8
    v_add_f32 v7, v7, v9
    v_lshlrev_b32 v8, 16, v34
    v_and_b32 v9, 0xffff0000, v34
    v_add_f32 v7, v7, v8
    v_add_f32 v7, v7, v9
    v_lshlrev_b32 v8, 16, v35
    v_and_b32 v9, 0xffff0000, v35
    v_add_f32 v7, v7, v8
    v_add_f32 v7, v7, v9
    v_lshlrev_b32 v8, 16, v36
    v_and_b32 v9, 0xffff0000, v36
    v_add_f32 v7, v7, v8
    v_add_f32 v7, v7, v9
    v_lshlrev_b32 v8, 16, v37
    v_and_b32 v9, 0xffff0000, v37
    v_add_f32 v7, v7, v8
    v_add_f32 v7, v7, v9
    v_lshlrev_b32 v8, 16, v38
    v_and_b32 v9, 0xffff0000, v38
    v_add_f32 v7, v7, v8
    v_add_f32 v7, v7, v9
    v_lshlrev_b32 v8, 16, v39
    v_and_b32 v9, 0xffff0000, v39
    v_add_f32 v7, v7, v8
    v_add_f32 v7, v7, v9
    v_lshlrev_b32 v8, 16, v40
    v_and_b32 v9, 0xffff0000, v40
    v_add_f32 v7, v7, v8
    v_add_f32 v7, v7, v9
    v_lshlrev_b32 v8, 16, v41
    v_and_b32 v9, 0xffff0000, v41
    v_add_f32 v7, v7, v8
    v_add_f32 v7, v7, v9
    v_lshlrev_b32 v8, 16, v42
    v_and_b32 v9, 0xffff0000, v42
    v_add_f32 v7, v7, v8
    v_add_f32 v7, v7, v9
    v_lshlrev_b32 v8, 16, v43
    v_and_b32 v9, 0xffff0000, v43
    v_add_f32 v7, v7, v8
    v_add_f32 v7, v7, v9
    v_lshlrev_b32 v8, 16, v44
    v_and_b32 v9, 0xffff0000, v44
    v_add_f32 v7, v7, v8
    v_add_f32 v7, v7, v9
    v_lshlrev_b32 v8, 16, v45
    v_and_b32 v9, 0xffff0000, v45
    v_add_f32 v7, v7, v8
    v_add_f32 v7, v7, v9
    v_lshlrev_b32 v8, 16, v46
    v_and_b32 v9, 0xffff0000, v46
    v_add_f32 v7, v7, v8
    v_add_f32 v7, v7, v9
    v_lshlrev_b32 v8, 16, v47
    v_and_b32 v9, 0xffff0000, v47
    v_add_f32 v7, v7, v8
    v_add_f32 v7, v7, v9
    v_lshlrev_b32 v8, 16, v48
    v_and_b32 v9, 0xffff0000, v48
    v_add_f32 v7, v7, v8
    v_add_f32 v7, v7, v9
    v_lshlrev_b32 v8, 16, v49
    v_and_b32 v9, 0xffff0000, v49
    v_add_f32 v7, v7, v8
    v_add_f32 v7, v7, v9
    v_lshlrev_b32 v8, 16, v50
    v_and_b32 v9, 0xffff0000, v50
    v_add_f32 v7, v7, v8
    v_add_f32 v7, v7, v9
    v_lshlrev_b32 v8, 16, v51
    v_and_b32 v9, 0xffff0000, v51
    v_add_f32 v7, v7, v8
    v_add_f32 v7, v7, v9
    v_lshlrev_b32 v8, 16, v52
    v_and_b32 v9, 0xffff0000, v52
    v_add_f32 v7, v7, v8
    v_add_f32 v7, v7, v9
    v_lshlrev_b32 v8, 16, v53
    v_and_b32 v9, 0xffff0000, v53
    v_add_f32 v7, v7, v8
    v_add_f32 v7, v7, v9
    v_lshlrev_b32 v8, 16, v54
    v_and_b32 v9, 0xffff0000, v54
    v_add_f32 v7, v7, v8
    v_add_f32 v7, v7, v9
    v_lshlrev_b32 v8, 16, v55
    v_and_b32 v9, 0xffff0000, v55
    v_add_f32 v7, v7, v8
    v_add_f32 v7, v7, v9
    v_lshlrev_b32 v8, 16, v56
    v_and_b32 v9, 0xffff0000, v56
    v_add_f32 v7, v7, v8
    v_add_f32 v7, v7, v9
    v_lshlrev_b32 v8, 16, v57
    v_and_b32 v9, 0xffff0000, v57
    v_add_f32 v7, v7, v8
    v_add_f32 v7, v7, v9
    v_lshlrev_b32 v8, 16, v58
    v_and_b32 v9, 0xffff0000, v58
    v_add_f32 v7, v7, v8
    v_add_f32 v7, v7, v9
    v_lshlrev_b32 v8, 16, v59
    v_and_b32 v9, 0xffff0000, v59
    v_add_f32 v7, v7, v8
    v_add_f32 v7, v7, v9
    v_lshlrev_b32 v8, 16, v60
    v_and_b32 v9, 0xffff0000, v60
    v_add_f32 v7, v7, v8
    v_add_f32 v7, v7, v9
    v_lshlrev_b32 v8, 16, v61
    v_and_b32 v9, 0xffff0000, v61
    v_add_f32 v7, v7, v8
    v_add_f32 v7, v7, v9
    v_lshlrev_b32 v8, 16, v62
    v_and_b32 v9, 0xffff0000, v62
    v_add_f32 v7, v7, v8
    v_add_f32 v7, v7, v9
    v_lshlrev_b32 v8, 16, v63
    v_and_b32 v9, 0xffff0000, v63
    v_add_f32 v7, v7, v8
    v_add_f32 v7, v7, v9
    v_lshlrev_b32 v8, 16, v64
    v_and_b32 v9, 0xffff0000, v64
    v_add_f32 v7, v7, v8
    v_add_f32 v7, v7, v9
    v_lshlrev_b32 v8, 16, v65
    v_and_b32 v9, 0xffff0000, v65
    v_add_f32 v7, v7, v8
    v_add_f32 v7, v7, v9
    v_lshlrev_b32 v8, 16, v66
    v_and_b32 v9, 0xffff0000, v66
    v_add_f32 v7, v7, v8
    v_add_f32 v7, v7, v9
    v_lshlrev_b32 v8, 16, v67
    v_and_b32 v9, 0xffff0000, v67
    v_add_f32 v7, v7, v8
    v_add_f32 v7, v7, v9
    v_lshlrev_b32 v8, 16, v68
    v_and_b32 v9, 0xffff0000, v68
    v_add_f32 v7, v7, v8
    v_add_f32 v7, v7, v9
    v_lshlrev_b32 v8, 16, v69
    v_and_b32 v9, 0xffff0000, v69
    v_add_f32 v7, v7, v8
    v_add_f32 v7, v7, v9
    v_lshlrev_b32 v8, 16, v70
    v_and_b32 v9, 0xffff0000, v70
    v_add_f32 v7, v7, v8
    v_add_f32 v7, v7, v9
    v_lshlrev_b32 v8, 16, v71
    v_and_b32 v9, 0xffff0000, v71
    v_add_f32 v7, v7, v8
    v_add_f32 v7, v7, v9
    v_lshlrev_b32 v8, 16, v72
    v_and_b32 v9, 0xffff0000, v72
    v_add_f32 v7, v7, v8
    v_add_f32 v7, v7, v9
    v_lshlrev_b32 v8, 16, v73
    v_and_b32 v9, 0xffff0000, v73
    v_add_f32 v7, v7, v8
    v_add_f32 v7, v7, v9
    v_lshlrev_b32 v8, 16, v74
    v_and_b32 v9, 0xffff0000, v74
    v_add_f32 v7, v7, v8
    v_add_f32 v7, v7, v9
    v_lshlrev_b32 v8, 16, v75
    v_and_b32 v9, 0xffff0000, v75
    v_add_f32 v7, v7, v8
    v_add_f32 v7, v7, v9
    v_lshlrev_b32 v8, 16, v76
    v_and_b32 v9, 0xffff0000, v76
    v_add_f32 v7, v7, v8
    v_add_f32 v7, v7, v9
    v_lshlrev_b32 v8, 16, v77
    v_and_b32 v9, 0xffff0000, v77
    v_add_f32 v7, v7, v8
    v_add_f32 v7, v7, v9
    v_lshlrev_b32 v8, 16, v78
    v_and_b32 v9, 0xffff0000, v78
    v_add_f32 v7, v7, v8
    v_add_f32 v7, v7, v9
    v_lshlrev_b32 v8, 16, v79
    v_and_b32 v9, 0xffff0000, v79
    v_add_f32 v7, v7, v8
    v_add_f32 v7, v7, v9
    v_lshlrev_b32 v8, 16, v80
    v_and_b32 v9, 0xffff0000, v80
    v_add_f32 v7, v7, v8
    v_add_f32 v7, v7, v9
    v_lshlrev_b32 v8, 16, v81
    v_and_b32 v9, 0xffff0000, v81
    v_add_f32 v7, v7, v8
    v_add_f32 v7, v7, v9
    v_lshlrev_b32 v8, 16, v82
    v_and_b32 v9, 0xffff0000, v82
    v_add_f32 v7, v7, v8
    v_add_f32 v7, v7, v9
    v_lshlrev_b32 v8, 16, v83
    v_and_b32 v9, 0xffff0000, v83
    v_add_f32 v7, v7, v8
    v_add_f32 v7, v7, v9
    v_lshlrev_b32 v8, 16, v84
    v_and_b32 v9, 0xffff0000, v84
    v_add_f32 v7, v7, v8
    v_add_f32 v7, v7, v9
    v_lshlrev_b32 v8, 16, v85
    v_and_b32 v9, 0xffff0000, v85
    v_add_f32 v7, v7, v8
    v_add_f32 v7, v7, v9
    v_lshlrev_b32 v8, 16, v86
    v_and_b32 v9, 0xffff0000, v86
    v_add_f32 v7, v7, v8
    v_add_f32 v7, v7, v9
    v_lshlrev_b32 v8, 16, v87
    v_and_b32 v9, 0xffff0000, v87
    v_add_f32 v7, v7, v8
    v_add_f32 v7, v7, v9
    v_lshlrev_b32 v10, 2, v0
    v_lshlrev_b32 v11, 2, v1
    ds_write_b32 v10, v7
    s_waitcnt lgkmcnt(0)
    s_barrier
    ds_read_b32 v96, v11 offset:0
    ds_read_b32 v97, v11 offset:256
    ds_read_b32 v98, v11 offset:512
    ds_read_b32 v99, v11 offset:768
    s_waitcnt lgkmcnt(0)
    v_add_f32 v96, v96, v97
    v_add_f32 v98, v98, v99
    v_add_f32 v96, v96, v98
    s_mov_b32 s10, 0x3ae38e39
    v_mul_f32 v12, s10, v96
    v_mov_b32 v7, 0
    v_lshlrev_b32 v8, 16, v16
    v_and_b32 v9, 0xffff0000, v16
    v_sub_f32 v8, v8, v12
    v_sub_f32 v9, v9, v12
    v_fma_f32 v7, v8, v8, v7
    v_fma_f32 v7, v9, v9, v7
    v_lshlrev_b32 v8, 16, v17
    v_and_b32 v9, 0xffff0000, v17
    v_sub_f32 v8, v8, v12
    v_sub_f32 v9, v9, v12
    v_fma_f32 v7, v8, v8, v7
    v_fma_f32 v7, v9, v9, v7
    v_lshlrev_b32 v8, 16, v18
    v_and_b32 v9, 0xffff0000, v18
    v_sub_f32 v8, v8, v12
    v_sub_f32 v9, v9, v12
    v_fma_f32 v7, v8, v8, v7
    v_fma_f32 v7, v9, v9, v7
    v_lshlrev_b32 v8, 16, v19
    v_and_b32 v9, 0xffff0000, v19
    v_sub_f32 v8, v8, v12
    v_sub_f32 v9, v9, v12
    v_fma_f32 v7, v8, v8, v7
    v_fma_f32 v7, v9, v9, v7
    v_lshlrev_b32 v8, 16, v20
    v_and_b32 v9, 0xffff0000, v20
    v_sub_f32 v8, v8, v12
    v_sub_f32 v9, v9, v12
    v_fma_f32 v7, v8, v8, v7
    v_fma_f32 v7, v9, v9, v7
    v_lshlrev_b32 v8, 16, v21
    v_and_b32 v9, 0xffff0000, v21
    v_sub_f32 v8, v8, v12
    v_sub_f32 v9, v9, v12
    v_fma_f32 v7, v8, v8, v7
    v_fma_f32 v7, v9, v9, v7
    v_lshlrev_b32 v8, 16, v22
    v_and_b32 v9, 0xffff0000, v22
    v_sub_f32 v8, v8, v12
    v_sub_f32 v9, v9, v12
    v_fma_f32 v7, v8, v8, v7
    v_fma_f32 v7, v9, v9, v7
    v_lshlrev_b32 v8, 16, v23
    v_and_b32 v9, 0xffff0000, v23
    v_sub_f32 v8, v8, v12
    v_sub_f32 v9, v9, v12
    v_fma_f32 v7, v8, v8, v7
    v_fma_f32 v7, v9, v9, v7
    v_lshlrev_b32 v8, 16, v24
    v_and_b32 v9, 0xffff0000, v24
    v_sub_f32 v8, v8, v12
    v_sub_f32 v9, v9, v12
    v_fma_f32 v7, v8, v8, v7
    v_fma_f32 v7, v9, v9, v7
    v_lshlrev_b32 v8, 16, v25
    v_and_b32 v9, 0xffff0000, v25
    v_sub_f32 v8, v8, v12
    v_sub_f32 v9, v9, v12
    v_fma_f32 v7, v8, v8, v7
    v_fma_f32 v7, v9, v9, v7
    v_lshlrev_b32 v8, 16, v26
    v_and_b32 v9, 0xffff0000, v26
    v_sub_f32 v8, v8, v12
    v_sub_f32 v9, v9, v12
    v_fma_f32 v7, v8, v8, v7
    v_fma_f32 v7, v9, v9, v7
    v_lshlrev_b32 v8, 16, v27
    v_and_b32 v9, 0xffff0000, v27
    v_sub_f32 v8, v8, v12
    v_sub_f32 v9, v9, v12
    v_fma_f32 v7, v8, v8, v7
    v_fma_f32 v7, v9, v9, v7
    v_lshlrev_b32 v8, 16, v28
    v_and_b32 v9, 0xffff0000, v28
    v_sub_f32 v8, v8, v12
    v_sub_f32 v9, v9, v12
    v_fma_f32 v7, v8, v8, v7
    v_fma_f32 v7, v9, v9, v7
    v_lshlrev_b32 v8, 16, v29
    v_and_b32 v9, 0xffff0000, v29
    v_sub_f32 v8, v8, v12
    v_sub_f32 v9, v9, v12
    v_fma_f32 v7, v8, v8, v7
    v_fma_f32 v7, v9, v9, v7
    v_lshlrev_b32 v8, 16, v30
    v_and_b32 v9, 0xffff0000, v30
    v_sub_f32 v8, v8, v12
    v_sub_f32 v9, v9, v12
    v_fma_f32 v7, v8, v8, v7
    v_fma_f32 v7, v9, v9, v7
    v_lshlrev_b32 v8, 16, v31
    v_and_b32 v9, 0xffff0000, v31
    v_sub_f32 v8, v8, v12
    v_sub_f32 v9, v9, v12
    v_fma_f32 v7, v8, v8, v7
    v_fma_f32 v7, v9, v9, v7
    v_lshlrev_b32 v8, 16, v32
    v_and_b32 v9, 0xffff0000, v32
    v_sub_f32 v8, v8, v12
    v_sub_f32 v9, v9, v12
    v_fma_f32 v7, v8, v8, v7
    v_fma_f32 v7, v9, v9, v7
    v_lshlrev_b32 v8, 16, v33
    v_and_b32 v9, 0xffff0000, v33
    v_sub_f32 v8, v8, v12
    v_sub_f32 v9, v9, v12
    v_fma_f32 v7, v8, v8, v7
    v_fma_f32 v7, v9, v9, v7
    v_lshlrev_b32 v8, 16, v34
    v_and_b32 v9, 0xffff0000, v34
    v_sub_f32 v8, v8, v12
    v_sub_f32 v9, v9, v12
    v_fma_f32 v7, v8, v8, v7
    v_fma_f32 v7, v9, v9, v7
    v_lshlrev_b32 v8, 16, v35
    v_and_b32 v9, 0xffff0000, v35
    v_sub_f32 v8, v8, v12
    v_sub_f32 v9, v9, v12
    v_fma_f32 v7, v8, v8, v7
    v_fma_f32 v7, v9, v9, v7
    v_lshlrev_b32 v8, 16, v36
    v_and_b32 v9, 0xffff0000, v36
    v_sub_f32 v8, v8, v12
    v_sub_f32 v9, v9, v12
    v_fma_f32 v7, v8, v8, v7
    v_fma_f32 v7, v9, v9, v7
    v_lshlrev_b32 v8, 16, v37
    v_and_b32 v9, 0xffff0000, v37
    v_sub_f32 v8, v8, v12
    v_sub_f32 v9, v9, v12
    v_fma_f32 v7, v8, v8, v7
    v_fma_f32 v7, v9, v9, v7
    v_lshlrev_b32 v8, 16, v38
    v_and_b32 v9, 0xffff0000, v38
    v_sub_f32 v8, v8, v12
    v_sub_f32 v9, v9, v12
    v_fma_f32 v7, v8, v8, v7
    v_fma_f32 v7, v9, v9, v7
    v_lshlrev_b32 v8, 16, v39
    v_and_b32 v9, 0xffff0000, v39
    v_sub_f32 v8, v8, v12
    v_sub_f32 v9, v9, v12
    v_fma_f32 v7, v8, v8, v7
    v_fma_f32 v7, v9, v9, v7
    v_lshlrev_b32 v8, 16, v40
    v_and_b32 v9, 0xffff0000, v40
    v_sub_f32 v8, v8, v12
    v_sub_f32 v9, v9, v12
    v_fma_f32 v7, v8, v8, v7
    v_fma_f32 v7, v9, v9, v7
    v_lshlrev_b32 v8, 16, v41
    v_and_b32 v9, 0xffff0000, v41
    v_sub_f32 v8, v8, v12
    v_sub_f32 v9, v9, v12
    v_fma_f32 v7, v8, v8, v7
    v_fma_f32 v7, v9, v9, v7
    v_lshlrev_b32 v8, 16, v42
    v_and_b32 v9, 0xffff0000, v42
    v_sub_f32 v8, v8, v12
    v_sub_f32 v9, v9, v12
    v_fma_f32 v7, v8, v8, v7
    v_fma_f32 v7, v9, v9, v7
    v_lshlrev_b32 v8, 16, v43
    v_and_b32 v9, 0xffff0000, v43
    v_sub_f32 v8, v8, v12
    v_sub_f32 v9, v9, v12
    v_fma_f32 v7, v8, v8, v7
    v_fma_f32 v7, v9, v9, v7
    v_lshlrev_b32 v8, 16, v44
    v_and_b32 v9, 0xffff0000, v44
    v_sub_f32 v8, v8, v12
    v_sub_f32 v9, v9, v12
    v_fma_f32 v7, v8, v8, v7
    v_fma_f32 v7, v9, v9, v7
    v_lshlrev_b32 v8, 16, v45
    v_and_b32 v9, 0xffff0000, v45
    v_sub_f32 v8, v8, v12
    v_sub_f32 v9, v9, v12
    v_fma_f32 v7, v8, v8, v7
    v_fma_f32 v7, v9, v9, v7
    v_lshlrev_b32 v8, 16, v46
    v_and_b32 v9, 0xffff0000, v46
    v_sub_f32 v8, v8, v12
    v_sub_f32 v9, v9, v12
    v_fma_f32 v7, v8, v8, v7
    v_fma_f32 v7, v9, v9, v7
    v_lshlrev_b32 v8, 16, v47
    v_and_b32 v9, 0xffff0000, v47
    v_sub_f32 v8, v8, v12
    v_sub_f32 v9, v9, v12
    v_fma_f32 v7, v8, v8, v7
    v_fma_f32 v7, v9, v9, v7
    v_lshlrev_b32 v8, 16, v48
    v_and_b32 v9, 0xffff0000, v48
    v_sub_f32 v8, v8, v12
    v_sub_f32 v9, v9, v12
    v_fma_f32 v7, v8, v8, v7
    v_fma_f32 v7, v9, v9, v7
    v_lshlrev_b32 v8, 16, v49
    v_and_b32 v9, 0xffff0000, v49
    v_sub_f32 v8, v8, v12
    v_sub_f32 v9, v9, v12
    v_fma_f32 v7, v8, v8, v7
    v_fma_f32 v7, v9, v9, v7
    v_lshlrev_b32 v8, 16, v50
    v_and_b32 v9, 0xffff0000, v50
    v_sub_f32 v8, v8, v12
    v_sub_f32 v9, v9, v12
    v_fma_f32 v7, v8, v8, v7
    v_fma_f32 v7, v9, v9, v7
    v_lshlrev_b32 v8, 16, v51
    v_and_b32 v9, 0xffff0000, v51
    v_sub_f32 v8, v8, v12
    v_sub_f32 v9, v9, v12
    v_fma_f32 v7, v8, v8, v7
    v_fma_f32 v7, v9, v9, v7
    v_lshlrev_b32 v8, 16, v52
    v_and_b32 v9, 0xffff0000, v52
    v_sub_f32 v8, v8, v12
    v_sub_f32 v9, v9, v12
    v_fma_f32 v7, v8, v8, v7
    v_fma_f32 v7, v9, v9, v7
    v_lshlrev_b32 v8, 16, v53
    v_and_b32 v9, 0xffff0000, v53
    v_sub_f32 v8, v8, v12
    v_sub_f32 v9, v9, v12
    v_fma_f32 v7, v8, v8, v7
    v_fma_f32 v7, v9, v9, v7
    v_lshlrev_b32 v8, 16, v54
    v_and_b32 v9, 0xffff0000, v54
    v_sub_f32 v8, v8, v12
    v_sub_f32 v9, v9, v12
    v_fma_f32 v7, v8, v8, v7
    v_fma_f32 v7, v9, v9, v7
    v_lshlrev_b32 v8, 16, v55
    v_and_b32 v9, 0xffff0000, v55
    v_sub_f32 v8, v8, v12
    v_sub_f32 v9, v9, v12
    v_fma_f32 v7, v8, v8, v7
    v_fma_f32 v7, v9, v9, v7
    v_lshlrev_b32 v8, 16, v56
    v_and_b32 v9, 0xffff0000, v56
    v_sub_f32 v8, v8, v12
    v_sub_f32 v9, v9, v12
    v_fma_f32 v7, v8, v8, v7
    v_fma_f32 v7, v9, v9, v7
    v_lshlrev_b32 v8, 16, v57
    v_and_b32 v9, 0xffff0000, v57
    v_sub_f32 v8, v8, v12
    v_sub_f32 v9, v9, v12
    v_fma_f32 v7, v8, v8, v7
    v_fma_f32 v7, v9, v9, v7
    v_lshlrev_b32 v8, 16, v58
    v_and_b32 v9, 0xffff0000, v58
    v_sub_f32 v8, v8, v12
    v_sub_f32 v9, v9, v12
    v_fma_f32 v7, v8, v8, v7
    v_fma_f32 v7, v9, v9, v7
    v_lshlrev_b32 v8, 16, v59
    v_and_b32 v9, 0xffff0000, v59
    v_sub_f32 v8, v8, v12
    v_sub_f32 v9, v9, v12
    v_fma_f32 v7, v8, v8, v7
    v_fma_f32 v7, v9, v9, v7
    v_lshlrev_b32 v8, 16, v60
    v_and_b32 v9, 0xffff0000, v60
    v_sub_f32 v8, v8, v12
    v_sub_f32 v9, v9, v12
    v_fma_f32 v7, v8, v8, v7
    v_fma_f32 v7, v9, v9, v7
    v_lshlrev_b32 v8, 16, v61
    v_and_b32 v9, 0xffff0000, v61
    v_sub_f32 v8, v8, v12
    v_sub_f32 v9, v9, v12
    v_fma_f32 v7, v8, v8, v7
    v_fma_f32 v7, v9, v9, v7
    v_lshlrev_b32 v8, 16, v62
    v_and_b32 v9, 0xffff0000, v62
    v_sub_f32 v8, v8, v12
    v_sub_f32 v9, v9, v12
    v_fma_f32 v7, v8, v8, v7
    v_fma_f32 v7, v9, v9, v7
    v_lshlrev_b32 v8, 16, v63
    v_and_b32 v9, 0xffff0000, v63
    v_sub_f32 v8, v8, v12
    v_sub_f32 v9, v9, v12
    v_fma_f32 v7, v8, v8, v7
    v_fma_f32 v7, v9, v9, v7
    v_lshlrev_b32 v8, 16, v64
    v_and_b32 v9, 0xffff0000, v64
    v_sub_f32 v8, v8, v12
    v_sub_f32 v9, v9, v12
    v_fma_f32 v7, v8, v8, v7
    v_fma_f32 v7, v9, v9, v7
    v_lshlrev_b32 v8, 16, v65
    v_and_b32 v9, 0xffff0000, v65
    v_sub_f32 v8, v8, v12
    v_sub_f32 v9, v9, v12
    v_fma_f32 v7, v8, v8, v7
    v_fma_f32 v7, v9, v9, v7
    v_lshlrev_b32 v8, 16, v66
    v_and_b32 v9, 0xffff0000, v66
    v_sub_f32 v8, v8, v12
    v_sub_f32 v9, v9, v12
    v_fma_f32 v7, v8, v8, v7
    v_fma_f32 v7, v9, v9, v7
    v_lshlrev_b32 v8, 16, v67
    v_and_b32 v9, 0xffff0000, v67
    v_sub_f32 v8, v8, v12
    v_sub_f32 v9, v9, v12
    v_fma_f32 v7, v8, v8, v7
    v_fma_f32 v7, v9, v9, v7
    v_lshlrev_b32 v8, 16, v68
    v_and_b32 v9, 0xffff0000, v68
    v_sub_f32 v8, v8, v12
    v_sub_f32 v9, v9, v12
    v_fma_f32 v7, v8, v8, v7
    v_fma_f32 v7, v9, v9, v7
    v_lshlrev_b32 v8, 16, v69
    v_and_b32 v9, 0xffff0000, v69
    v_sub_f32 v8, v8, v12
    v_sub_f32 v9, v9, v12
    v_fma_f32 v7, v8, v8, v7
    v_fma_f32 v7, v9, v9, v7
    v_lshlrev_b32 v8, 16, v70
    v_and_b32 v9, 0xffff0000, v70
    v_sub_f32 v8, v8, v12
    v_sub_f32 v9, v9, v12
    v_fma_f32 v7, v8, v8, v7
    v_fma_f32 v7, v9, v9, v7
    v_lshlrev_b32 v8, 16, v71
    v_and_b32 v9, 0xffff0000, v71
    v_sub_f32 v8, v8, v12
    v_sub_f32 v9, v9, v12
    v_fma_f32 v7, v8, v8, v7
    v_fma_f32 v7, v9, v9, v7
    v_lshlrev_b32 v8, 16, v72
    v_and_b32 v9, 0xffff0000, v72
    v_sub_f32 v8, v8, v12
    v_sub_f32 v9, v9, v12
    v_fma_f32 v7, v8, v8, v7
    v_fma_f32 v7, v9, v9, v7
    v_lshlrev_b32 v8, 16, v73
    v_and_b32 v9, 0xffff0000, v73
    v_sub_f32 v8, v8, v12
    v_sub_f32 v9, v9, v12
    v_fma_f32 v7, v8, v8, v7
    v_fma_f32 v7, v9, v9, v7
    v_lshlrev_b32 v8, 16, v74
    v_and_b32 v9, 0xffff0000, v74
    v_sub_f32 v8, v8, v12
    v_sub_f32 v9, v9, v12
    v_fma_f32 v7, v8, v8, v7
    v_fma_f32 v7, v9, v9, v7
    v_lshlrev_b32 v8, 16, v75
    v_and_b32 v9, 0xffff0000, v75
    v_sub_f32 v8, v8, v12
    v_sub_f32 v9, v9, v12
    v_fma_f32 v7, v8, v8, v7
    v_fma_f32 v7, v9, v9, v7
    v_lshlrev_b32 v8, 16, v76
    v_and_b32 v9, 0xffff0000, v76
    v_sub_f32 v8, v8, v12
    v_sub_f32 v9, v9, v12
    v_fma_f32 v7, v8, v8, v7
    v_fma_f32 v7, v9, v9, v7
    v_lshlrev_b32 v8, 16, v77
    v_and_b32 v9, 0xffff0000, v77
    v_sub_f32 v8, v8, v12
    v_sub_f32 v9, v9, v12
    v_fma_f32 v7, v8, v8, v7
    v_fma_f32 v7, v9, v9, v7
    v_lshlrev_b32 v8, 16, v78
    v_and_b32 v9, 0xffff0000, v78
    v_sub_f32 v8, v8, v12
    v_sub_f32 v9, v9, v12
    v_fma_f32 v7, v8, v8, v7
    v_fma_f32 v7, v9, v9, v7
    v_lshlrev_b32 v8, 16, v79
    v_and_b32 v9, 0xffff0000, v79
    v_sub_f32 v8, v8, v12
    v_sub_f32 v9, v9, v12
    v_fma_f32 v7, v8, v8, v7
    v_fma_f32 v7, v9, v9, v7
    v_lshlrev_b32 v8, 16, v80
    v_and_b32 v9, 0xffff0000, v80
    v_sub_f32 v8, v8, v12
    v_sub_f32 v9, v9, v12
    v_fma_f32 v7, v8, v8, v7
    v_fma_f32 v7, v9, v9, v7
    v_lshlrev_b32 v8, 16, v81
    v_and_b32 v9, 0xffff0000, v81
    v_sub_f32 v8, v8, v12
    v_sub_f32 v9, v9, v12
    v_fma_f32 v7, v8, v8, v7
    v_fma_f32 v7, v9, v9, v7
    v_lshlrev_b32 v8, 16, v82
    v_and_b32 v9, 0xffff0000, v82
    v_sub_f32 v8, v8, v12
    v_sub_f32 v9, v9, v12
    v_fma_f32 v7, v8, v8, v7
    v_fma_f32 v7, v9, v9, v7
    v_lshlrev_b32 v8, 16, v83
    v_and_b32 v9, 0xffff0000, v83
    v_sub_f32 v8, v8, v12
    v_sub_f32 v9, v9, v12
    v_fma_f32 v7, v8, v8, v7
    v_fma_f32 v7, v9, v9, v7
    v_lshlrev_b32 v8, 16, v84
    v_and_b32 v9, 0xffff0000, v84
    v_sub_f32 v8, v8, v12
    v_sub_f32 v9, v9, v12
    v_fma_f32 v7, v8, v8, v7
    v_fma_f32 v7, v9, v9, v7
    v_lshlrev_b32 v8, 16, v85
    v_and_b32 v9, 0xffff0000, v85
    v_sub_f32 v8, v8, v12
    v_sub_f32 v9, v9, v12
    v_fma_f32 v7, v8, v8, v7
    v_fma_f32 v7, v9, v9, v7
    v_lshlrev_b32 v8, 16, v86
    v_and_b32 v9, 0xffff0000, v86
    v_sub_f32 v8, v8, v12
    v_sub_f32 v9, v9, v12
    v_fma_f32 v7, v8, v8, v7
    v_fma_f32 v7, v9, v9, v7
    v_lshlrev_b32 v8, 16, v87
    v_and_b32 v9, 0xffff0000, v87
    v_sub_f32 v8, v8, v12
    v_sub_f32 v9, v9, v12
    v_fma_f32 v7, v8, v8, v7
    v_fma_f32 v7, v9, v9, v7
    s_barrier
    ds_write_b32 v10, v7 offset:1024
    s_waitcnt lgkmcnt(0)
    s_barrier
    ds_read_b32 v96, v11 offset:1024
    ds_read_b32 v97, v11 offset:1280
    ds_read_b32 v98, v11 offset:1536
    ds_read_b32 v99, v11 offset:1792
    s_waitcnt lgkmcnt(0)
    v_add_f32 v96, v96, v97
    v_add_f32 v98, v98, v99
    v_add_f32 v96, v96, v98
    v_mul_f32 v13, s10, v96
    v_cvt_pk_bf16_f32 v12, v12, v12
    v_lshlrev_b32 v12, 16, v12
    v_cvt_pk_bf16_f32 v13, v13, v13
    v_lshlrev_b32 v13, 16, v13
    v_add_f32 v13, 0x3727c5ac, v13
    v_cvt_pk_bf16_f32 v13, v13, v13
    v_lshlrev_b32 v13, 16, v13
    v_sqrt_f32 v13, v13
    s_nop 0
    v_cvt_pk_bf16_f32 v13, v13, v13
    v_lshlrev_b32 v13, 16, v13
    v_rcp_f32 v13, v13
    v_mul_u32_u24 v14, 589824, v2
    v_lshl_add_u32 v14, v3, 1, v14
    v_add_u32 v15, 4096, v14
    v_lshlrev_b32 v8, 16, v16
    v_and_b32 v9, 0xffff0000, v16
    v_sub_f32 v8, v8, v12
    v_sub_f32 v9, v9, v12
    v_cvt_pk_bf16_f32 v8, v8, v9
    v_and_b32 v9, 0xffff0000, v8
    v_lshlrev_b32 v8, 16, v8
    v_mul_f32 v8, v8, v13
    v_mul_f32 v9, v9, v13
    v_cvt_pk_bf16_f32 v8, v8, v9
    global_store_short v14, v8, s[6:7]
    global_store_short_d16_hi v15, v8, s[6:7]
    global_store_short v14, v16, s[8:9]
    global_store_short_d16_hi v15, v16, s[8:9]
    v_add_u32 v14, 8192, v14
    v_add_u32 v15, 8192, v15
    v_lshlrev_b32 v8, 16, v17
    v_and_b32 v9, 0xffff0000, v17
    v_sub_f32 v8, v8, v12
    v_sub_f32 v9, v9, v12
    v_cvt_pk_bf16_f32 v8, v8, v9
    v_and_b32 v9, 0xffff0000, v8
    v_lshlrev_b32 v8, 16, v8
    v_mul_f32 v8, v8, v13
    v_mul_f32 v9, v9, v13
    v_cvt_pk_bf16_f32 v8, v8, v9
    global_store_short v14, v8, s[6:7]
    global_store_short_d16_hi v15, v8, s[6:7]
    global_store_short v14, v17, s[8:9]
    global_store_short_d16_hi v15, v17, s[8:9]
    v_add_u32 v14, 8192, v14
    v_add_u32 v15, 8192, v15
    v_lshlrev_b32 v8, 16, v18
    v_and_b32 v9, 0xffff0000, v18
    v_sub_f32 v8, v8, v12
    v_sub_f32 v9, v9, v12
    v_cvt_pk_bf16_f32 v8, v8, v9
    v_and_b32 v9, 0xffff0000, v8
    v_lshlrev_b32 v8, 16, v8
    v_mul_f32 v8, v8, v13
    v_mul_f32 v9, v9, v13
    v_cvt_pk_bf16_f32 v8, v8, v9
    global_store_short v14, v8, s[6:7]
    global_store_short_d16_hi v15, v8, s[6:7]
    global_store_short v14, v18, s[8:9]
    global_store_short_d16_hi v15, v18, s[8:9]
    v_add_u32 v14, 8192, v14
    v_add_u32 v15, 8192, v15
    v_lshlrev_b32 v8, 16, v19
    v_and_b32 v9, 0xffff0000, v19
    v_sub_f32 v8, v8, v12
    v_sub_f32 v9, v9, v12
    v_cvt_pk_bf16_f32 v8, v8, v9
    v_and_b32 v9, 0xffff0000, v8
    v_lshlrev_b32 v8, 16, v8
    v_mul_f32 v8, v8, v13
    v_mul_f32 v9, v9, v13
    v_cvt_pk_bf16_f32 v8, v8, v9
    global_store_short v14, v8, s[6:7]
    global_store_short_d16_hi v15, v8, s[6:7]
    global_store_short v14, v19, s[8:9]
    global_store_short_d16_hi v15, v19, s[8:9]
    v_add_u32 v14, 8192, v14
    v_add_u32 v15, 8192, v15
    v_lshlrev_b32 v8, 16, v20
    v_and_b32 v9, 0xffff0000, v20
    v_sub_f32 v8, v8, v12
    v_sub_f32 v9, v9, v12
    v_cvt_pk_bf16_f32 v8, v8, v9
    v_and_b32 v9, 0xffff0000, v8
    v_lshlrev_b32 v8, 16, v8
    v_mul_f32 v8, v8, v13
    v_mul_f32 v9, v9, v13
    v_cvt_pk_bf16_f32 v8, v8, v9
    global_store_short v14, v8, s[6:7]
    global_store_short_d16_hi v15, v8, s[6:7]
    global_store_short v14, v20, s[8:9]
    global_store_short_d16_hi v15, v20, s[8:9]
    v_add_u32 v14, 8192, v14
    v_add_u32 v15, 8192, v15
    v_lshlrev_b32 v8, 16, v21
    v_and_b32 v9, 0xffff0000, v21
    v_sub_f32 v8, v8, v12
    v_sub_f32 v9, v9, v12
    v_cvt_pk_bf16_f32 v8, v8, v9
    v_and_b32 v9, 0xffff0000, v8
    v_lshlrev_b32 v8, 16, v8
    v_mul_f32 v8, v8, v13
    v_mul_f32 v9, v9, v13
    v_cvt_pk_bf16_f32 v8, v8, v9
    global_store_short v14, v8, s[6:7]
    global_store_short_d16_hi v15, v8, s[6:7]
    global_store_short v14, v21, s[8:9]
    global_store_short_d16_hi v15, v21, s[8:9]
    v_add_u32 v14, 8192, v14
    v_add_u32 v15, 8192, v15
    v_lshlrev_b32 v8, 16, v22
    v_and_b32 v9, 0xffff0000, v22
    v_sub_f32 v8, v8, v12
    v_sub_f32 v9, v9, v12
    v_cvt_pk_bf16_f32 v8, v8, v9
    v_and_b32 v9, 0xffff0000, v8
    v_lshlrev_b32 v8, 16, v8
    v_mul_f32 v8, v8, v13
    v_mul_f32 v9, v9, v13
    v_cvt_pk_bf16_f32 v8, v8, v9
    global_store_short v14, v8, s[6:7]
    global_store_short_d16_hi v15, v8, s[6:7]
    global_store_short v14, v22, s[8:9]
    global_store_short_d16_hi v15, v22, s[8:9]
    v_add_u32 v14, 8192, v14
    v_add_u32 v15, 8192, v15
    v_lshlrev_b32 v8, 16, v23
    v_and_b32 v9, 0xffff0000, v23
    v_sub_f32 v8, v8, v12
    v_sub_f32 v9, v9, v12
    v_cvt_pk_bf16_f32 v8, v8, v9
    v_and_b32 v9, 0xffff0000, v8
    v_lshlrev_b32 v8, 16, v8
    v_mul_f32 v8, v8, v13
    v_mul_f32 v9, v9, v13
    v_cvt_pk_bf16_f32 v8, v8, v9
    global_store_short v14, v8, s[6:7]
    global_store_short_d16_hi v15, v8, s[6:7]
    global_store_short v14, v23, s[8:9]
    global_store_short_d16_hi v15, v23, s[8:9]
    v_add_u32 v14, 8192, v14
    v_add_u32 v15, 8192, v15
    v_lshlrev_b32 v8, 16, v24
    v_and_b32 v9, 0xffff0000, v24
    v_sub_f32 v8, v8, v12
    v_sub_f32 v9, v9, v12
    v_cvt_pk_bf16_f32 v8, v8, v9
    v_and_b32 v9, 0xffff0000, v8
    v_lshlrev_b32 v8, 16, v8
    v_mul_f32 v8, v8, v13
    v_mul_f32 v9, v9, v13
    v_cvt_pk_bf16_f32 v8, v8, v9
    global_store_short v14, v8, s[6:7]
    global_store_short_d16_hi v15, v8, s[6:7]
    global_store_short v14, v24, s[8:9]
    global_store_short_d16_hi v15, v24, s[8:9]
    v_add_u32 v14, 8192, v14
    v_add_u32 v15, 8192, v15
    v_lshlrev_b32 v8, 16, v25
    v_and_b32 v9, 0xffff0000, v25
    v_sub_f32 v8, v8, v12
    v_sub_f32 v9, v9, v12
    v_cvt_pk_bf16_f32 v8, v8, v9
    v_and_b32 v9, 0xffff0000, v8
    v_lshlrev_b32 v8, 16, v8
    v_mul_f32 v8, v8, v13
    v_mul_f32 v9, v9, v13
    v_cvt_pk_bf16_f32 v8, v8, v9
    global_store_short v14, v8, s[6:7]
    global_store_short_d16_hi v15, v8, s[6:7]
    global_store_short v14, v25, s[8:9]
    global_store_short_d16_hi v15, v25, s[8:9]
    v_add_u32 v14, 8192, v14
    v_add_u32 v15, 8192, v15
    v_lshlrev_b32 v8, 16, v26
    v_and_b32 v9, 0xffff0000, v26
    v_sub_f32 v8, v8, v12
    v_sub_f32 v9, v9, v12
    v_cvt_pk_bf16_f32 v8, v8, v9
    v_and_b32 v9, 0xffff0000, v8
    v_lshlrev_b32 v8, 16, v8
    v_mul_f32 v8, v8, v13
    v_mul_f32 v9, v9, v13
    v_cvt_pk_bf16_f32 v8, v8, v9
    global_store_short v14, v8, s[6:7]
    global_store_short_d16_hi v15, v8, s[6:7]
    global_store_short v14, v26, s[8:9]
    global_store_short_d16_hi v15, v26, s[8:9]
    v_add_u32 v14, 8192, v14
    v_add_u32 v15, 8192, v15
    v_lshlrev_b32 v8, 16, v27
    v_and_b32 v9, 0xffff0000, v27
    v_sub_f32 v8, v8, v12
    v_sub_f32 v9, v9, v12
    v_cvt_pk_bf16_f32 v8, v8, v9
    v_and_b32 v9, 0xffff0000, v8
    v_lshlrev_b32 v8, 16, v8
    v_mul_f32 v8, v8, v13
    v_mul_f32 v9, v9, v13
    v_cvt_pk_bf16_f32 v8, v8, v9
    global_store_short v14, v8, s[6:7]
    global_store_short_d16_hi v15, v8, s[6:7]
    global_store_short v14, v27, s[8:9]
    global_store_short_d16_hi v15, v27, s[8:9]
    v_add_u32 v14, 8192, v14
    v_add_u32 v15, 8192, v15
    v_lshlrev_b32 v8, 16, v28
    v_and_b32 v9, 0xffff0000, v28
    v_sub_f32 v8, v8, v12
    v_sub_f32 v9, v9, v12
    v_cvt_pk_bf16_f32 v8, v8, v9
    v_and_b32 v9, 0xffff0000, v8
    v_lshlrev_b32 v8, 16, v8
    v_mul_f32 v8, v8, v13
    v_mul_f32 v9, v9, v13
    v_cvt_pk_bf16_f32 v8, v8, v9
    global_store_short v14, v8, s[6:7]
    global_store_short_d16_hi v15, v8, s[6:7]
    global_store_short v14, v28, s[8:9]
    global_store_short_d16_hi v15, v28, s[8:9]
    v_add_u32 v14, 8192, v14
    v_add_u32 v15, 8192, v15
    v_lshlrev_b32 v8, 16, v29
    v_and_b32 v9, 0xffff0000, v29
    v_sub_f32 v8, v8, v12
    v_sub_f32 v9, v9, v12
    v_cvt_pk_bf16_f32 v8, v8, v9
    v_and_b32 v9, 0xffff0000, v8
    v_lshlrev_b32 v8, 16, v8
    v_mul_f32 v8, v8, v13
    v_mul_f32 v9, v9, v13
    v_cvt_pk_bf16_f32 v8, v8, v9
    global_store_short v14, v8, s[6:7]
    global_store_short_d16_hi v15, v8, s[6:7]
    global_store_short v14, v29, s[8:9]
    global_store_short_d16_hi v15, v29, s[8:9]
    v_add_u32 v14, 8192, v14
    v_add_u32 v15, 8192, v15
    v_lshlrev_b32 v8, 16, v30
    v_and_b32 v9, 0xffff0000, v30
    v_sub_f32 v8, v8, v12
    v_sub_f32 v9, v9, v12
    v_cvt_pk_bf16_f32 v8, v8, v9
    v_and_b32 v9, 0xffff0000, v8
    v_lshlrev_b32 v8, 16, v8
    v_mul_f32 v8, v8, v13
    v_mul_f32 v9, v9, v13
    v_cvt_pk_bf16_f32 v8, v8, v9
    global_store_short v14, v8, s[6:7]
    global_store_short_d16_hi v15, v8, s[6:7]
    global_store_short v14, v30, s[8:9]
    global_store_short_d16_hi v15, v30, s[8:9]
    v_add_u32 v14, 8192, v14
    v_add_u32 v15, 8192, v15
    v_lshlrev_b32 v8, 16, v31
    v_and_b32 v9, 0xffff0000, v31
    v_sub_f32 v8, v8, v12
    v_sub_f32 v9, v9, v12
    v_cvt_pk_bf16_f32 v8, v8, v9
    v_and_b32 v9, 0xffff0000, v8
    v_lshlrev_b32 v8, 16, v8
    v_mul_f32 v8, v8, v13
    v_mul_f32 v9, v9, v13
    v_cvt_pk_bf16_f32 v8, v8, v9
    global_store_short v14, v8, s[6:7]
    global_store_short_d16_hi v15, v8, s[6:7]
    global_store_short v14, v31, s[8:9]
    global_store_short_d16_hi v15, v31, s[8:9]
    v_add_u32 v14, 8192, v14
    v_add_u32 v15, 8192, v15
    v_lshlrev_b32 v8, 16, v32
    v_and_b32 v9, 0xffff0000, v32
    v_sub_f32 v8, v8, v12
    v_sub_f32 v9, v9, v12
    v_cvt_pk_bf16_f32 v8, v8, v9
    v_and_b32 v9, 0xffff0000, v8
    v_lshlrev_b32 v8, 16, v8
    v_mul_f32 v8, v8, v13
    v_mul_f32 v9, v9, v13
    v_cvt_pk_bf16_f32 v8, v8, v9
    global_store_short v14, v8, s[6:7]
    global_store_short_d16_hi v15, v8, s[6:7]
    global_store_short v14, v32, s[8:9]
    global_store_short_d16_hi v15, v32, s[8:9]
    v_add_u32 v14, 8192, v14
    v_add_u32 v15, 8192, v15
    v_lshlrev_b32 v8, 16, v33
    v_and_b32 v9, 0xffff0000, v33
    v_sub_f32 v8, v8, v12
    v_sub_f32 v9, v9, v12
    v_cvt_pk_bf16_f32 v8, v8, v9
    v_and_b32 v9, 0xffff0000, v8
    v_lshlrev_b32 v8, 16, v8
    v_mul_f32 v8, v8, v13
    v_mul_f32 v9, v9, v13
    v_cvt_pk_bf16_f32 v8, v8, v9
    global_store_short v14, v8, s[6:7]
    global_store_short_d16_hi v15, v8, s[6:7]
    global_store_short v14, v33, s[8:9]
    global_store_short_d16_hi v15, v33, s[8:9]
    v_add_u32 v14, 8192, v14
    v_add_u32 v15, 8192, v15
    v_lshlrev_b32 v8, 16, v34
    v_and_b32 v9, 0xffff0000, v34
    v_sub_f32 v8, v8, v12
    v_sub_f32 v9, v9, v12
    v_cvt_pk_bf16_f32 v8, v8, v9
    v_and_b32 v9, 0xffff0000, v8
    v_lshlrev_b32 v8, 16, v8
    v_mul_f32 v8, v8, v13
    v_mul_f32 v9, v9, v13
    v_cvt_pk_bf16_f32 v8, v8, v9
    global_store_short v14, v8, s[6:7]
    global_store_short_d16_hi v15, v8, s[6:7]
    global_store_short v14, v34, s[8:9]
    global_store_short_d16_hi v15, v34, s[8:9]
    v_add_u32 v14, 8192, v14
    v_add_u32 v15, 8192, v15
    v_lshlrev_b32 v8, 16, v35
    v_and_b32 v9, 0xffff0000, v35
    v_sub_f32 v8, v8, v12
    v_sub_f32 v9, v9, v12
    v_cvt_pk_bf16_f32 v8, v8, v9
    v_and_b32 v9, 0xffff0000, v8
    v_lshlrev_b32 v8, 16, v8
    v_mul_f32 v8, v8, v13
    v_mul_f32 v9, v9, v13
    v_cvt_pk_bf16_f32 v8, v8, v9
    global_store_short v14, v8, s[6:7]
    global_store_short_d16_hi v15, v8, s[6:7]
    global_store_short v14, v35, s[8:9]
    global_store_short_d16_hi v15, v35, s[8:9]
    v_add_u32 v14, 8192, v14
    v_add_u32 v15, 8192, v15
    v_lshlrev_b32 v8, 16, v36
    v_and_b32 v9, 0xffff0000, v36
    v_sub_f32 v8, v8, v12
    v_sub_f32 v9, v9, v12
    v_cvt_pk_bf16_f32 v8, v8, v9
    v_and_b32 v9, 0xffff0000, v8
    v_lshlrev_b32 v8, 16, v8
    v_mul_f32 v8, v8, v13
    v_mul_f32 v9, v9, v13
    v_cvt_pk_bf16_f32 v8, v8, v9
    global_store_short v14, v8, s[6:7]
    global_store_short_d16_hi v15, v8, s[6:7]
    global_store_short v14, v36, s[8:9]
    global_store_short_d16_hi v15, v36, s[8:9]
    v_add_u32 v14, 8192, v14
    v_add_u32 v15, 8192, v15
    v_lshlrev_b32 v8, 16, v37
    v_and_b32 v9, 0xffff0000, v37
    v_sub_f32 v8, v8, v12
    v_sub_f32 v9, v9, v12
    v_cvt_pk_bf16_f32 v8, v8, v9
    v_and_b32 v9, 0xffff0000, v8
    v_lshlrev_b32 v8, 16, v8
    v_mul_f32 v8, v8, v13
    v_mul_f32 v9, v9, v13
    v_cvt_pk_bf16_f32 v8, v8, v9
    global_store_short v14, v8, s[6:7]
    global_store_short_d16_hi v15, v8, s[6:7]
    global_store_short v14, v37, s[8:9]
    global_store_short_d16_hi v15, v37, s[8:9]
    v_add_u32 v14, 8192, v14
    v_add_u32 v15, 8192, v15
    v_lshlrev_b32 v8, 16, v38
    v_and_b32 v9, 0xffff0000, v38
    v_sub_f32 v8, v8, v12
    v_sub_f32 v9, v9, v12
    v_cvt_pk_bf16_f32 v8, v8, v9
    v_and_b32 v9, 0xffff0000, v8
    v_lshlrev_b32 v8, 16, v8
    v_mul_f32 v8, v8, v13
    v_mul_f32 v9, v9, v13
    v_cvt_pk_bf16_f32 v8, v8, v9
    global_store_short v14, v8, s[6:7]
    global_store_short_d16_hi v15, v8, s[6:7]
    global_store_short v14, v38, s[8:9]
    global_store_short_d16_hi v15, v38, s[8:9]
    v_add_u32 v14, 8192, v14
    v_add_u32 v15, 8192, v15
    v_lshlrev_b32 v8, 16, v39
    v_and_b32 v9, 0xffff0000, v39
    v_sub_f32 v8, v8, v12
    v_sub_f32 v9, v9, v12
    v_cvt_pk_bf16_f32 v8, v8, v9
    v_and_b32 v9, 0xffff0000, v8
    v_lshlrev_b32 v8, 16, v8
    v_mul_f32 v8, v8, v13
    v_mul_f32 v9, v9, v13
    v_cvt_pk_bf16_f32 v8, v8, v9
    global_store_short v14, v8, s[6:7]
    global_store_short_d16_hi v15, v8, s[6:7]
    global_store_short v14, v39, s[8:9]
    global_store_short_d16_hi v15, v39, s[8:9]
    v_add_u32 v14, 8192, v14
    v_add_u32 v15, 8192, v15
    v_lshlrev_b32 v8, 16, v40
    v_and_b32 v9, 0xffff0000, v40
    v_sub_f32 v8, v8, v12
    v_sub_f32 v9, v9, v12
    v_cvt_pk_bf16_f32 v8, v8, v9
    v_and_b32 v9, 0xffff0000, v8
    v_lshlrev_b32 v8, 16, v8
    v_mul_f32 v8, v8, v13
    v_mul_f32 v9, v9, v13
    v_cvt_pk_bf16_f32 v8, v8, v9
    global_store_short v14, v8, s[6:7]
    global_store_short_d16_hi v15, v8, s[6:7]
    global_store_short v14, v40, s[8:9]
    global_store_short_d16_hi v15, v40, s[8:9]
    v_add_u32 v14, 8192, v14
    v_add_u32 v15, 8192, v15
    v_lshlrev_b32 v8, 16, v41
    v_and_b32 v9, 0xffff0000, v41
    v_sub_f32 v8, v8, v12
    v_sub_f32 v9, v9, v12
    v_cvt_pk_bf16_f32 v8, v8, v9
    v_and_b32 v9, 0xffff0000, v8
    v_lshlrev_b32 v8, 16, v8
    v_mul_f32 v8, v8, v13
    v_mul_f32 v9, v9, v13
    v_cvt_pk_bf16_f32 v8, v8, v9
    global_store_short v14, v8, s[6:7]
    global_store_short_d16_hi v15, v8, s[6:7]
    global_store_short v14, v41, s[8:9]
    global_store_short_d16_hi v15, v41, s[8:9]
    v_add_u32 v14, 8192, v14
    v_add_u32 v15, 8192, v15
    v_lshlrev_b32 v8, 16, v42
    v_and_b32 v9, 0xffff0000, v42
    v_sub_f32 v8, v8, v12
    v_sub_f32 v9, v9, v12
    v_cvt_pk_bf16_f32 v8, v8, v9
    v_and_b32 v9, 0xffff0000, v8
    v_lshlrev_b32 v8, 16, v8
    v_mul_f32 v8, v8, v13
    v_mul_f32 v9, v9, v13
    v_cvt_pk_bf16_f32 v8, v8, v9
    global_store_short v14, v8, s[6:7]
    global_store_short_d16_hi v15, v8, s[6:7]
    global_store_short v14, v42, s[8:9]
    global_store_short_d16_hi v15, v42, s[8:9]
    v_add_u32 v14, 8192, v14
    v_add_u32 v15, 8192, v15
    v_lshlrev_b32 v8, 16, v43
    v_and_b32 v9, 0xffff0000, v43
    v_sub_f32 v8, v8, v12
    v_sub_f32 v9, v9, v12
    v_cvt_pk_bf16_f32 v8, v8, v9
    v_and_b32 v9, 0xffff0000, v8
    v_lshlrev_b32 v8, 16, v8
    v_mul_f32 v8, v8, v13
    v_mul_f32 v9, v9, v13
    v_cvt_pk_bf16_f32 v8, v8, v9
    global_store_short v14, v8, s[6:7]
    global_store_short_d16_hi v15, v8, s[6:7]
    global_store_short v14, v43, s[8:9]
    global_store_short_d16_hi v15, v43, s[8:9]
    v_add_u32 v14, 8192, v14
    v_add_u32 v15, 8192, v15
    v_lshlrev_b32 v8, 16, v44
    v_and_b32 v9, 0xffff0000, v44
    v_sub_f32 v8, v8, v12
    v_sub_f32 v9, v9, v12
    v_cvt_pk_bf16_f32 v8, v8, v9
    v_and_b32 v9, 0xffff0000, v8
    v_lshlrev_b32 v8, 16, v8
    v_mul_f32 v8, v8, v13
    v_mul_f32 v9, v9, v13
    v_cvt_pk_bf16_f32 v8, v8, v9
    global_store_short v14, v8, s[6:7]
    global_store_short_d16_hi v15, v8, s[6:7]
    global_store_short v14, v44, s[8:9]
    global_store_short_d16_hi v15, v44, s[8:9]
    v_add_u32 v14, 8192, v14
    v_add_u32 v15, 8192, v15
    v_lshlrev_b32 v8, 16, v45
    v_and_b32 v9, 0xffff0000, v45
    v_sub_f32 v8, v8, v12
    v_sub_f32 v9, v9, v12
    v_cvt_pk_bf16_f32 v8, v8, v9
    v_and_b32 v9, 0xffff0000, v8
    v_lshlrev_b32 v8, 16, v8
    v_mul_f32 v8, v8, v13
    v_mul_f32 v9, v9, v13
    v_cvt_pk_bf16_f32 v8, v8, v9
    global_store_short v14, v8, s[6:7]
    global_store_short_d16_hi v15, v8, s[6:7]
    global_store_short v14, v45, s[8:9]
    global_store_short_d16_hi v15, v45, s[8:9]
    v_add_u32 v14, 8192, v14
    v_add_u32 v15, 8192, v15
    v_lshlrev_b32 v8, 16, v46
    v_and_b32 v9, 0xffff0000, v46
    v_sub_f32 v8, v8, v12
    v_sub_f32 v9, v9, v12
    v_cvt_pk_bf16_f32 v8, v8, v9
    v_and_b32 v9, 0xffff0000, v8
    v_lshlrev_b32 v8, 16, v8
    v_mul_f32 v8, v8, v13
    v_mul_f32 v9, v9, v13
    v_cvt_pk_bf16_f32 v8, v8, v9
    global_store_short v14, v8, s[6:7]
    global_store_short_d16_hi v15, v8, s[6:7]
    global_store_short v14, v46, s[8:9]
    global_store_short_d16_hi v15, v46, s[8:9]
    v_add_u32 v14, 8192, v14
    v_add_u32 v15, 8192, v15
    v_lshlrev_b32 v8, 16, v47
    v_and_b32 v9, 0xffff0000, v47
    v_sub_f32 v8, v8, v12
    v_sub_f32 v9, v9, v12
    v_cvt_pk_bf16_f32 v8, v8, v9
    v_and_b32 v9, 0xffff0000, v8
    v_lshlrev_b32 v8, 16, v8
    v_mul_f32 v8, v8, v13
    v_mul_f32 v9, v9, v13
    v_cvt_pk_bf16_f32 v8, v8, v9
    global_store_short v14, v8, s[6:7]
    global_store_short_d16_hi v15, v8, s[6:7]
    global_store_short v14, v47, s[8:9]
    global_store_short_d16_hi v15, v47, s[8:9]
    v_add_u32 v14, 8192, v14
    v_add_u32 v15, 8192, v15
    v_lshlrev_b32 v8, 16, v48
    v_and_b32 v9, 0xffff0000, v48
    v_sub_f32 v8, v8, v12
    v_sub_f32 v9, v9, v12
    v_cvt_pk_bf16_f32 v8, v8, v9
    v_and_b32 v9, 0xffff0000, v8
    v_lshlrev_b32 v8, 16, v8
    v_mul_f32 v8, v8, v13
    v_mul_f32 v9, v9, v13
    v_cvt_pk_bf16_f32 v8, v8, v9
    global_store_short v14, v8, s[6:7]
    global_store_short_d16_hi v15, v8, s[6:7]
    global_store_short v14, v48, s[8:9]
    global_store_short_d16_hi v15, v48, s[8:9]
    v_add_u32 v14, 8192, v14
    v_add_u32 v15, 8192, v15
    v_lshlrev_b32 v8, 16, v49
    v_and_b32 v9, 0xffff0000, v49
    v_sub_f32 v8, v8, v12
    v_sub_f32 v9, v9, v12
    v_cvt_pk_bf16_f32 v8, v8, v9
    v_and_b32 v9, 0xffff0000, v8
    v_lshlrev_b32 v8, 16, v8
    v_mul_f32 v8, v8, v13
    v_mul_f32 v9, v9, v13
    v_cvt_pk_bf16_f32 v8, v8, v9
    global_store_short v14, v8, s[6:7]
    global_store_short_d16_hi v15, v8, s[6:7]
    global_store_short v14, v49, s[8:9]
    global_store_short_d16_hi v15, v49, s[8:9]
    v_add_u32 v14, 8192, v14
    v_add_u32 v15, 8192, v15
    v_lshlrev_b32 v8, 16, v50
    v_and_b32 v9, 0xffff0000, v50
    v_sub_f32 v8, v8, v12
    v_sub_f32 v9, v9, v12
    v_cvt_pk_bf16_f32 v8, v8, v9
    v_and_b32 v9, 0xffff0000, v8
    v_lshlrev_b32 v8, 16, v8
    v_mul_f32 v8, v8, v13
    v_mul_f32 v9, v9, v13
    v_cvt_pk_bf16_f32 v8, v8, v9
    global_store_short v14, v8, s[6:7]
    global_store_short_d16_hi v15, v8, s[6:7]
    global_store_short v14, v50, s[8:9]
    global_store_short_d16_hi v15, v50, s[8:9]
    v_add_u32 v14, 8192, v14
    v_add_u32 v15, 8192, v15
    v_lshlrev_b32 v8, 16, v51
    v_and_b32 v9, 0xffff0000, v51
    v_sub_f32 v8, v8, v12
    v_sub_f32 v9, v9, v12
    v_cvt_pk_bf16_f32 v8, v8, v9
    v_and_b32 v9, 0xffff0000, v8
    v_lshlrev_b32 v8, 16, v8
    v_mul_f32 v8, v8, v13
    v_mul_f32 v9, v9, v13
    v_cvt_pk_bf16_f32 v8, v8, v9
    global_store_short v14, v8, s[6:7]
    global_store_short_d16_hi v15, v8, s[6:7]
    global_store_short v14, v51, s[8:9]
    global_store_short_d16_hi v15, v51, s[8:9]
    v_add_u32 v14, 8192, v14
    v_add_u32 v15, 8192, v15
    v_lshlrev_b32 v8, 16, v52
    v_and_b32 v9, 0xffff0000, v52
    v_sub_f32 v8, v8, v12
    v_sub_f32 v9, v9, v12
    v_cvt_pk_bf16_f32 v8, v8, v9
    v_and_b32 v9, 0xffff0000, v8
    v_lshlrev_b32 v8, 16, v8
    v_mul_f32 v8, v8, v13
    v_mul_f32 v9, v9, v13
    v_cvt_pk_bf16_f32 v8, v8, v9
    global_store_short v14, v8, s[6:7]
    global_store_short_d16_hi v15, v8, s[6:7]
    global_store_short v14, v52, s[8:9]
    global_store_short_d16_hi v15, v52, s[8:9]
    v_add_u32 v14, 8192, v14
    v_add_u32 v15, 8192, v15
    v_lshlrev_b32 v8, 16, v53
    v_and_b32 v9, 0xffff0000, v53
    v_sub_f32 v8, v8, v12
    v_sub_f32 v9, v9, v12
    v_cvt_pk_bf16_f32 v8, v8, v9
    v_and_b32 v9, 0xffff0000, v8
    v_lshlrev_b32 v8, 16, v8
    v_mul_f32 v8, v8, v13
    v_mul_f32 v9, v9, v13
    v_cvt_pk_bf16_f32 v8, v8, v9
    global_store_short v14, v8, s[6:7]
    global_store_short_d16_hi v15, v8, s[6:7]
    global_store_short v14, v53, s[8:9]
    global_store_short_d16_hi v15, v53, s[8:9]
    v_add_u32 v14, 8192, v14
    v_add_u32 v15, 8192, v15
    v_lshlrev_b32 v8, 16, v54
    v_and_b32 v9, 0xffff0000, v54
    v_sub_f32 v8, v8, v12
    v_sub_f32 v9, v9, v12
    v_cvt_pk_bf16_f32 v8, v8, v9
    v_and_b32 v9, 0xffff0000, v8
    v_lshlrev_b32 v8, 16, v8
    v_mul_f32 v8, v8, v13
    v_mul_f32 v9, v9, v13
    v_cvt_pk_bf16_f32 v8, v8, v9
    global_store_short v14, v8, s[6:7]
    global_store_short_d16_hi v15, v8, s[6:7]
    global_store_short v14, v54, s[8:9]
    global_store_short_d16_hi v15, v54, s[8:9]
    v_add_u32 v14, 8192, v14
    v_add_u32 v15, 8192, v15
    v_lshlrev_b32 v8, 16, v55
    v_and_b32 v9, 0xffff0000, v55
    v_sub_f32 v8, v8, v12
    v_sub_f32 v9, v9, v12
    v_cvt_pk_bf16_f32 v8, v8, v9
    v_and_b32 v9, 0xffff0000, v8
    v_lshlrev_b32 v8, 16, v8
    v_mul_f32 v8, v8, v13
    v_mul_f32 v9, v9, v13
    v_cvt_pk_bf16_f32 v8, v8, v9
    global_store_short v14, v8, s[6:7]
    global_store_short_d16_hi v15, v8, s[6:7]
    global_store_short v14, v55, s[8:9]
    global_store_short_d16_hi v15, v55, s[8:9]
    v_add_u32 v14, 8192, v14
    v_add_u32 v15, 8192, v15
    v_lshlrev_b32 v8, 16, v56
    v_and_b32 v9, 0xffff0000, v56
    v_sub_f32 v8, v8, v12
    v_sub_f32 v9, v9, v12
    v_cvt_pk_bf16_f32 v8, v8, v9
    v_and_b32 v9, 0xffff0000, v8
    v_lshlrev_b32 v8, 16, v8
    v_mul_f32 v8, v8, v13
    v_mul_f32 v9, v9, v13
    v_cvt_pk_bf16_f32 v8, v8, v9
    global_store_short v14, v8, s[6:7]
    global_store_short_d16_hi v15, v8, s[6:7]
    global_store_short v14, v56, s[8:9]
    global_store_short_d16_hi v15, v56, s[8:9]
    v_add_u32 v14, 8192, v14
    v_add_u32 v15, 8192, v15
    v_lshlrev_b32 v8, 16, v57
    v_and_b32 v9, 0xffff0000, v57
    v_sub_f32 v8, v8, v12
    v_sub_f32 v9, v9, v12
    v_cvt_pk_bf16_f32 v8, v8, v9
    v_and_b32 v9, 0xffff0000, v8
    v_lshlrev_b32 v8, 16, v8
    v_mul_f32 v8, v8, v13
    v_mul_f32 v9, v9, v13
    v_cvt_pk_bf16_f32 v8, v8, v9
    global_store_short v14, v8, s[6:7]
    global_store_short_d16_hi v15, v8, s[6:7]
    global_store_short v14, v57, s[8:9]
    global_store_short_d16_hi v15, v57, s[8:9]
    v_add_u32 v14, 8192, v14
    v_add_u32 v15, 8192, v15
    v_lshlrev_b32 v8, 16, v58
    v_and_b32 v9, 0xffff0000, v58
    v_sub_f32 v8, v8, v12
    v_sub_f32 v9, v9, v12
    v_cvt_pk_bf16_f32 v8, v8, v9
    v_and_b32 v9, 0xffff0000, v8
    v_lshlrev_b32 v8, 16, v8
    v_mul_f32 v8, v8, v13
    v_mul_f32 v9, v9, v13
    v_cvt_pk_bf16_f32 v8, v8, v9
    global_store_short v14, v8, s[6:7]
    global_store_short_d16_hi v15, v8, s[6:7]
    global_store_short v14, v58, s[8:9]
    global_store_short_d16_hi v15, v58, s[8:9]
    v_add_u32 v14, 8192, v14
    v_add_u32 v15, 8192, v15
    v_lshlrev_b32 v8, 16, v59
    v_and_b32 v9, 0xffff0000, v59
    v_sub_f32 v8, v8, v12
    v_sub_f32 v9, v9, v12
    v_cvt_pk_bf16_f32 v8, v8, v9
    v_and_b32 v9, 0xffff0000, v8
    v_lshlrev_b32 v8, 16, v8
    v_mul_f32 v8, v8, v13
    v_mul_f32 v9, v9, v13
    v_cvt_pk_bf16_f32 v8, v8, v9
    global_store_short v14, v8, s[6:7]
    global_store_short_d16_hi v15, v8, s[6:7]
    global_store_short v14, v59, s[8:9]
    global_store_short_d16_hi v15, v59, s[8:9]
    v_add_u32 v14, 8192, v14
    v_add_u32 v15, 8192, v15
    v_lshlrev_b32 v8, 16, v60
    v_and_b32 v9, 0xffff0000, v60
    v_sub_f32 v8, v8, v12
    v_sub_f32 v9, v9, v12
    v_cvt_pk_bf16_f32 v8, v8, v9
    v_and_b32 v9, 0xffff0000, v8
    v_lshlrev_b32 v8, 16, v8
    v_mul_f32 v8, v8, v13
    v_mul_f32 v9, v9, v13
    v_cvt_pk_bf16_f32 v8, v8, v9
    global_store_short v14, v8, s[6:7]
    global_store_short_d16_hi v15, v8, s[6:7]
    global_store_short v14, v60, s[8:9]
    global_store_short_d16_hi v15, v60, s[8:9]
    v_add_u32 v14, 8192, v14
    v_add_u32 v15, 8192, v15
    v_lshlrev_b32 v8, 16, v61
    v_and_b32 v9, 0xffff0000, v61
    v_sub_f32 v8, v8, v12
    v_sub_f32 v9, v9, v12
    v_cvt_pk_bf16_f32 v8, v8, v9
    v_and_b32 v9, 0xffff0000, v8
    v_lshlrev_b32 v8, 16, v8
    v_mul_f32 v8, v8, v13
    v_mul_f32 v9, v9, v13
    v_cvt_pk_bf16_f32 v8, v8, v9
    global_store_short v14, v8, s[6:7]
    global_store_short_d16_hi v15, v8, s[6:7]
    global_store_short v14, v61, s[8:9]
    global_store_short_d16_hi v15, v61, s[8:9]
    v_add_u32 v14, 8192, v14
    v_add_u32 v15, 8192, v15
    v_lshlrev_b32 v8, 16, v62
    v_and_b32 v9, 0xffff0000, v62
    v_sub_f32 v8, v8, v12
    v_sub_f32 v9, v9, v12
    v_cvt_pk_bf16_f32 v8, v8, v9
    v_and_b32 v9, 0xffff0000, v8
    v_lshlrev_b32 v8, 16, v8
    v_mul_f32 v8, v8, v13
    v_mul_f32 v9, v9, v13
    v_cvt_pk_bf16_f32 v8, v8, v9
    global_store_short v14, v8, s[6:7]
    global_store_short_d16_hi v15, v8, s[6:7]
    global_store_short v14, v62, s[8:9]
    global_store_short_d16_hi v15, v62, s[8:9]
    v_add_u32 v14, 8192, v14
    v_add_u32 v15, 8192, v15
    v_lshlrev_b32 v8, 16, v63
    v_and_b32 v9, 0xffff0000, v63
    v_sub_f32 v8, v8, v12
    v_sub_f32 v9, v9, v12
    v_cvt_pk_bf16_f32 v8, v8, v9
    v_and_b32 v9, 0xffff0000, v8
    v_lshlrev_b32 v8, 16, v8
    v_mul_f32 v8, v8, v13
    v_mul_f32 v9, v9, v13
    v_cvt_pk_bf16_f32 v8, v8, v9
    global_store_short v14, v8, s[6:7]
    global_store_short_d16_hi v15, v8, s[6:7]
    global_store_short v14, v63, s[8:9]
    global_store_short_d16_hi v15, v63, s[8:9]
    v_add_u32 v14, 8192, v14
    v_add_u32 v15, 8192, v15
    v_lshlrev_b32 v8, 16, v64
    v_and_b32 v9, 0xffff0000, v64
    v_sub_f32 v8, v8, v12
    v_sub_f32 v9, v9, v12
    v_cvt_pk_bf16_f32 v8, v8, v9
    v_and_b32 v9, 0xffff0000, v8
    v_lshlrev_b32 v8, 16, v8
    v_mul_f32 v8, v8, v13
    v_mul_f32 v9, v9, v13
    v_cvt_pk_bf16_f32 v8, v8, v9
    global_store_short v14, v8, s[6:7]
    global_store_short_d16_hi v15, v8, s[6:7]
    global_store_short v14, v64, s[8:9]
    global_store_short_d16_hi v15, v64, s[8:9]
    v_add_u32 v14, 8192, v14
    v_add_u32 v15, 8192, v15
    v_lshlrev_b32 v8, 16, v65
    v_and_b32 v9, 0xffff0000, v65
    v_sub_f32 v8, v8, v12
    v_sub_f32 v9, v9, v12
    v_cvt_pk_bf16_f32 v8, v8, v9
    v_and_b32 v9, 0xffff0000, v8
    v_lshlrev_b32 v8, 16, v8
    v_mul_f32 v8, v8, v13
    v_mul_f32 v9, v9, v13
    v_cvt_pk_bf16_f32 v8, v8, v9
    global_store_short v14, v8, s[6:7]
    global_store_short_d16_hi v15, v8, s[6:7]
    global_store_short v14, v65, s[8:9]
    global_store_short_d16_hi v15, v65, s[8:9]
    v_add_u32 v14, 8192, v14
    v_add_u32 v15, 8192, v15
    v_lshlrev_b32 v8, 16, v66
    v_and_b32 v9, 0xffff0000, v66
    v_sub_f32 v8, v8, v12
    v_sub_f32 v9, v9, v12
    v_cvt_pk_bf16_f32 v8, v8, v9
    v_and_b32 v9, 0xffff0000, v8
    v_lshlrev_b32 v8, 16, v8
    v_mul_f32 v8, v8, v13
    v_mul_f32 v9, v9, v13
    v_cvt_pk_bf16_f32 v8, v8, v9
    global_store_short v14, v8, s[6:7]
    global_store_short_d16_hi v15, v8, s[6:7]
    global_store_short v14, v66, s[8:9]
    global_store_short_d16_hi v15, v66, s[8:9]
    v_add_u32 v14, 8192, v14
    v_add_u32 v15, 8192, v15
    v_lshlrev_b32 v8, 16, v67
    v_and_b32 v9, 0xffff0000, v67
    v_sub_f32 v8, v8, v12
    v_sub_f32 v9, v9, v12
    v_cvt_pk_bf16_f32 v8, v8, v9
    v_and_b32 v9, 0xffff0000, v8
    v_lshlrev_b32 v8, 16, v8
    v_mul_f32 v8, v8, v13
    v_mul_f32 v9, v9, v13
    v_cvt_pk_bf16_f32 v8, v8, v9
    global_store_short v14, v8, s[6:7]
    global_store_short_d16_hi v15, v8, s[6:7]
    global_store_short v14, v67, s[8:9]
    global_store_short_d16_hi v15, v67, s[8:9]
    v_add_u32 v14, 8192, v14
    v_add_u32 v15, 8192, v15
    v_lshlrev_b32 v8, 16, v68
    v_and_b32 v9, 0xffff0000, v68
    v_sub_f32 v8, v8, v12
    v_sub_f32 v9, v9, v12
    v_cvt_pk_bf16_f32 v8, v8, v9
    v_and_b32 v9, 0xffff0000, v8
    v_lshlrev_b32 v8, 16, v8
    v_mul_f32 v8, v8, v13
    v_mul_f32 v9, v9, v13
    v_cvt_pk_bf16_f32 v8, v8, v9
    global_store_short v14, v8, s[6:7]
    global_store_short_d16_hi v15, v8, s[6:7]
    global_store_short v14, v68, s[8:9]
    global_store_short_d16_hi v15, v68, s[8:9]
    v_add_u32 v14, 8192, v14
    v_add_u32 v15, 8192, v15
    v_lshlrev_b32 v8, 16, v69
    v_and_b32 v9, 0xffff0000, v69
    v_sub_f32 v8, v8, v12
    v_sub_f32 v9, v9, v12
    v_cvt_pk_bf16_f32 v8, v8, v9
    v_and_b32 v9, 0xffff0000, v8
    v_lshlrev_b32 v8, 16, v8
    v_mul_f32 v8, v8, v13
    v_mul_f32 v9, v9, v13
    v_cvt_pk_bf16_f32 v8, v8, v9
    global_store_short v14, v8, s[6:7]
    global_store_short_d16_hi v15, v8, s[6:7]
    global_store_short v14, v69, s[8:9]
    global_store_short_d16_hi v15, v69, s[8:9]
    v_add_u32 v14, 8192, v14
    v_add_u32 v15, 8192, v15
    v_lshlrev_b32 v8, 16, v70
    v_and_b32 v9, 0xffff0000, v70
    v_sub_f32 v8, v8, v12
    v_sub_f32 v9, v9, v12
    v_cvt_pk_bf16_f32 v8, v8, v9
    v_and_b32 v9, 0xffff0000, v8
    v_lshlrev_b32 v8, 16, v8
    v_mul_f32 v8, v8, v13
    v_mul_f32 v9, v9, v13
    v_cvt_pk_bf16_f32 v8, v8, v9
    global_store_short v14, v8, s[6:7]
    global_store_short_d16_hi v15, v8, s[6:7]
    global_store_short v14, v70, s[8:9]
    global_store_short_d16_hi v15, v70, s[8:9]
    v_add_u32 v14, 8192, v14
    v_add_u32 v15, 8192, v15
    v_lshlrev_b32 v8, 16, v71
    v_and_b32 v9, 0xffff0000, v71
    v_sub_f32 v8, v8, v12
    v_sub_f32 v9, v9, v12
    v_cvt_pk_bf16_f32 v8, v8, v9
    v_and_b32 v9, 0xffff0000, v8
    v_lshlrev_b32 v8, 16, v8
    v_mul_f32 v8, v8, v13
    v_mul_f32 v9, v9, v13
    v_cvt_pk_bf16_f32 v8, v8, v9
    global_store_short v14, v8, s[6:7]
    global_store_short_d16_hi v15, v8, s[6:7]
    global_store_short v14, v71, s[8:9]
    global_store_short_d16_hi v15, v71, s[8:9]
    v_add_u32 v14, 8192, v14
    v_add_u32 v15, 8192, v15
    v_lshlrev_b32 v8, 16, v72
    v_and_b32 v9, 0xffff0000, v72
    v_sub_f32 v8, v8, v12
    v_sub_f32 v9, v9, v12
    v_cvt_pk_bf16_f32 v8, v8, v9
    v_and_b32 v9, 0xffff0000, v8
    v_lshlrev_b32 v8, 16, v8
    v_mul_f32 v8, v8, v13
    v_mul_f32 v9, v9, v13
    v_cvt_pk_bf16_f32 v8, v8, v9
    global_store_short v14, v8, s[6:7]
    global_store_short_d16_hi v15, v8, s[6:7]
    global_store_short v14, v72, s[8:9]
    global_store_short_d16_hi v15, v72, s[8:9]
    v_add_u32 v14, 8192, v14
    v_add_u32 v15, 8192, v15
    v_lshlrev_b32 v8, 16, v73
    v_and_b32 v9, 0xffff0000, v73
    v_sub_f32 v8, v8, v12
    v_sub_f32 v9, v9, v12
    v_cvt_pk_bf16_f32 v8, v8, v9
    v_and_b32 v9, 0xffff0000, v8
    v_lshlrev_b32 v8, 16, v8
    v_mul_f32 v8, v8, v13
    v_mul_f32 v9, v9, v13
    v_cvt_pk_bf16_f32 v8, v8, v9
    global_store_short v14, v8, s[6:7]
    global_store_short_d16_hi v15, v8, s[6:7]
    global_store_short v14, v73, s[8:9]
    global_store_short_d16_hi v15, v73, s[8:9]
    v_add_u32 v14, 8192, v14
    v_add_u32 v15, 8192, v15
    v_lshlrev_b32 v8, 16, v74
    v_and_b32 v9, 0xffff0000, v74
    v_sub_f32 v8, v8, v12
    v_sub_f32 v9, v9, v12
    v_cvt_pk_bf16_f32 v8, v8, v9
    v_and_b32 v9, 0xffff0000, v8
    v_lshlrev_b32 v8, 16, v8
    v_mul_f32 v8, v8, v13
    v_mul_f32 v9, v9, v13
    v_cvt_pk_bf16_f32 v8, v8, v9
    global_store_short v14, v8, s[6:7]
    global_store_short_d16_hi v15, v8, s[6:7]
    global_store_short v14, v74, s[8:9]
    global_store_short_d16_hi v15, v74, s[8:9]
    v_add_u32 v14, 8192, v14
    v_add_u32 v15, 8192, v15
    v_lshlrev_b32 v8, 16, v75
    v_and_b32 v9, 0xffff0000, v75
    v_sub_f32 v8, v8, v12
    v_sub_f32 v9, v9, v12
    v_cvt_pk_bf16_f32 v8, v8, v9
    v_and_b32 v9, 0xffff0000, v8
    v_lshlrev_b32 v8, 16, v8
    v_mul_f32 v8, v8, v13
    v_mul_f32 v9, v9, v13
    v_cvt_pk_bf16_f32 v8, v8, v9
    global_store_short v14, v8, s[6:7]
    global_store_short_d16_hi v15, v8, s[6:7]
    global_store_short v14, v75, s[8:9]
    global_store_short_d16_hi v15, v75, s[8:9]
    v_add_u32 v14, 8192, v14
    v_add_u32 v15, 8192, v15
    v_lshlrev_b32 v8, 16, v76
    v_and_b32 v9, 0xffff0000, v76
    v_sub_f32 v8, v8, v12
    v_sub_f32 v9, v9, v12
    v_cvt_pk_bf16_f32 v8, v8, v9
    v_and_b32 v9, 0xffff0000, v8
    v_lshlrev_b32 v8, 16, v8
    v_mul_f32 v8, v8, v13
    v_mul_f32 v9, v9, v13
    v_cvt_pk_bf16_f32 v8, v8, v9
    global_store_short v14, v8, s[6:7]
    global_store_short_d16_hi v15, v8, s[6:7]
    global_store_short v14, v76, s[8:9]
    global_store_short_d16_hi v15, v76, s[8:9]
    v_add_u32 v14, 8192, v14
    v_add_u32 v15, 8192, v15
    v_lshlrev_b32 v8, 16, v77
    v_and_b32 v9, 0xffff0000, v77
    v_sub_f32 v8, v8, v12
    v_sub_f32 v9, v9, v12
    v_cvt_pk_bf16_f32 v8, v8, v9
    v_and_b32 v9, 0xffff0000, v8
    v_lshlrev_b32 v8, 16, v8
    v_mul_f32 v8, v8, v13
    v_mul_f32 v9, v9, v13
    v_cvt_pk_bf16_f32 v8, v8, v9
    global_store_short v14, v8, s[6:7]
    global_store_short_d16_hi v15, v8, s[6:7]
    global_store_short v14, v77, s[8:9]
    global_store_short_d16_hi v15, v77, s[8:9]
    v_add_u32 v14, 8192, v14
    v_add_u32 v15, 8192, v15
    v_lshlrev_b32 v8, 16, v78
    v_and_b32 v9, 0xffff0000, v78
    v_sub_f32 v8, v8, v12
    v_sub_f32 v9, v9, v12
    v_cvt_pk_bf16_f32 v8, v8, v9
    v_and_b32 v9, 0xffff0000, v8
    v_lshlrev_b32 v8, 16, v8
    v_mul_f32 v8, v8, v13
    v_mul_f32 v9, v9, v13
    v_cvt_pk_bf16_f32 v8, v8, v9
    global_store_short v14, v8, s[6:7]
    global_store_short_d16_hi v15, v8, s[6:7]
    global_store_short v14, v78, s[8:9]
    global_store_short_d16_hi v15, v78, s[8:9]
    v_add_u32 v14, 8192, v14
    v_add_u32 v15, 8192, v15
    v_lshlrev_b32 v8, 16, v79
    v_and_b32 v9, 0xffff0000, v79
    v_sub_f32 v8, v8, v12
    v_sub_f32 v9, v9, v12
    v_cvt_pk_bf16_f32 v8, v8, v9
    v_and_b32 v9, 0xffff0000, v8
    v_lshlrev_b32 v8, 16, v8
    v_mul_f32 v8, v8, v13
    v_mul_f32 v9, v9, v13
    v_cvt_pk_bf16_f32 v8, v8, v9
    global_store_short v14, v8, s[6:7]
    global_store_short_d16_hi v15, v8, s[6:7]
    global_store_short v14, v79, s[8:9]
    global_store_short_d16_hi v15, v79, s[8:9]
    v_add_u32 v14, 8192, v14
    v_add_u32 v15, 8192, v15
    v_lshlrev_b32 v8, 16, v80
    v_and_b32 v9, 0xffff0000, v80
    v_sub_f32 v8, v8, v12
    v_sub_f32 v9, v9, v12
    v_cvt_pk_bf16_f32 v8, v8, v9
    v_and_b32 v9, 0xffff0000, v8
    v_lshlrev_b32 v8, 16, v8
    v_mul_f32 v8, v8, v13
    v_mul_f32 v9, v9, v13
    v_cvt_pk_bf16_f32 v8, v8, v9
    global_store_short v14, v8, s[6:7]
    global_store_short_d16_hi v15, v8, s[6:7]
    global_store_short v14, v80, s[8:9]
    global_store_short_d16_hi v15, v80, s[8:9]
    v_add_u32 v14, 8192, v14
    v_add_u32 v15, 8192, v15
    v_lshlrev_b32 v8, 16, v81
    v_and_b32 v9, 0xffff0000, v81
    v_sub_f32 v8, v8, v12
    v_sub_f32 v9, v9, v12
    v_cvt_pk_bf16_f32 v8, v8, v9
    v_and_b32 v9, 0xffff0000, v8
    v_lshlrev_b32 v8, 16, v8
    v_mul_f32 v8, v8, v13
    v_mul_f32 v9, v9, v13
    v_cvt_pk_bf16_f32 v8, v8, v9
    global_store_short v14, v8, s[6:7]
    global_store_short_d16_hi v15, v8, s[6:7]
    global_store_short v14, v81, s[8:9]
    global_store_short_d16_hi v15, v81, s[8:9]
    v_add_u32 v14, 8192, v14
    v_add_u32 v15, 8192, v15
    v_lshlrev_b32 v8, 16, v82
    v_and_b32 v9, 0xffff0000, v82
    v_sub_f32 v8, v8, v12
    v_sub_f32 v9, v9, v12
    v_cvt_pk_bf16_f32 v8, v8, v9
    v_and_b32 v9, 0xffff0000, v8
    v_lshlrev_b32 v8, 16, v8
    v_mul_f32 v8, v8, v13
    v_mul_f32 v9, v9, v13
    v_cvt_pk_bf16_f32 v8, v8, v9
    global_store_short v14, v8, s[6:7]
    global_store_short_d16_hi v15, v8, s[6:7]
    global_store_short v14, v82, s[8:9]
    global_store_short_d16_hi v15, v82, s[8:9]
    v_add_u32 v14, 8192, v14
    v_add_u32 v15, 8192, v15
    v_lshlrev_b32 v8, 16, v83
    v_and_b32 v9, 0xffff0000, v83
    v_sub_f32 v8, v8, v12
    v_sub_f32 v9, v9, v12
    v_cvt_pk_bf16_f32 v8, v8, v9
    v_and_b32 v9, 0xffff0000, v8
    v_lshlrev_b32 v8, 16, v8
    v_mul_f32 v8, v8, v13
    v_mul_f32 v9, v9, v13
    v_cvt_pk_bf16_f32 v8, v8, v9
    global_store_short v14, v8, s[6:7]
    global_store_short_d16_hi v15, v8, s[6:7]
    global_store_short v14, v83, s[8:9]
    global_store_short_d16_hi v15, v83, s[8:9]
    v_add_u32 v14, 8192, v14
    v_add_u32 v15, 8192, v15
    v_lshlrev_b32 v8, 16, v84
    v_and_b32 v9, 0xffff0000, v84
    v_sub_f32 v8, v8, v12
    v_sub_f32 v9, v9, v12
    v_cvt_pk_bf16_f32 v8, v8, v9
    v_and_b32 v9, 0xffff0000, v8
    v_lshlrev_b32 v8, 16, v8
    v_mul_f32 v8, v8, v13
    v_mul_f32 v9, v9, v13
    v_cvt_pk_bf16_f32 v8, v8, v9
    global_store_short v14, v8, s[6:7]
    global_store_short_d16_hi v15, v8, s[6:7]
    global_store_short v14, v84, s[8:9]
    global_store_short_d16_hi v15, v84, s[8:9]
    v_add_u32 v14, 8192, v14
    v_add_u32 v15, 8192, v15
    v_lshlrev_b32 v8, 16, v85
    v_and_b32 v9, 0xffff0000, v85
    v_sub_f32 v8, v8, v12
    v_sub_f32 v9, v9, v12
    v_cvt_pk_bf16_f32 v8, v8, v9
    v_and_b32 v9, 0xffff0000, v8
    v_lshlrev_b32 v8, 16, v8
    v_mul_f32 v8, v8, v13
    v_mul_f32 v9, v9, v13
    v_cvt_pk_bf16_f32 v8, v8, v9
    global_store_short v14, v8, s[6:7]
    global_store_short_d16_hi v15, v8, s[6:7]
    global_store_short v14, v85, s[8:9]
    global_store_short_d16_hi v15, v85, s[8:9]
    v_add_u32 v14, 8192, v14
    v_add_u32 v15, 8192, v15
    v_lshlrev_b32 v8, 16, v86
    v_and_b32 v9, 0xffff0000, v86
    v_sub_f32 v8, v8, v12
    v_sub_f32 v9, v9, v12
    v_cvt_pk_bf16_f32 v8, v8, v9
    v_and_b32 v9, 0xffff0000, v8
    v_lshlrev_b32 v8, 16, v8
    v_mul_f32 v8, v8, v13
    v_mul_f32 v9, v9, v13
    v_cvt_pk_bf16_f32 v8, v8, v9
    global_store_short v14, v8, s[6:7]
    global_store_short_d16_hi v15, v8, s[6:7]
    global_store_short v14, v86, s[8:9]
    global_store_short_d16_hi v15, v86, s[8:9]
    v_add_u32 v14, 8192, v14
    v_add_u32 v15, 8192, v15
    v_lshlrev_b32 v8, 16, v87
    v_and_b32 v9, 0xffff0000, v87
    v_sub_f32 v8, v8, v12
    v_sub_f32 v9, v9, v12
    v_cvt_pk_bf16_f32 v8, v8, v9
    v_and_b32 v9, 0xffff0000, v8
    v_lshlrev_b32 v8, 16, v8
    v_mul_f32 v8, v8, v13
    v_mul_f32 v9, v9, v13
    v_cvt_pk_bf16_f32 v8, v8, v9
    global_store_short v14, v8, s[6:7]
    global_store_short_d16_hi v15, v8, s[6:7]
    global_store_short v14, v87, s[8:9]
    global_store_short_d16_hi v15, v87, s[8:9]
    s_branch prep_end
prep_mod:
    s_load_dwordx4 s[4:7], s[0:1], 96
    s_sub_u32 s20, s2, 32
    s_waitcnt lgkmcnt(0)
    v_lshlrev_b32 v3, 1, v0
    global_load_ushort v8, v3, s[4:5]
    global_load_ushort v9, v3, s[4:5] offset:512
    v_cmp_gt_u32 vcc, 64, v0
    s_and_saveexec_b64 s[10:11], vcc
    global_load_ushort v10, v3, s[4:5] offset:1024
    s_mov_b64 exec, s[10:11]
    s_mov_b32 s23, 0xbfb8aa3b
    s_waitcnt vmcnt(0)
    v_lshlrev_b32 v8, 16, v8
    v_mul_f32 v11, s23, v8
    v_exp_f32 v11, v11
    s_nop 0
    v_add_f32 v11, 1.0, v11
    v_rcp_f32 v11, v11
    s_nop 0
    v_mul_f32 v8, v8, v11
    v_cvt_pk_bf16_f32 v8, v8, v8
    v_lshlrev_b32 v8, 16, v8
    v_lshlrev_b32 v9, 16, v9
    v_mul_f32 v11, s23, v9
    v_exp_f32 v11, v11
    s_nop 0
    v_add_f32 v11, 1.0, v11
    v_rcp_f32 v11, v11
    s_nop 0
    v_mul_f32 v9, v9, v11
    v_cvt_pk_bf16_f32 v9, v9, v9
    v_lshlrev_b32 v9, 16, v9
    v_lshlrev_b32 v10, 16, v10
    v_mul_f32 v11, s23, v10
    v_exp_f32 v11, v11
    s_nop 0
    v_add_f32 v11, 1.0, v11
    v_rcp_f32 v11, v11
    s_nop 0
    v_mul_f32 v10, v10, v11
    v_cvt_pk_bf16_f32 v10, v10, v10
    v_lshlrev_b32 v10, 16, v10
    v_lshlrev_b32 v4, 2, v0
    ds_write_b32 v4, v8
    ds_write_b32 v4, v9 offset:1024
    s_and_saveexec_b64 s[10:11], vcc
    ds_write_b32 v4, v10 offset:2048
    s_mov_b64 exec, s[10:11]
    s_waitcnt lgkmcnt(0)
    s_barrier
    v_mul_u32_u24 v5, 995328, v2
    s_lshl_b32 s21, s20, 7
    v_lshl_add_u32 v5, v1, 1, v5
    v_add_u32 v5, s21, v5
    v_mul_u32_u24 v6, 576, v2
    v_mov_b32 v7, 0
    s_mov_b32 s22, 6912
    global_load_ushort v16, v5, s[6:7]
    v_add_u32 v5, s22, v5
    global_load_ushort v17, v5, s[6:7]
    v_add_u32 v5, s22, v5
    global_load_ushort v18, v5, s[6:7]
    v_add_u32 v5, s22, v5
    global_load_ushort v19, v5, s[6:7]
    v_add_u32 v5, s22, v5
    global_load_ushort v20, v5, s[6:7]
    v_add_u32 v5, s22, v5
    global_load_ushort v21, v5, s[6:7]
    v_add_u32 v5, s22, v5
    global_load_ushort v22, v5, s[6:7]
    v_add_u32 v5, s22, v5
    global_load_ushort v23, v5, s[6:7]
    v_add_u32 v5, s22, v5
    ds_read_b128 v[24:27], v6 offset:0
    ds_read_b128 v[28:31], v6 offset:16
    s_waitcnt vmcnt(0) lgkmcnt(0)
    v_lshlrev_b32 v16, 16, v16
    v_fma_f32 v7, v16, v24, v7
    v_lshlrev_b32 v17, 16, v17
    v_fma_f32 v7, v17, v25, v7
    v_lshlrev_b32 v18, 16, v18
    v_fma_f32 v7, v18, v26, v7
    v_lshlrev_b32 v19, 16, v19
    v_fma_f32 v7, v19, v27, v7
    v_lshlrev_b32 v20, 16, v20
    v_fma_f32 v7, v20, v28, v7
    v_lshlrev_b32 v21, 16, v21
    v_fma_f32 v7, v21, v29, v7
    v_lshlrev_b32 v22, 16, v22
    v_fma_f32 v7, v22, v30, v7
    v_lshlrev_b32 v23, 16, v23
    v_fma_f32 v7, v23, v31, v7
    global_load_ushort v16, v5, s[6:7]
    v_add_u32 v5, s22, v5
    global_load_ushort v17, v5, s[6:7]
    v_add_u32 v5, s22, v5
    global_load_ushort v18, v5, s[6:7]
    v_add_u32 v5, s22, v5
    global_load_ushort v19, v5, s[6:7]
    v_add_u32 v5, s22, v5
    global_load_ushort v20, v5, s[6:7]
    v_add_u32 v5, s22, v5
    global_load_ushort v21, v5, s[6:7]
    v_add_u32 v5, s22, v5
    global_load_ushort v22, v5, s[6:7]
    v_add_u32 v5, s22, v5
    global_load_ushort v23, v5, s[6:7]
    v_add_u32 v5, s22, v5
    ds_read_b128 v[24:27], v6 offset:32
    ds_read_b128 v[28:31], v6 offset:48
    s_waitcnt vmcnt(0) lgkmcnt(0)
    v_lshlrev_b32 v16, 16, v16
    v_fma_f32 v7, v16, v24, v7
    v_lshlrev_b32 v17, 16, v17
    v_fma_f32 v7, v17, v25, v7
    v_lshlrev_b32 v18, 16, v18
    v_fma_f32 v7, v18, v26, v7
    v_lshlrev_b32 v19, 16, v19
    v_fma_f32 v7, v19, v27, v7
    v_lshlrev_b32 v20, 16, v20
    v_fma_f32 v7, v20, v28, v7
    v_lshlrev_b32 v21, 16, v21
    v_fma_f32 v7, v21, v29, v7
    v_lshlrev_b32 v22, 16, v22
    v_fma_f32 v7, v22, v30, v7
    v_lshlrev_b32 v23, 16, v23
    v_fma_f32 v7, v23, v31, v7
    global_load_ushort v16, v5, s[6:7]
    v_add_u32 v5, s22, v5
    global_load_ushort v17, v5, s[6:7]
    v_add_u32 v5, s22, v5
    global_load_ushort v18, v5, s[6:7]
    v_add_u32 v5, s22, v5
    global_load_ushort v19, v5, s[6:7]
    v_add_u32 v5, s22, v5
    global_load_ushort v20, v5, s[6:7]
    v_add_u32 v5, s22, v5
    global_load_ushort v21, v5, s[6:7]
    v_add_u32 v5, s22, v5
    global_load_ushort v22, v5, s[6:7]
    v_add_u32 v5, s22, v5
    global_load_ushort v23, v5, s[6:7]
    v_add_u32 v5, s22, v5
    ds_read_b128 v[24:27], v6 offset:64
    ds_read_b128 v[28:31], v6 offset:80
    s_waitcnt vmcnt(0) lgkmcnt(0)
    v_lshlrev_b32 v16, 16, v16
    v_fma_f32 v7, v16, v24, v7
    v_lshlrev_b32 v17, 16, v17
    v_fma_f32 v7, v17, v25, v7
    v_lshlrev_b32 v18, 16, v18
    v_fma_f32 v7, v18, v26, v7
    v_lshlrev_b32 v19, 16, v19
    v_fma_f32 v7, v19, v27, v7
    v_lshlrev_b32 v20, 16, v20
    v_fma_f32 v7, v20, v28, v7
    v_lshlrev_b32 v21, 16, v21
    v_fma_f32 v7, v21, v29, v7
    v_lshlrev_b32 v22, 16, v22
    v_fma_f32 v7, v22, v30, v7
    v_lshlrev_b32 v23, 16, v23
    v_fma_f32 v7, v23, v31, v7
    global_load_ushort v16, v5, s[6:7]
    v_add_u32 v5, s22, v5
    global_load_ushort v17, v5, s[6:7]
    v_add_u32 v5, s22, v5
    global_load_ushort v18, v5, s[6:7]
    v_add_u32 v5, s22, v5
    global_load_ushort v19, v5, s[6:7]
    v_add_u32 v5, s22, v5
    global_load_ushort v20, v5, s[6:7]
    v_add_u32 v5, s22, v5
    global_load_ushort v21, v5, s[6:7]
    v_add_u32 v5, s22, v5
    global_load_ushort v22, v5, s[6:7]
    v_add_u32 v5, s22, v5
    global_load_ushort v23, v5, s[6:7]
    v_add_u32 v5, s22, v5
    ds_read_b128 v[24:27], v6 offset:96
    ds_read_b128 v[28:31], v6 offset:112
    s_waitcnt vmcnt(0) lgkmcnt(0)
    v_lshlrev_b32 v16, 16, v16
    v_fma_f32 v7, v16, v24, v7
    v_lshlrev_b32 v17, 16, v17
    v_fma_f32 v7, v17, v25, v7
    v_lshlrev_b32 v18, 16, v18
    v_fma_f32 v7, v18, v26, v7
    v_lshlrev_b32 v19, 16, v19
    v_fma_f32 v7, v19, v27, v7
    v_lshlrev_b32 v20, 16, v20
    v_fma_f32 v7, v20, v28, v7
    v_lshlrev_b32 v21, 16, v21
    v_fma_f32 v7, v21, v29, v7
    v_lshlrev_b32 v22, 16, v22
    v_fma_f32 v7, v22, v30, v7
    v_lshlrev_b32 v23, 16, v23
    v_fma_f32 v7, v23, v31, v7
    global_load_ushort v16, v5, s[6:7]
    v_add_u32 v5, s22, v5
    global_load_ushort v17, v5, s[6:7]
    v_add_u32 v5, s22, v5
    global_load_ushort v18, v5, s[6:7]
    v_add_u32 v5, s22, v5
    global_load_ushort v19, v5, s[6:7]
    v_add_u32 v5, s22, v5
    global_load_ushort v20, v5, s[6:7]
    v_add_u32 v5, s22, v5
    global_load_ushort v21, v5, s[6:7]
    v_add_u32 v5, s22, v5
    global_load_ushort v22, v5, s[6:7]
    v_add_u32 v5, s22, v5
    global_load_ushort v23, v5, s[6:7]
    v_add_u32 v5, s22, v5
    ds_read_b128 v[24:27], v6 offset:128
    ds_read_b128 v[28:31], v6 offset:144
    s_waitcnt vmcnt(0) lgkmcnt(0)
    v_lshlrev_b32 v16, 16, v16
    v_fma_f32 v7, v16, v24, v7
    v_lshlrev_b32 v17, 16, v17
    v_fma_f32 v7, v17, v25, v7
    v_lshlrev_b32 v18, 16, v18
    v_fma_f32 v7, v18, v26, v7
    v_lshlrev_b32 v19, 16, v19
    v_fma_f32 v7, v19, v27, v7
    v_lshlrev_b32 v20, 16, v20
    v_fma_f32 v7, v20, v28, v7
    v_lshlrev_b32 v21, 16, v21
    v_fma_f32 v7, v21, v29, v7
    v_lshlrev_b32 v22, 16, v22
    v_fma_f32 v7, v22, v30, v7
    v_lshlrev_b32 v23, 16, v23
    v_fma_f32 v7, v23, v31, v7
    global_load_ushort v16, v5, s[6:7]
    v_add_u32 v5, s22, v5
    global_load_ushort v17, v5, s[6:7]
    v_add_u32 v5, s22, v5
    global_load_ushort v18, v5, s[6:7]
    v_add_u32 v5, s22, v5
    global_load_ushort v19, v5, s[6:7]
    v_add_u32 v5, s22, v5
    global_load_ushort v20, v5, s[6:7]
    v_add_u32 v5, s22, v5
    global_load_ushort v21, v5, s[6:7]
    v_add_u32 v5, s22, v5
    global_load_ushort v22, v5, s[6:7]
    v_add_u32 v5, s22, v5
    global_load_ushort v23, v5, s[6:7]
    v_add_u32 v5, s22, v5
    ds_read_b128 v[24:27], v6 offset:160
    ds_read_b128 v[28:31], v6 offset:176
    s_waitcnt vmcnt(0) lgkmcnt(0)
    v_lshlrev_b32 v16, 16, v16
    v_fma_f32 v7, v16, v24, v7
    v_lshlrev_b32 v17, 16, v17
    v_fma_f32 v7, v17, v25, v7
    v_lshlrev_b32 v18, 16, v18
    v_fma_f32 v7, v18, v26, v7
    v_lshlrev_b32 v19, 16, v19
    v_fma_f32 v7, v19, v27, v7
    v_lshlrev_b32 v20, 16, v20
    v_fma_f32 v7, v20, v28, v7
    v_lshlrev_b32 v21, 16, v21
    v_fma_f32 v7, v21, v29, v7
    v_lshlrev_b32 v22, 16, v22
    v_fma_f32 v7, v22, v30, v7
    v_lshlrev_b32 v23, 16, v23
    v_fma_f32 v7, v23, v31, v7
    global_load_ushort v16, v5, s[6:7]
    v_add_u32 v5, s22, v5
    global_load_ushort v17, v5, s[6:7]
    v_add_u32 v5, s22, v5
    global_load_ushort v18, v5, s[6:7]
    v_add_u32 v5, s22, v5
    global_load_ushort v19, v5, s[6:7]
    v_add_u32 v5, s22, v5
    global_load_ushort v20, v5, s[6:7]
    v_add_u32 v5, s22, v5
    global_load_ushort v21, v5, s[6:7]
    v_add_u32 v5, s22, v5
    global_load_ushort v22, v5, s[6:7]
    v_add_u32 v5, s22, v5
    global_load_ushort v23, v5, s[6:7]
    v_add_u32 v5, s22, v5
    ds_read_b128 v[24:27], v6 offset:192
    ds_read_b128 v[28:31], v6 offset:208
    s_waitcnt vmcnt(0) lgkmcnt(0)
    v_lshlrev_b32 v16, 16, v16
    v_fma_f32 v7, v16, v24, v7
    v_lshlrev_b32 v17, 16, v17
    v_fma_f32 v7, v17, v25, v7
    v_lshlrev_b32 v18, 16, v18
    v_fma_f32 v7, v18, v26, v7
    v_lshlrev_b32 v19, 16, v19
    v_fma_f32 v7, v19, v27, v7
    v_lshlrev_b32 v20, 16, v20
    v_fma_f32 v7, v20, v28, v7
    v_lshlrev_b32 v21, 16, v21
    v_fma_f32 v7, v21, v29, v7
    v_lshlrev_b32 v22, 16, v22
    v_fma_f32 v7, v22, v30, v7
    v_lshlrev_b32 v23, 16, v23
    v_fma_f32 v7, v23, v31, v7
    global_load_ushort v16, v5, s[6:7]
    v_add_u32 v5, s22, v5
    global_load_ushort v17, v5, s[6:7]
    v_add_u32 v5, s22, v5
    global_load_ushort v18, v5, s[6:7]
    v_add_u32 v5, s22, v5
    global_load_ushort v19, v5, s[6:7]
    v_add_u32 v5, s22, v5
    global_load_ushort v20, v5, s[6:7]
    v_add_u32 v5, s22, v5
    global_load_ushort v21, v5, s[6:7]
    v_add_u32 v5, s22, v5
    global_load_ushort v22, v5, s[6:7]
    v_add_u32 v5, s22, v5
    global_load_ushort v23, v5, s[6:7]
    v_add_u32 v5, s22, v5
    ds_read_b128 v[24:27], v6 offset:224
    ds_read_b128 v[28:31], v6 offset:240
    s_waitcnt vmcnt(0) lgkmcnt(0)
    v_lshlrev_b32 v16, 16, v16
    v_fma_f32 v7, v16, v24, v7
    v_lshlrev_b32 v17, 16, v17
    v_fma_f32 v7, v17, v25, v7
    v_lshlrev_b32 v18, 16, v18
    v_fma_f32 v7, v18, v26, v7
    v_lshlrev_b32 v19, 16, v19
    v_fma_f32 v7, v19, v27, v7
    v_lshlrev_b32 v20, 16, v20
    v_fma_f32 v7, v20, v28, v7
    v_lshlrev_b32 v21, 16, v21
    v_fma_f32 v7, v21, v29, v7
    v_lshlrev_b32 v22, 16, v22
    v_fma_f32 v7, v22, v30, v7
    v_lshlrev_b32 v23, 16, v23
    v_fma_f32 v7, v23, v31, v7
    global_load_ushort v16, v5, s[6:7]
    v_add_u32 v5, s22, v5
    global_load_ushort v17, v5, s[6:7]
    v_add_u32 v5, s22, v5
    global_load_ushort v18, v5, s[6:7]
    v_add_u32 v5, s22, v5
    global_load_ushort v19, v5, s[6:7]
    v_add_u32 v5, s22, v5
    global_load_ushort v20, v5, s[6:7]
    v_add_u32 v5, s22, v5
    global_load_ushort v21, v5, s[6:7]
    v_add_u32 v5, s22, v5
    global_load_ushort v22, v5, s[6:7]
    v_add_u32 v5, s22, v5
    global_load_ushort v23, v5, s[6:7]
    v_add_u32 v5, s22, v5
    ds_read_b128 v[24:27], v6 offset:256
    ds_read_b128 v[28:31], v6 offset:272
    s_waitcnt vmcnt(0) lgkmcnt(0)
    v_lshlrev_b32 v16, 16, v16
    v_fma_f32 v7, v16, v24, v7
    v_lshlrev_b32 v17, 16, v17
    v_fma_f32 v7, v17, v25, v7
    v_lshlrev_b32 v18, 16, v18
    v_fma_f32 v7, v18, v26, v7
    v_lshlrev_b32 v19, 16, v19
    v_fma_f32 v7, v19, v27, v7
    v_lshlrev_b32 v20, 16, v20
    v_fma_f32 v7, v20, v28, v7
    v_lshlrev_b32 v21, 16, v21
    v_fma_f32 v7, v21, v29, v7
    v_lshlrev_b32 v22, 16, v22
    v_fma_f32 v7, v22, v30, v7
    v_lshlrev_b32 v23, 16, v23
    v_fma_f32 v7, v23, v31, v7
    global_load_ushort v16, v5, s[6:7]
    v_add_u32 v5, s22, v5
    global_load_ushort v17, v5, s[6:7]
    v_add_u32 v5, s22, v5
    global_load_ushort v18, v5, s[6:7]
    v_add_u32 v5, s22, v5
    global_load_ushort v19, v5, s[6:7]
    v_add_u32 v5, s22, v5
    global_load_ushort v20, v5, s[6:7]
    v_add_u32 v5, s22, v5
    global_load_ushort v21, v5, s[6:7]
    v_add_u32 v5, s22, v5
    global_load_ushort v22, v5, s[6:7]
    v_add_u32 v5, s22, v5
    global_load_ushort v23, v5, s[6:7]
    v_add_u32 v5, s22, v5
    ds_read_b128 v[24:27], v6 offset:288
    ds_read_b128 v[28:31], v6 offset:304
    s_waitcnt vmcnt(0) lgkmcnt(0)
    v_lshlrev_b32 v16, 16, v16
    v_fma_f32 v7, v16, v24, v7
    v_lshlrev_b32 v17, 16, v17
    v_fma_f32 v7, v17, v25, v7
    v_lshlrev_b32 v18, 16, v18
    v_fma_f32 v7, v18, v26, v7
    v_lshlrev_b32 v19, 16, v19
    v_fma_f32 v7, v19, v27, v7
    v_lshlrev_b32 v20, 16, v20
    v_fma_f32 v7, v20, v28, v7
    v_lshlrev_b32 v21, 16, v21
    v_fma_f32 v7, v21, v29, v7
    v_lshlrev_b32 v22, 16, v22
    v_fma_f32 v7, v22, v30, v7
    v_lshlrev_b32 v23, 16, v23
    v_fma_f32 v7, v23, v31, v7
    global_load_ushort v16, v5, s[6:7]
    v_add_u32 v5, s22, v5
    global_load_ushort v17, v5, s[6:7]
    v_add_u32 v5, s22, v5
    global_load_ushort v18, v5, s[6:7]
    v_add_u32 v5, s22, v5
    global_load_ushort v19, v5, s[6:7]
    v_add_u32 v5, s22, v5
    global_load_ushort v20, v5, s[6:7]
    v_add_u32 v5, s22, v5
    global_load_ushort v21, v5, s[6:7]
    v_add_u32 v5, s22, v5
    global_load_ushort v22, v5, s[6:7]
    v_add_u32 v5, s22, v5
    global_load_ushort v23, v5, s[6:7]
    v_add_u32 v5, s22, v5
    ds_read_b128 v[24:27], v6 offset:320
    ds_read_b128 v[28:31], v6 offset:336
    s_waitcnt vmcnt(0) lgkmcnt(0)
    v_lshlrev_b32 v16, 16, v16
    v_fma_f32 v7, v16, v24, v7
    v_lshlrev_b32 v17, 16, v17
    v_fma_f32 v7, v17, v25, v7
    v_lshlrev_b32 v18, 16, v18
    v_fma_f32 v7, v18, v26, v7
    v_lshlrev_b32 v19, 16, v19
    v_fma_f32 v7, v19, v27, v7
    v_lshlrev_b32 v20, 16, v20
    v_fma_f32 v7, v20, v28, v7
    v_lshlrev_b32 v21, 16, v21
    v_fma_f32 v7, v21, v29, v7
    v_lshlrev_b32 v22, 16, v22
    v_fma_f32 v7, v22, v30, v7
    v_lshlrev_b32 v23, 16, v23
    v_fma_f32 v7, v23, v31, v7
    global_load_ushort v16, v5, s[6:7]
    v_add_u32 v5, s22, v5
    global_load_ushort v17, v5, s[6:7]
    v_add_u32 v5, s22, v5
    global_load_ushort v18, v5, s[6:7]
    v_add_u32 v5, s22, v5
    global_load_ushort v19, v5, s[6:7]
    v_add_u32 v5, s22, v5
    global_load_ushort v20, v5, s[6:7]
    v_add_u32 v5, s22, v5
    global_load_ushort v21, v5, s[6:7]
    v_add_u32 v5, s22, v5
    global_load_ushort v22, v5, s[6:7]
    v_add_u32 v5, s22, v5
    global_load_ushort v23, v5, s[6:7]
    v_add_u32 v5, s22, v5
    ds_read_b128 v[24:27], v6 offset:352
    ds_read_b128 v[28:31], v6 offset:368
    s_waitcnt vmcnt(0) lgkmcnt(0)
    v_lshlrev_b32 v16, 16, v16
    v_fma_f32 v7, v16, v24, v7
    v_lshlrev_b32 v17, 16, v17
    v_fma_f32 v7, v17, v25, v7
    v_lshlrev_b32 v18, 16, v18
    v_fma_f32 v7, v18, v26, v7
    v_lshlrev_b32 v19, 16, v19
    v_fma_f32 v7, v19, v27, v7
    v_lshlrev_b32 v20, 16, v20
    v_fma_f32 v7, v20, v28, v7
    v_lshlrev_b32 v21, 16, v21
    v_fma_f32 v7, v21, v29, v7
    v_lshlrev_b32 v22, 16, v22
    v_fma_f32 v7, v22, v30, v7
    v_lshlrev_b32 v23, 16, v23
    v_fma_f32 v7, v23, v31, v7
    global_load_ushort v16, v5, s[6:7]
    v_add_u32 v5, s22, v5
    global_load_ushort v17, v5, s[6:7]
    v_add_u32 v5, s22, v5
    global_load_ushort v18, v5, s[6:7]
    v_add_u32 v5, s22, v5
    global_load_ushort v19, v5, s[6:7]
    v_add_u32 v5, s22, v5
    global_load_ushort v20, v5, s[6:7]
    v_add_u32 v5, s22, v5
    global_load_ushort v21, v5, s[6:7]
    v_add_u32 v5, s22, v5
    global_load_ushort v22, v5, s[6:7]
    v_add_u32 v5, s22, v5
    global_load_ushort v23, v5, s[6:7]
    v_add_u32 v5, s22, v5
    ds_read_b128 v[24:27], v6 offset:384
    ds_read_b128 v[28:31], v6 offset:400
    s_waitcnt vmcnt(0) lgkmcnt(0)
    v_lshlrev_b32 v16, 16, v16
    v_fma_f32 v7, v16, v24, v7
    v_lshlrev_b32 v17, 16, v17
    v_fma_f32 v7, v17, v25, v7
    v_lshlrev_b32 v18, 16, v18
    v_fma_f32 v7, v18, v26, v7
    v_lshlrev_b32 v19, 16, v19
    v_fma_f32 v7, v19, v27, v7
    v_lshlrev_b32 v20, 16, v20
    v_fma_f32 v7, v20, v28, v7
    v_lshlrev_b32 v21, 16, v21
    v_fma_f32 v7, v21, v29, v7
    v_lshlrev_b32 v22, 16, v22
    v_fma_f32 v7, v22, v30, v7
    v_lshlrev_b32 v23, 16, v23
    v_fma_f32 v7, v23, v31, v7
    global_load_ushort v16, v5, s[6:7]
    v_add_u32 v5, s22, v5
    global_load_ushort v17, v5, s[6:7]
    v_add_u32 v5, s22, v5
    global_load_ushort v18, v5, s[6:7]
    v_add_u32 v5, s22, v5
    global_load_ushort v19, v5, s[6:7]
    v_add_u32 v5, s22, v5
    global_load_ushort v20, v5, s[6:7]
    v_add_u32 v5, s22, v5
    global_load_ushort v21, v5, s[6:7]
    v_add_u32 v5, s22, v5
    global_load_ushort v22, v5, s[6:7]
    v_add_u32 v5, s22, v5
    global_load_ushort v23, v5, s[6:7]
    v_add_u32 v5, s22, v5
    ds_read_b128 v[24:27], v6 offset:416
    ds_read_b128 v[28:31], v6 offset:432
    s_waitcnt vmcnt(0) lgkmcnt(0)
    v_lshlrev_b32 v16, 16, v16
    v_fma_f32 v7, v16, v24, v7
    v_lshlrev_b32 v17, 16, v17
    v_fma_f32 v7, v17, v25, v7
    v_lshlrev_b32 v18, 16, v18
    v_fma_f32 v7, v18, v26, v7
    v_lshlrev_b32 v19, 16, v19
    v_fma_f32 v7, v19, v27, v7
    v_lshlrev_b32 v20, 16, v20
    v_fma_f32 v7, v20, v28, v7
    v_lshlrev_b32 v21, 16, v21
    v_fma_f32 v7, v21, v29, v7
    v_lshlrev_b32 v22, 16, v22
    v_fma_f32 v7, v22, v30, v7
    v_lshlrev_b32 v23, 16, v23
    v_fma_f32 v7, v23, v31, v7
    global_load_ushort v16, v5, s[6:7]
    v_add_u32 v5, s22, v5
    global_load_ushort v17, v5, s[6:7]
    v_add_u32 v5, s22, v5
    global_load_ushort v18, v5, s[6:7]
    v_add_u32 v5, s22, v5
    global_load_ushort v19, v5, s[6:7]
    v_add_u32 v5, s22, v5
    global_load_ushort v20, v5, s[6:7]
    v_add_u32 v5, s22, v5
    global_load_ushort v21, v5, s[6:7]
    v_add_u32 v5, s22, v5
    global_load_ushort v22, v5, s[6:7]
    v_add_u32 v5, s22, v5
    global_load_ushort v23, v5, s[6:7]
    v_add_u32 v5, s22, v5
    ds_read_b128 v[24:27], v6 offset:448
    ds_read_b128 v[28:31], v6 offset:464
    s_waitcnt vmcnt(0) lgkmcnt(0)
    v_lshlrev_b32 v16, 16, v16
    v_fma_f32 v7, v16, v24, v7
    v_lshlrev_b32 v17, 16, v17
    v_fma_f32 v7, v17, v25, v7
    v_lshlrev_b32 v18, 16, v18
    v_fma_f32 v7, v18, v26, v7
    v_lshlrev_b32 v19, 16, v19
    v_fma_f32 v7, v19, v27, v7
    v_lshlrev_b32 v20, 16, v20
    v_fma_f32 v7, v20, v28, v7
    v_lshlrev_b32 v21, 16, v21
    v_fma_f32 v7, v21, v29, v7
    v_lshlrev_b32 v22, 16, v22
    v_fma_f32 v7, v22, v30, v7
    v_lshlrev_b32 v23, 16, v23
    v_fma_f32 v7, v23, v31, v7
    global_load_ushort v16, v5, s[6:7]
    v_add_u32 v5, s22, v5
    global_load_ushort v17, v5, s[6:7]
    v_add_u32 v5, s22, v5
    global_load_ushort v18, v5, s[6:7]
    v_add_u32 v5, s22, v5
    global_load_ushort v19, v5, s[6:7]
    v_add_u32 v5, s22, v5
    global_load_ushort v20, v5, s[6:7]
    v_add_u32 v5, s22, v5
    global_load_ushort v21, v5, s[6:7]
    v_add_u32 v5, s22, v5
    global_load_ushort v22, v5, s[6:7]
    v_add_u32 v5, s22, v5
    global_load_ushort v23, v5, s[6:7]
    v_add_u32 v5, s22, v5
    ds_read_b128 v[24:27], v6 offset:480
    ds_read_b128 v[28:31], v6 offset:496
    s_waitcnt vmcnt(0) lgkmcnt(0)
    v_lshlrev_b32 v16, 16, v16
    v_fma_f32 v7, v16, v24, v7
    v_lshlrev_b32 v17, 16, v17
    v_fma_f32 v7, v17, v25, v7
    v_lshlrev_b32 v18, 16, v18
    v_fma_f32 v7, v18, v26, v7
    v_lshlrev_b32 v19, 16, v19
    v_fma_f32 v7, v19, v27, v7
    v_lshlrev_b32 v20, 16, v20
    v_fma_f32 v7, v20, v28, v7
    v_lshlrev_b32 v21, 16, v21
    v_fma_f32 v7, v21, v29, v7
    v_lshlrev_b32 v22, 16, v22
    v_fma_f32 v7, v22, v30, v7
    v_lshlrev_b32 v23, 16, v23
    v_fma_f32 v7, v23, v31, v7
    global_load_ushort v16, v5, s[6:7]
    v_add_u32 v5, s22, v5
    global_load_ushort v17, v5, s[6:7]
    v_add_u32 v5, s22, v5
    global_load_ushort v18, v5, s[6:7]
    v_add_u32 v5, s22, v5
    global_load_ushort v19, v5, s[6:7]
    v_add_u32 v5, s22, v5
    global_load_ushort v20, v5, s[6:7]
    v_add_u32 v5, s22, v5
    global_load_ushort v21, v5, s[6:7]
    v_add_u32 v5, s22, v5
    global_load_ushort v22, v5, s[6:7]
    v_add_u32 v5, s22, v5
    global_load_ushort v23, v5, s[6:7]
    v_add_u32 v5, s22, v5
    ds_read_b128 v[24:27], v6 offset:512
    ds_read_b128 v[28:31], v6 offset:528
    s_waitcnt vmcnt(0) lgkmcnt(0)
    v_lshlrev_b32 v16, 16, v16
    v_fma_f32 v7, v16, v24, v7
    v_lshlrev_b32 v17, 16, v17
    v_fma_f32 v7, v17, v25, v7
    v_lshlrev_b32 v18, 16, v18
    v_fma_f32 v7, v18, v26, v7
    v_lshlrev_b32 v19, 16, v19
    v_fma_f32 v7, v19, v27, v7
    v_lshlrev_b32 v20, 16, v20
    v_fma_f32 v7, v20, v28, v7
    v_lshlrev_b32 v21, 16, v21
    v_fma_f32 v7, v21, v29, v7
    v_lshlrev_b32 v22, 16, v22
    v_fma_f32 v7, v22, v30, v7
    v_lshlrev_b32 v23, 16, v23
    v_fma_f32 v7, v23, v31, v7
    global_load_ushort v16, v5, s[6:7]
    v_add_u32 v5, s22, v5
    global_load_ushort v17, v5, s[6:7]
    v_add_u32 v5, s22, v5
    global_load_ushort v18, v5, s[6:7]
    v_add_u32 v5, s22, v5
    global_load_ushort v19, v5, s[6:7]
    v_add_u32 v5, s22, v5
    global_load_ushort v20, v5, s[6:7]
    v_add_u32 v5, s22, v5
    global_load_ushort v21, v5, s[6:7]
    v_add_u32 v5, s22, v5
    global_load_ushort v22, v5, s[6:7]
    v_add_u32 v5, s22, v5
    global_load_ushort v23, v5, s[6:7]
    v_add_u32 v5, s22, v5
    ds_read_b128 v[24:27], v6 offset:544
    ds_read_b128 v[28:31], v6 offset:560
    s_waitcnt vmcnt(0) lgkmcnt(0)
    v_lshlrev_b32 v16, 16, v16
    v_fma_f32 v7, v16, v24, v7
    v_lshlrev_b32 v17, 16, v17
    v_fma_f32 v7, v17, v25, v7
    v_lshlrev_b32 v18, 16, v18
    v_fma_f32 v7, v18, v26, v7
    v_lshlrev_b32 v19, 16, v19
    v_fma_f32 v7, v19, v27, v7
    v_lshlrev_b32 v20, 16, v20
    v_fma_f32 v7, v20, v28, v7
    v_lshlrev_b32 v21, 16, v21
    v_fma_f32 v7, v21, v29, v7
    v_lshlrev_b32 v22, 16, v22
    v_fma_f32 v7, v22, v30, v7
    v_lshlrev_b32 v23, 16, v23
    v_fma_f32 v7, v23, v31, v7
    s_barrier
    ds_write_b32 v4, v7 offset:4096
    s_waitcnt lgkmcnt(0)
    s_barrier
    v_lshlrev_b32 v11, 2, v1
    ds_read_b32 v96, v11 offset:4096
    ds_read_b32 v97, v11 offset:4352
    ds_read_b32 v98, v11 offset:4608
    ds_read_b32 v99, v11 offset:4864
    s_waitcnt lgkmcnt(0)
    v_add_f32 v96, v96, v97
    v_add_f32 v98, v98, v99
    v_add_f32 v96, v96, v98
    v_cvt_pk_bf16_f32 v96, v96, v96
    v_lshlrev_b32 v96, 16, v96
    s_lshl_b32 s21, s20, 8
    v_add_u32 v11, s21, v11
    v_cmp_gt_u32 vcc, 64, v0
    s_and_saveexec_b64 s[10:11], vcc
    global_store_dword v11, v96, s[18:19] offset:0
    s_mov_b64 exec, s[10:11]
prep_end:
    s_endpgm
.text
.globl conv_kernel
.p2align 8
.type conv_kernel,@function
conv_kernel:
    s_cmp_ge_u32 s2, 576
    s_cbranch_scc1 conv_end
    s_load_dwordx2 s[18:19], s[0:1], 128
    s_load_dwordx2 s[16:17], s[0:1], 64
    v_and_b32 v1, 63, v0
    v_lshrrev_b32 v2, 6, v0
    s_lshl_b32 s20, s2, 2
    s_waitcnt lgkmcnt(0)
    s_add_u32 s4, s18, s20
    s_addc_u32 s5, s19, 0
    s_load_dword s10, s[4:5], 0
    s_load_dword s11, s[4:5], 2304
    s_load_dword s12, s[4:5], 4608
    s_lshl_b32 s21, s2, 13
    s_add_u32 s21, s21, 11812864
    v_lshlrev_b32 v3, 5, v0
    v_add_u32 v3, s21, v3
    global_load_dwordx4 v[16:19], v3, s[18:19]
    global_load_dwordx4 v[20:23], v3, s[18:19] offset:16
    v_mov_b32 v24, 0
    v_cmp_lt_u32 vcc, 0, v0
    s_and_saveexec_b64 s[6:7], vcc
    global_load_dword v24, v3, s[18:19] offset:-4
    s_mov_b64 exec, s[6:7]
    s_lshl_b32 s22, s2, 12
    v_lshlrev_b32 v4, 4, v0
    v_add_u32 v4, s22, v4
    v_add_u32 v5, 2375680, v4
    global_load_dwordx4 v[28:31], v5, s[18:19]
    v_add_u32 v5, 16384, v4
    global_load_dwordx4 v[32:35], v5, s[18:19]
    v_mov_b32 v6, s2
    v_lshlrev_b32 v6, 1, v6
    global_load_ushort v36, v6, s[16:17]
    v_mov_b32 v40, 0
    v_mov_b32 v41, 0
    v_mov_b32 v42, 0
    v_mov_b32 v43, 0
    v_lshlrev_b32 v7, 4, v0
    ds_write_b128 v7, v[40:43] offset:0
    v_cmp_gt_u32 vcc, 64, v0
    s_and_saveexec_b64 s[6:7], vcc
    ds_write_b128 v7, v[40:43] offset:4096
    s_mov_b64 exec, s[6:7]
    v_cmp_gt_u32 vcc, 5, v0
    s_and_saveexec_b64 s[6:7], vcc
    ds_write_b128 v7, v[40:43] offset:14320
    ds_write_b128 v7, v[40:43] offset:18480
    ds_write_b128 v7, v[40:43] offset:22640
    ds_write_b128 v7, v[40:43] offset:26800
    ds_write_b128 v7, v[40:43] offset:30960
    ds_write_b128 v7, v[40:43] offset:35120
    ds_write_b128 v7, v[40:43] offset:39280
    ds_write_b128 v7, v[40:43] offset:43440
    s_mov_b64 exec, s[6:7]
    s_waitcnt vmcnt(0) lgkmcnt(0)
    s_barrier
    v_cvt_pk_bf16_f32 v44, v24, v24
    v_lshlrev_b32 v44, 16, v44
    v_sub_f32 v53, v24, v44
    v_cvt_pk_bf16_f32 v45, v16, v16
    v_lshlrev_b32 v45, 16, v45
    v_sub_f32 v54, v16, v45
    v_cvt_pk_bf16_f32 v46, v17, v17
    v_lshlrev_b32 v46, 16, v46
    v_sub_f32 v55, v17, v46
    v_cvt_pk_bf16_f32 v47, v18, v18
    v_lshlrev_b32 v47, 16, v47
    v_sub_f32 v56, v18, v47
    v_cvt_pk_bf16_f32 v48, v19, v19
    v_lshlrev_b32 v48, 16, v48
    v_sub_f32 v57, v19, v48
    v_cvt_pk_bf16_f32 v49, v20, v20
    v_lshlrev_b32 v49, 16, v49
    v_sub_f32 v58, v20, v49
    v_cvt_pk_bf16_f32 v50, v21, v21
    v_lshlrev_b32 v50, 16, v50
    v_sub_f32 v59, v21, v50
    v_cvt_pk_bf16_f32 v51, v22, v22
    v_lshlrev_b32 v51, 16, v51
    v_sub_f32 v60, v22, v51
    v_cvt_pk_bf16_f32 v52, v23, v23
    v_lshlrev_b32 v52, 16, v52
    v_sub_f32 v61, v23, v52
    v_sub_u32 v8, 4080, v7
    v_cvt_pk_bf16_f32 v62, v45, v44
    v_cvt_pk_bf16_f32 v66, v46, v45
    v_cvt_pk_bf16_f32 v63, v47, v46
    v_cvt_pk_bf16_f32 v67, v48, v47
    v_cvt_pk_bf16_f32 v64, v49, v48
    v_cvt_pk_bf16_f32 v68, v50, v49
    v_cvt_pk_bf16_f32 v65, v51, v50
    v_cvt_pk_bf16_f32 v69, v52, v51
    ds_write_b32 v8, v62 offset:10256
    ds_write_b32 v8, v63 offset:10252
    ds_write_b32 v8, v64 offset:10248
    ds_write_b32 v8, v65 offset:10244
    ds_write_b32 v8, v66 offset:14412
    ds_write_b32 v8, v67 offset:14408
    ds_write_b32 v8, v68 offset:14404
    ds_write_b32 v8, v69 offset:14400
    ds_write_b32 v8, v62 offset:18572
    ds_write_b32 v8, v63 offset:18568
    ds_write_b32 v8, v64 offset:18564
    ds_write_b32 v8, v65 offset:18560
    ds_write_b32 v8, v66 offset:22728
    ds_write_b32 v8, v67 offset:22724
    ds_write_b32 v8, v68 offset:22720
    ds_write_b32 v8, v69 offset:22716
    v_cvt_pk_bf16_f32 v62, v54, v53
    v_cvt_pk_bf16_f32 v66, v55, v54
    v_cvt_pk_bf16_f32 v63, v56, v55
    v_cvt_pk_bf16_f32 v67, v57, v56
    v_cvt_pk_bf16_f32 v64, v58, v57
    v_cvt_pk_bf16_f32 v68, v59, v58
    v_cvt_pk_bf16_f32 v65, v60, v59
    v_cvt_pk_bf16_f32 v69, v61, v60
    ds_write_b32 v8, v62 offset:26896
    ds_write_b32 v8, v63 offset:26892
    ds_write_b32 v8, v64 offset:26888
    ds_write_b32 v8, v65 offset:26884
    ds_write_b32 v8, v66 offset:31052
    ds_write_b32 v8, v67 offset:31048
    ds_write_b32 v8, v68 offset:31044
    ds_write_b32 v8, v69 offset:31040
    ds_write_b32 v8, v62 offset:35212
    ds_write_b32 v8, v63 offset:35208
    ds_write_b32 v8, v64 offset:35204
    ds_write_b32 v8, v65 offset:35200
    ds_write_b32 v8, v66 offset:39368
    ds_write_b32 v8, v67 offset:39364
    ds_write_b32 v8, v68 offset:39360
    ds_write_b32 v8, v69 offset:39356
    s_waitcnt lgkmcnt(0)
    v_mov_b32 v9, s11
    v_add_f32 v9, 1.0, v9
    v_cvt_pk_bf16_f32 v9, v9, v9
    v_lshlrev_b32 v9, 16, v9
    v_lshlrev_b32 v10, 16, v28
    v_and_b32 v11, 0xffff0000, v28
    v_mul_f32 v10, v10, v9
    v_mul_f32 v11, v11, v9
    v_cvt_pk_bf16_f32 v10, v10, v11
    v_and_b32 v11, 0xffff0000, v10
    v_lshlrev_b32 v10, 16, v10
    v_add_f32 v10, s10, v10
    v_add_f32 v11, s10, v11
    v_cvt_pk_bf16_f32 v28, v10, v11
    v_lshlrev_b32 v10, 16, v29
    v_and_b32 v11, 0xffff0000, v29
    v_mul_f32 v10, v10, v9
    v_mul_f32 v11, v11, v9
    v_cvt_pk_bf16_f32 v10, v10, v11
    v_and_b32 v11, 0xffff0000, v10
    v_lshlrev_b32 v10, 16, v10
    v_add_f32 v10, s10, v10
    v_add_f32 v11, s10, v11
    v_cvt_pk_bf16_f32 v29, v10, v11
    v_lshlrev_b32 v10, 16, v30
    v_and_b32 v11, 0xffff0000, v30
    v_mul_f32 v10, v10, v9
    v_mul_f32 v11, v11, v9
    v_cvt_pk_bf16_f32 v10, v10, v11
    v_and_b32 v11, 0xffff0000, v10
    v_lshlrev_b32 v10, 16, v10
    v_add_f32 v10, s10, v10
    v_add_f32 v11, s10, v11
    v_cvt_pk_bf16_f32 v30, v10, v11
    v_lshlrev_b32 v10, 16, v31
    v_and_b32 v11, 0xffff0000, v31
    v_mul_f32 v10, v10, v9
    v_mul_f32 v11, v11, v9
    v_cvt_pk_bf16_f32 v10, v10, v11
    v_and_b32 v11, 0xffff0000, v10
    v_lshlrev_b32 v10, 16, v10
    v_add_f32 v10, s10, v10
    v_add_f32 v11, s10, v11
    v_cvt_pk_bf16_f32 v31, v10, v11
    v_lshrrev_b32 v10, 2, v0
    v_mul_u32_u24 v10, 80, v10
    v_and_b32 v11, 3, v0
    v_lshl_add_u32 v10, v11, 4, v10
    ds_write_b128 v10, v[28:31] offset:5120
    s_waitcnt lgkmcnt(0)
    s_barrier
    v_and_b32 v12, 31, v1
    v_lshrrev_b32 v13, 5, v1
    v_and_b32 v14, 1, v2
    v_lshrrev_b32 v15, 1, v2
    v_and_b32 v16, 3, v12
    v_sub_u32 v16, 4, v16
    v_and_b32 v16, 3, v16
    v_mul_u32_u24 v17, 16640, v14
    v_mul_u32_u24 v18, 4158, v16
    v_add_u32 v17, v17, v18
    v_lshlrev_b32 v18, 4, v13
    v_add_u32 v17, v17, v18
    v_lshlrev_b32 v18, 1, v12
    v_sub_u32 v17, v17, v18
    v_lshlrev_b32 v18, 6, v15
    v_sub_u32 v17, v17, v18
    v_add_u32 v17, 10368, v17
    v_sub_u32 v19, v12, v15
    v_add_u32 v19, 2, v19
    v_mul_u32_u24 v19, 80, v19
    v_lshlrev_b32 v18, 4, v13
    v_add_u32 v19, v19, v18
    v_accvgpr_write_b32 a0, 0
    v_accvgpr_write_b32 a1, 0
    v_accvgpr_write_b32 a2, 0
    v_accvgpr_write_b32 a3, 0
    v_accvgpr_write_b32 a4, 0
    v_accvgpr_write_b32 a5, 0
    v_accvgpr_write_b32 a6, 0
    v_accvgpr_write_b32 a7, 0
    v_accvgpr_write_b32 a8, 0
    v_accvgpr_write_b32 a9, 0
    v_accvgpr_write_b32 a10, 0
    v_accvgpr_write_b32 a11, 0
    v_accvgpr_write_b32 a12, 0
    v_accvgpr_write_b32 a13, 0
    v_accvgpr_write_b32 a14, 0
    v_accvgpr_write_b32 a15, 0
    v_accvgpr_write_b32 a16, 0
    v_accvgpr_write_b32 a17, 0
    v_accvgpr_write_b32 a18, 0
    v_accvgpr_write_b32 a19, 0
    v_accvgpr_write_b32 a20, 0
    v_accvgpr_write_b32 a21, 0
    v_accvgpr_write_b32 a22, 0
    v_accvgpr_write_b32 a23, 0
    v_accvgpr_write_b32 a24, 0
    v_accvgpr_write_b32 a25, 0
    v_accvgpr_write_b32 a26, 0
    v_accvgpr_write_b32 a27, 0
    v_accvgpr_write_b32 a28, 0
    v_accvgpr_write_b32 a29, 0
    v_accvgpr_write_b32 a30, 0
    v_accvgpr_write_b32 a31, 0
    ds_read_b64 v[64:65], v17 offset:3968
    ds_read_b64 v[66:67], v17 offset:3976
    ds_read_b128 v[72:75], v19 offset:7520
    ds_read_b128 v[80:83], v19 offset:4960
    ds_read_b64 v[68:69], v17 offset:4000
    ds_read_b64 v[70:71], v17 offset:4008
    ds_read_b128 v[76:79], v19 offset:7552
    ds_read_b128 v[84:87], v19 offset:4992
    s_waitcnt lgkmcnt(4)
    v_mfma_f32_32x32x16_bf16 a[16:31], v[64:67], v[72:75], a[16:31]
    v_mfma_f32_32x32x16_bf16 a[0:15], v[64:67], v[80:83], a[0:15]
    ds_read_b64 v[64:65], v17 offset:3840
    ds_read_b64 v[66:67], v17 offset:3848
    ds_read_b128 v[72:75], v19 offset:7360
    ds_read_b128 v[80:83], v19 offset:4800
    s_waitcnt lgkmcnt(4)
    v_mfma_f32_32x32x16_bf16 a[16:31], v[68:71], v[76:79], a[16:31]
    v_mfma_f32_32x32x16_bf16 a[0:15], v[68:71], v[84:87], a[0:15]
    ds_read_b64 v[68:69], v17 offset:3872
    ds_read_b64 v[70:71], v17 offset:3880
    ds_read_b128 v[76:79], v19 offset:7392
    ds_read_b128 v[84:87], v19 offset:4832
    s_waitcnt lgkmcnt(4)
    v_mfma_f32_32x32x16_bf16 a[16:31], v[64:67], v[72:75], a[16:31]
    v_mfma_f32_32x32x16_bf16 a[0:15], v[64:67], v[80:83], a[0:15]
    ds_read_b64 v[64:65], v17 offset:3712
    ds_read_b64 v[66:67], v17 offset:3720
    ds_read_b128 v[72:75], v19 offset:7200
    ds_read_b128 v[80:83], v19 offset:4640
    s_waitcnt lgkmcnt(4)
    v_mfma_f32_32x32x16_bf16 a[16:31], v[68:71], v[76:79], a[16:31]
    v_mfma_f32_32x32x16_bf16 a[0:15], v[68:71], v[84:87], a[0:15]
    ds_read_b64 v[68:69], v17 offset:3744
    ds_read_b64 v[70:71], v17 offset:3752
    ds_read_b128 v[76:79], v19 offset:7232
    ds_read_b128 v[84:87], v19 offset:4672
    s_waitcnt lgkmcnt(4)
    v_mfma_f32_32x32x16_bf16 a[16:31], v[64:67], v[72:75], a[16:31]
    v_mfma_f32_32x32x16_bf16 a[0:15], v[64:67], v[80:83], a[0:15]
    ds_read_b64 v[64:65], v17 offset:3584
    ds_read_b64 v[66:67], v17 offset:3592
    ds_read_b128 v[72:75], v19 offset:7040
    ds_read_b128 v[80:83], v19 offset:4480
    s_waitcnt lgkmcnt(4)
    v_mfma_f32_32x32x16_bf16 a[16:31], v[68:71], v[76:79], a[16:31]
    v_mfma_f32_32x32x16_bf16 a[0:15], v[68:71], v[84:87], a[0:15]
    ds_read_b64 v[68:69], v17 offset:3616
    ds_read_b64 v[70:71], v17 offset:3624
    ds_read_b128 v[76:79], v19 offset:7072
    ds_read_b128 v[84:87], v19 offset:4512
    s_waitcnt lgkmcnt(4)
    v_mfma_f32_32x32x16_bf16 a[16:31], v[64:67], v[72:75], a[16:31]
    v_mfma_f32_32x32x16_bf16 a[0:15], v[64:67], v[80:83], a[0:15]
    ds_read_b64 v[64:65], v17 offset:3456
    ds_read_b64 v[66:67], v17 offset:3464
    ds_read_b128 v[72:75], v19 offset:6880
    ds_read_b128 v[80:83], v19 offset:4320
    s_waitcnt lgkmcnt(4)
    v_mfma_f32_32x32x16_bf16 a[16:31], v[68:71], v[76:79], a[16:31]
    v_mfma_f32_32x32x16_bf16 a[0:15], v[68:71], v[84:87], a[0:15]
    ds_read_b64 v[68:69], v17 offset:3488
    ds_read_b64 v[70:71], v17 offset:3496
    ds_read_b128 v[76:79], v19 offset:6912
    ds_read_b128 v[84:87], v19 offset:4352
    s_waitcnt lgkmcnt(4)
    v_mfma_f32_32x32x16_bf16 a[16:31], v[64:67], v[72:75], a[16:31]
    v_mfma_f32_32x32x16_bf16 a[0:15], v[64:67], v[80:83], a[0:15]
    ds_read_b64 v[64:65], v17 offset:3328
    ds_read_b64 v[66:67], v17 offset:3336
    ds_read_b128 v[72:75], v19 offset:6720
    ds_read_b128 v[80:83], v19 offset:4160
    s_waitcnt lgkmcnt(4)
    v_mfma_f32_32x32x16_bf16 a[16:31], v[68:71], v[76:79], a[16:31]
    v_mfma_f32_32x32x16_bf16 a[0:15], v[68:71], v[84:87], a[0:15]
    ds_read_b64 v[68:69], v17 offset:3360
    ds_read_b64 v[70:71], v17 offset:3368
    ds_read_b128 v[76:79], v19 offset:6752
    ds_read_b128 v[84:87], v19 offset:4192
    s_waitcnt lgkmcnt(4)
    v_mfma_f32_32x32x16_bf16 a[16:31], v[64:67], v[72:75], a[16:31]
    v_mfma_f32_32x32x16_bf16 a[0:15], v[64:67], v[80:83], a[0:15]
    ds_read_b64 v[64:65], v17 offset:3200
    ds_read_b64 v[66:67], v17 offset:3208
    ds_read_b128 v[72:75], v19 offset:6560
    ds_read_b128 v[80:83], v19 offset:4000
    s_waitcnt lgkmcnt(4)
    v_mfma_f32_32x32x16_bf16 a[16:31], v[68:71], v[76:79], a[16:31]
    v_mfma_f32_32x32x16_bf16 a[0:15], v[68:71], v[84:87], a[0:15]
    ds_read_b64 v[68:69], v17 offset:3232
    ds_read_b64 v[70:71], v17 offset:3240
    ds_read_b128 v[76:79], v19 offset:6592
    ds_read_b128 v[84:87], v19 offset:4032
    s_waitcnt lgkmcnt(4)
    v_mfma_f32_32x32x16_bf16 a[16:31], v[64:67], v[72:75], a[16:31]
    v_mfma_f32_32x32x16_bf16 a[0:15], v[64:67], v[80:83], a[0:15]
    ds_read_b64 v[64:65], v17 offset:3072
    ds_read_b64 v[66:67], v17 offset:3080
    ds_read_b128 v[72:75], v19 offset:6400
    ds_read_b128 v[80:83], v19 offset:3840
    s_waitcnt lgkmcnt(4)
    v_mfma_f32_32x32x16_bf16 a[16:31], v[68:71], v[76:79], a[16:31]
    v_mfma_f32_32x32x16_bf16 a[0:15], v[68:71], v[84:87], a[0:15]
    ds_read_b64 v[68:69], v17 offset:3104
    ds_read_b64 v[70:71], v17 offset:3112
    ds_read_b128 v[76:79], v19 offset:6432
    ds_read_b128 v[84:87], v19 offset:3872
    s_waitcnt lgkmcnt(4)
    v_mfma_f32_32x32x16_bf16 a[16:31], v[64:67], v[72:75], a[16:31]
    v_mfma_f32_32x32x16_bf16 a[0:15], v[64:67], v[80:83], a[0:15]
    ds_read_b64 v[64:65], v17 offset:2944
    ds_read_b64 v[66:67], v17 offset:2952
    ds_read_b128 v[72:75], v19 offset:6240
    ds_read_b128 v[80:83], v19 offset:3680
    s_waitcnt lgkmcnt(4)
    v_mfma_f32_32x32x16_bf16 a[16:31], v[68:71], v[76:79], a[16:31]
    v_mfma_f32_32x32x16_bf16 a[0:15], v[68:71], v[84:87], a[0:15]
    ds_read_b64 v[68:69], v17 offset:2976
    ds_read_b64 v[70:71], v17 offset:2984
    ds_read_b128 v[76:79], v19 offset:6272
    ds_read_b128 v[84:87], v19 offset:3712
    s_waitcnt lgkmcnt(4)
    v_mfma_f32_32x32x16_bf16 a[16:31], v[64:67], v[72:75], a[16:31]
    v_mfma_f32_32x32x16_bf16 a[0:15], v[64:67], v[80:83], a[0:15]
    ds_read_b64 v[64:65], v17 offset:2816
    ds_read_b64 v[66:67], v17 offset:2824
    ds_read_b128 v[72:75], v19 offset:6080
    ds_read_b128 v[80:83], v19 offset:3520
    s_waitcnt lgkmcnt(4)
    v_mfma_f32_32x32x16_bf16 a[16:31], v[68:71], v[76:79], a[16:31]
    v_mfma_f32_32x32x16_bf16 a[0:15], v[68:71], v[84:87], a[0:15]
    ds_read_b64 v[68:69], v17 offset:2848
    ds_read_b64 v[70:71], v17 offset:2856
    ds_read_b128 v[76:79], v19 offset:6112
    ds_read_b128 v[84:87], v19 offset:3552
    s_waitcnt lgkmcnt(4)
    v_mfma_f32_32x32x16_bf16 a[16:31], v[64:67], v[72:75], a[16:31]
    v_mfma_f32_32x32x16_bf16 a[0:15], v[64:67], v[80:83], a[0:15]
    ds_read_b64 v[64:65], v17 offset:2688
    ds_read_b64 v[66:67], v17 offset:2696
    ds_read_b128 v[72:75], v19 offset:5920
    ds_read_b128 v[80:83], v19 offset:3360
    s_waitcnt lgkmcnt(4)
    v_mfma_f32_32x32x16_bf16 a[16:31], v[68:71], v[76:79], a[16:31]
    v_mfma_f32_32x32x16_bf16 a[0:15], v[68:71], v[84:87], a[0:15]
    ds_read_b64 v[68:69], v17 offset:2720
    ds_read_b64 v[70:71], v17 offset:2728
    ds_read_b128 v[76:79], v19 offset:5952
    ds_read_b128 v[84:87], v19 offset:3392
    s_waitcnt lgkmcnt(4)
    v_mfma_f32_32x32x16_bf16 a[16:31], v[64:67], v[72:75], a[16:31]
    v_mfma_f32_32x32x16_bf16 a[0:15], v[64:67], v[80:83], a[0:15]
    ds_read_b64 v[64:65], v17 offset:2560
    ds_read_b64 v[66:67], v17 offset:2568
    ds_read_b128 v[72:75], v19 offset:5760
    ds_read_b128 v[80:83], v19 offset:3200
    s_waitcnt lgkmcnt(4)
    v_mfma_f32_32x32x16_bf16 a[16:31], v[68:71], v[76:79], a[16:31]
    v_mfma_f32_32x32x16_bf16 a[0:15], v[68:71], v[84:87], a[0:15]
    ds_read_b64 v[68:69], v17 offset:2592
    ds_read_b64 v[70:71], v17 offset:2600
    ds_read_b128 v[76:79], v19 offset:5792
    ds_read_b128 v[84:87], v19 offset:3232
    s_waitcnt lgkmcnt(4)
    v_mfma_f32_32x32x16_bf16 a[16:31], v[64:67], v[72:75], a[16:31]
    v_mfma_f32_32x32x16_bf16 a[0:15], v[64:67], v[80:83], a[0:15]
    ds_read_b64 v[64:65], v17 offset:2432
    ds_read_b64 v[66:67], v17 offset:2440
    ds_read_b128 v[72:75], v19 offset:5600
    ds_read_b128 v[80:83], v19 offset:3040
    s_waitcnt lgkmcnt(4)
    v_mfma_f32_32x32x16_bf16 a[16:31], v[68:71], v[76:79], a[16:31]
    v_mfma_f32_32x32x16_bf16 a[0:15], v[68:71], v[84:87], a[0:15]
    ds_read_b64 v[68:69], v17 offset:2464
    ds_read_b64 v[70:71], v17 offset:2472
    ds_read_b128 v[76:79], v19 offset:5632
    ds_read_b128 v[84:87], v19 offset:3072
    s_waitcnt lgkmcnt(4)
    v_mfma_f32_32x32x16_bf16 a[16:31], v[64:67], v[72:75], a[16:31]
    v_mfma_f32_32x32x16_bf16 a[0:15], v[64:67], v[80:83], a[0:15]
    ds_read_b64 v[64:65], v17 offset:2304
    ds_read_b64 v[66:67], v17 offset:2312
    ds_read_b128 v[72:75], v19 offset:5440
    ds_read_b128 v[80:83], v19 offset:2880
    s_waitcnt lgkmcnt(4)
    v_mfma_f32_32x32x16_bf16 a[16:31], v[68:71], v[76:79], a[16:31]
    v_mfma_f32_32x32x16_bf16 a[0:15], v[68:71], v[84:87], a[0:15]
    ds_read_b64 v[68:69], v17 offset:2336
    ds_read_b64 v[70:71], v17 offset:2344
    ds_read_b128 v[76:79], v19 offset:5472
    ds_read_b128 v[84:87], v19 offset:2912
    s_waitcnt lgkmcnt(4)
    v_mfma_f32_32x32x16_bf16 a[16:31], v[64:67], v[72:75], a[16:31]
    v_mfma_f32_32x32x16_bf16 a[0:15], v[64:67], v[80:83], a[0:15]
    ds_read_b64 v[64:65], v17 offset:2176
    ds_read_b64 v[66:67], v17 offset:2184
    ds_read_b128 v[72:75], v19 offset:5280
    ds_read_b128 v[80:83], v19 offset:2720
    s_waitcnt lgkmcnt(4)
    v_mfma_f32_32x32x16_bf16 a[16:31], v[68:71], v[76:79], a[16:31]
    v_mfma_f32_32x32x16_bf16 a[0:15], v[68:71], v[84:87], a[0:15]
    ds_read_b64 v[68:69], v17 offset:2208
    ds_read_b64 v[70:71], v17 offset:2216
    ds_read_b128 v[76:79], v19 offset:5312
    ds_read_b128 v[84:87], v19 offset:2752
    s_waitcnt lgkmcnt(4)
    v_mfma_f32_32x32x16_bf16 a[16:31], v[64:67], v[72:75], a[16:31]
    v_mfma_f32_32x32x16_bf16 a[0:15], v[64:67], v[80:83], a[0:15]
    ds_read_b64 v[64:65], v17 offset:2048
    ds_read_b64 v[66:67], v17 offset:2056
    ds_read_b128 v[72:75], v19 offset:5120
    ds_read_b128 v[80:83], v19 offset:2560
    s_waitcnt lgkmcnt(4)
    v_mfma_f32_32x32x16_bf16 a[16:31], v[68:71], v[76:79], a[16:31]
    v_mfma_f32_32x32x16_bf16 a[0:15], v[68:71], v[84:87], a[0:15]
    ds_read_b64 v[68:69], v17 offset:2080
    ds_read_b64 v[70:71], v17 offset:2088
    ds_read_b128 v[76:79], v19 offset:5152
    ds_read_b128 v[84:87], v19 offset:2592
    s_waitcnt lgkmcnt(4)
    v_mfma_f32_32x32x16_bf16 a[16:31], v[64:67], v[72:75], a[16:31]
    v_mfma_f32_32x32x16_bf16 a[0:15], v[64:67], v[80:83], a[0:15]
    ds_read_b64 v[64:65], v17 offset:1920
    ds_read_b64 v[66:67], v17 offset:1928
    ds_read_b128 v[72:75], v19 offset:4960
    s_waitcnt lgkmcnt(3)
    v_mfma_f32_32x32x16_bf16 a[16:31], v[68:71], v[76:79], a[16:31]
    v_mfma_f32_32x32x16_bf16 a[0:15], v[68:71], v[84:87], a[0:15]
    ds_read_b64 v[68:69], v17 offset:1952
    ds_read_b64 v[70:71], v17 offset:1960
    ds_read_b128 v[76:79], v19 offset:4992
    s_waitcnt lgkmcnt(3)
    v_mfma_f32_32x32x16_bf16 a[16:31], v[64:67], v[72:75], a[16:31]
    ds_read_b64 v[64:65], v17 offset:1792
    ds_read_b64 v[66:67], v17 offset:1800
    ds_read_b128 v[72:75], v19 offset:4800
    s_waitcnt lgkmcnt(3)
    v_mfma_f32_32x32x16_bf16 a[16:31], v[68:71], v[76:79], a[16:31]
    ds_read_b64 v[68:69], v17 offset:1824
    ds_read_b64 v[70:71], v17 offset:1832
    ds_read_b128 v[76:79], v19 offset:4832
    s_waitcnt lgkmcnt(3)
    v_mfma_f32_32x32x16_bf16 a[16:31], v[64:67], v[72:75], a[16:31]
    ds_read_b64 v[64:65], v17 offset:1664
    ds_read_b64 v[66:67], v17 offset:1672
    ds_read_b128 v[72:75], v19 offset:4640
    s_waitcnt lgkmcnt(3)
    v_mfma_f32_32x32x16_bf16 a[16:31], v[68:71], v[76:79], a[16:31]
    ds_read_b64 v[68:69], v17 offset:1696
    ds_read_b64 v[70:71], v17 offset:1704
    ds_read_b128 v[76:79], v19 offset:4672
    s_waitcnt lgkmcnt(3)
    v_mfma_f32_32x32x16_bf16 a[16:31], v[64:67], v[72:75], a[16:31]
    ds_read_b64 v[64:65], v17 offset:1536
    ds_read_b64 v[66:67], v17 offset:1544
    ds_read_b128 v[72:75], v19 offset:4480
    s_waitcnt lgkmcnt(3)
    v_mfma_f32_32x32x16_bf16 a[16:31], v[68:71], v[76:79], a[16:31]
    ds_read_b64 v[68:69], v17 offset:1568
    ds_read_b64 v[70:71], v17 offset:1576
    ds_read_b128 v[76:79], v19 offset:4512
    s_waitcnt lgkmcnt(3)
    v_mfma_f32_32x32x16_bf16 a[16:31], v[64:67], v[72:75], a[16:31]
    ds_read_b64 v[64:65], v17 offset:1408
    ds_read_b64 v[66:67], v17 offset:1416
    ds_read_b128 v[72:75], v19 offset:4320
    s_waitcnt lgkmcnt(3)
    v_mfma_f32_32x32x16_bf16 a[16:31], v[68:71], v[76:79], a[16:31]
    ds_read_b64 v[68:69], v17 offset:1440
    ds_read_b64 v[70:71], v17 offset:1448
    ds_read_b128 v[76:79], v19 offset:4352
    s_waitcnt lgkmcnt(3)
    v_mfma_f32_32x32x16_bf16 a[16:31], v[64:67], v[72:75], a[16:31]
    ds_read_b64 v[64:65], v17 offset:1280
    ds_read_b64 v[66:67], v17 offset:1288
    ds_read_b128 v[72:75], v19 offset:4160
    s_waitcnt lgkmcnt(3)
    v_mfma_f32_32x32x16_bf16 a[16:31], v[68:71], v[76:79], a[16:31]
    ds_read_b64 v[68:69], v17 offset:1312
    ds_read_b64 v[70:71], v17 offset:1320
    ds_read_b128 v[76:79], v19 offset:4192
    s_waitcnt lgkmcnt(3)
    v_mfma_f32_32x32x16_bf16 a[16:31], v[64:67], v[72:75], a[16:31]
    ds_read_b64 v[64:65], v17 offset:1152
    ds_read_b64 v[66:67], v17 offset:1160
    ds_read_b128 v[72:75], v19 offset:4000
    s_waitcnt lgkmcnt(3)
    v_mfma_f32_32x32x16_bf16 a[16:31], v[68:71], v[76:79], a[16:31]
    ds_read_b64 v[68:69], v17 offset:1184
    ds_read_b64 v[70:71], v17 offset:1192
    ds_read_b128 v[76:79], v19 offset:4032
    s_waitcnt lgkmcnt(3)
    v_mfma_f32_32x32x16_bf16 a[16:31], v[64:67], v[72:75], a[16:31]
    ds_read_b64 v[64:65], v17 offset:1024
    ds_read_b64 v[66:67], v17 offset:1032
    ds_read_b128 v[72:75], v19 offset:3840
    s_waitcnt lgkmcnt(3)
    v_mfma_f32_32x32x16_bf16 a[16:31], v[68:71], v[76:79], a[16:31]
    ds_read_b64 v[68:69], v17 offset:1056
    ds_read_b64 v[70:71], v17 offset:1064
    ds_read_b128 v[76:79], v19 offset:3872
    s_waitcnt lgkmcnt(3)
    v_mfma_f32_32x32x16_bf16 a[16:31], v[64:67], v[72:75], a[16:31]
    ds_read_b64 v[64:65], v17 offset:896
    ds_read_b64 v[66:67], v17 offset:904
    ds_read_b128 v[72:75], v19 offset:3680
    s_waitcnt lgkmcnt(3)
    v_mfma_f32_32x32x16_bf16 a[16:31], v[68:71], v[76:79], a[16:31]
    ds_read_b64 v[68:69], v17 offset:928
    ds_read_b64 v[70:71], v17 offset:936
    ds_read_b128 v[76:79], v19 offset:3712
    s_waitcnt lgkmcnt(3)
    v_mfma_f32_32x32x16_bf16 a[16:31], v[64:67], v[72:75], a[16:31]
    ds_read_b64 v[64:65], v17 offset:768
    ds_read_b64 v[66:67], v17 offset:776
    ds_read_b128 v[72:75], v19 offset:3520
    s_waitcnt lgkmcnt(3)
    v_mfma_f32_32x32x16_bf16 a[16:31], v[68:71], v[76:79], a[16:31]
    ds_read_b64 v[68:69], v17 offset:800
    ds_read_b64 v[70:71], v17 offset:808
    ds_read_b128 v[76:79], v19 offset:3552
    s_waitcnt lgkmcnt(3)
    v_mfma_f32_32x32x16_bf16 a[16:31], v[64:67], v[72:75], a[16:31]
    ds_read_b64 v[64:65], v17 offset:640
    ds_read_b64 v[66:67], v17 offset:648
    ds_read_b128 v[72:75], v19 offset:3360
    s_waitcnt lgkmcnt(3)
    v_mfma_f32_32x32x16_bf16 a[16:31], v[68:71], v[76:79], a[16:31]
    ds_read_b64 v[68:69], v17 offset:672
    ds_read_b64 v[70:71], v17 offset:680
    ds_read_b128 v[76:79], v19 offset:3392
    s_waitcnt lgkmcnt(3)
    v_mfma_f32_32x32x16_bf16 a[16:31], v[64:67], v[72:75], a[16:31]
    ds_read_b64 v[64:65], v17 offset:512
    ds_read_b64 v[66:67], v17 offset:520
    ds_read_b128 v[72:75], v19 offset:3200
    s_waitcnt lgkmcnt(3)
    v_mfma_f32_32x32x16_bf16 a[16:31], v[68:71], v[76:79], a[16:31]
    ds_read_b64 v[68:69], v17 offset:544
    ds_read_b64 v[70:71], v17 offset:552
    ds_read_b128 v[76:79], v19 offset:3232
    s_waitcnt lgkmcnt(3)
    v_mfma_f32_32x32x16_bf16 a[16:31], v[64:67], v[72:75], a[16:31]
    ds_read_b64 v[64:65], v17 offset:384
    ds_read_b64 v[66:67], v17 offset:392
    ds_read_b128 v[72:75], v19 offset:3040
    s_waitcnt lgkmcnt(3)
    v_mfma_f32_32x32x16_bf16 a[16:31], v[68:71], v[76:79], a[16:31]
    ds_read_b64 v[68:69], v17 offset:416
    ds_read_b64 v[70:71], v17 offset:424
    ds_read_b128 v[76:79], v19 offset:3072
    s_waitcnt lgkmcnt(3)
    v_mfma_f32_32x32x16_bf16 a[16:31], v[64:67], v[72:75], a[16:31]
    ds_read_b64 v[64:65], v17 offset:256
    ds_read_b64 v[66:67], v17 offset:264
    ds_read_b128 v[72:75], v19 offset:2880
    s_waitcnt lgkmcnt(3)
    v_mfma_f32_32x32x16_bf16 a[16:31], v[68:71], v[76:79], a[16:31]
    ds_read_b64 v[68:69], v17 offset:288
    ds_read_b64 v[70:71], v17 offset:296
    ds_read_b128 v[76:79], v19 offset:2912
    s_waitcnt lgkmcnt(3)
    v_mfma_f32_32x32x16_bf16 a[16:31], v[64:67], v[72:75], a[16:31]
    ds_read_b64 v[64:65], v17 offset:128
    ds_read_b64 v[66:67], v17 offset:136
    ds_read_b128 v[72:75], v19 offset:2720
    s_waitcnt lgkmcnt(3)
    v_mfma_f32_32x32x16_bf16 a[16:31], v[68:71], v[76:79], a[16:31]
    ds_read_b64 v[68:69], v17 offset:160
    ds_read_b64 v[70:71], v17 offset:168
    ds_read_b128 v[76:79], v19 offset:2752
    s_waitcnt lgkmcnt(3)
    v_mfma_f32_32x32x16_bf16 a[16:31], v[64:67], v[72:75], a[16:31]
    ds_read_b64 v[64:65], v17 offset:0
    ds_read_b64 v[66:67], v17 offset:8
    ds_read_b128 v[72:75], v19 offset:2560
    s_waitcnt lgkmcnt(3)
    v_mfma_f32_32x32x16_bf16 a[16:31], v[68:71], v[76:79], a[16:31]
    ds_read_b64 v[68:69], v17 offset:32
    ds_read_b64 v[70:71], v17 offset:40
    ds_read_b128 v[76:79], v19 offset:2592
    s_waitcnt lgkmcnt(3)
    v_mfma_f32_32x32x16_bf16 a[16:31], v[64:67], v[72:75], a[16:31]
    s_waitcnt lgkmcnt(0)
    v_mfma_f32_32x32x16_bf16 a[16:31], v[68:71], v[76:79], a[16:31]
    s_nop 15
    s_barrier
    v_lshlrev_b32 v20, 13, v2
    v_lshlrev_b32 v21, 7, v12
    v_lshlrev_b32 v22, 4, v13
    v_add3_u32 v20, v20, v21, v22
    v_accvgpr_read_b32 v64, a0
    v_accvgpr_read_b32 v65, a1
    v_accvgpr_read_b32 v66, a2
    v_accvgpr_read_b32 v67, a3
    ds_write_b128 v20, v[64:67] offset:0
    v_accvgpr_read_b32 v64, a4
    v_accvgpr_read_b32 v65, a5
    v_accvgpr_read_b32 v66, a6
    v_accvgpr_read_b32 v67, a7
    ds_write_b128 v20, v[64:67] offset:32
    v_accvgpr_read_b32 v64, a8
    v_accvgpr_read_b32 v65, a9
    v_accvgpr_read_b32 v66, a10
    v_accvgpr_read_b32 v67, a11
    ds_write_b128 v20, v[64:67] offset:64
    v_accvgpr_read_b32 v64, a12
    v_accvgpr_read_b32 v65, a13
    v_accvgpr_read_b32 v66, a14
    v_accvgpr_read_b32 v67, a15
    ds_write_b128 v20, v[64:67] offset:96
    v_accvgpr_read_b32 v64, a16
    v_accvgpr_read_b32 v65, a17
    v_accvgpr_read_b32 v66, a18
    v_accvgpr_read_b32 v67, a19
    ds_write_b128 v20, v[64:67] offset:4096
    v_accvgpr_read_b32 v64, a20
    v_accvgpr_read_b32 v65, a21
    v_accvgpr_read_b32 v66, a22
    v_accvgpr_read_b32 v67, a23
    ds_write_b128 v20, v[64:67] offset:4128
    v_accvgpr_read_b32 v64, a24
    v_accvgpr_read_b32 v65, a25
    v_accvgpr_read_b32 v66, a26
    v_accvgpr_read_b32 v67, a27
    ds_write_b128 v20, v[64:67] offset:4160
    v_accvgpr_read_b32 v64, a28
    v_accvgpr_read_b32 v65, a29
    v_accvgpr_read_b32 v66, a30
    v_accvgpr_read_b32 v67, a31
    ds_write_b128 v20, v[64:67] offset:4192
    s_waitcnt lgkmcnt(0)
    s_barrier
    v_lshlrev_b32 v21, 5, v0
    ds_read_b128 v[64:67], v21 offset:0
    ds_read_b128 v[68:71], v21 offset:16
    ds_read_b128 v[72:75], v21 offset:8192
    ds_read_b128 v[76:79], v21 offset:8208
    ds_read_b128 v[80:83], v21 offset:16384
    ds_read_b128 v[84:87], v21 offset:16400
    ds_read_b128 v[88:91], v21 offset:24576
    ds_read_b128 v[92:95], v21 offset:24592
    v_lshlrev_b32 v36, 16, v36
    s_waitcnt lgkmcnt(0) vmcnt(0)
    v_add_f32 v64, v64, v72
    v_add_f32 v80, v80, v88
    v_add_f32 v64, v64, v80
    v_add_f32 v65, v65, v73
    v_add_f32 v81, v81, v89
    v_add_f32 v65, v65, v81
    v_add_f32 v66, v66, v74
    v_add_f32 v82, v82, v90
    v_add_f32 v66, v66, v82
    v_add_f32 v67, v67, v75
    v_add_f32 v83, v83, v91
    v_add_f32 v67, v67, v83
    v_add_f32 v68, v68, v76
    v_add_f32 v84, v84, v92
    v_add_f32 v68, v68, v84
    v_add_f32 v69, v69, v77
    v_add_f32 v85, v85, v93
    v_add_f32 v69, v69, v85
    v_add_f32 v70, v70, v78
    v_add_f32 v86, v86, v94
    v_add_f32 v70, v70, v86
    v_add_f32 v71, v71, v79
    v_add_f32 v87, v87, v95
    v_add_f32 v71, v71, v87
    v_cvt_pk_bf16_f32 v10, v64, v65
    v_lshlrev_b32 v11, 16, v28
    v_and_b32 v12, 0xffff0000, v28
    v_mul_f32 v11, v11, v36
    v_mul_f32 v12, v12, v36
    v_cvt_pk_bf16_f32 v11, v11, v12
    v_lshlrev_b32 v13, 16, v10
    v_and_b32 v14, 0xffff0000, v10
    v_lshlrev_b32 v15, 16, v11
    v_and_b32 v16, 0xffff0000, v11
    v_add_f32 v13, v13, v15
    v_add_f32 v14, v14, v16
    v_cvt_pk_bf16_f32 v13, v13, v14
    v_and_b32 v14, 0xffff0000, v13
    v_lshlrev_b32 v13, 16, v13
    v_mul_f32 v13, s12, v13
    v_mul_f32 v14, s12, v14
    v_cvt_pk_bf16_f32 v13, v13, v14
    v_and_b32 v14, 0xffff0000, v13
    v_lshlrev_b32 v13, 16, v13
    v_lshlrev_b32 v15, 16, v32
    v_and_b32 v16, 0xffff0000, v32
    v_add_f32 v13, v13, v15
    v_add_f32 v14, v14, v16
    v_cvt_pk_bf16_f32 v40, v13, v14
    v_cvt_pk_bf16_f32 v10, v66, v67
    v_lshlrev_b32 v11, 16, v29
    v_and_b32 v12, 0xffff0000, v29
    v_mul_f32 v11, v11, v36
    v_mul_f32 v12, v12, v36
    v_cvt_pk_bf16_f32 v11, v11, v12
    v_lshlrev_b32 v13, 16, v10
    v_and_b32 v14, 0xffff0000, v10
    v_lshlrev_b32 v15, 16, v11
    v_and_b32 v16, 0xffff0000, v11
    v_add_f32 v13, v13, v15
    v_add_f32 v14, v14, v16
    v_cvt_pk_bf16_f32 v13, v13, v14
    v_and_b32 v14, 0xffff0000, v13
    v_lshlrev_b32 v13, 16, v13
    v_mul_f32 v13, s12, v13
    v_mul_f32 v14, s12, v14
    v_cvt_pk_bf16_f32 v13, v13, v14
    v_and_b32 v14, 0xffff0000, v13
    v_lshlrev_b32 v13, 16, v13
    v_lshlrev_b32 v15, 16, v33
    v_and_b32 v16, 0xffff0000, v33
    v_add_f32 v13, v13, v15
    v_add_f32 v14, v14, v16
    v_cvt_pk_bf16_f32 v41, v13, v14
    v_cvt_pk_bf16_f32 v10, v68, v69
    v_lshlrev_b32 v11, 16, v30
    v_and_b32 v12, 0xffff0000, v30
    v_mul_f32 v11, v11, v36
    v_mul_f32 v12, v12, v36
    v_cvt_pk_bf16_f32 v11, v11, v12
    v_lshlrev_b32 v13, 16, v10
    v_and_b32 v14, 0xffff0000, v10
    v_lshlrev_b32 v15, 16, v11
    v_and_b32 v16, 0xffff0000, v11
    v_add_f32 v13, v13, v15
    v_add_f32 v14, v14, v16
    v_cvt_pk_bf16_f32 v13, v13, v14
    v_and_b32 v14, 0xffff0000, v13
    v_lshlrev_b32 v13, 16, v13
    v_mul_f32 v13, s12, v13
    v_mul_f32 v14, s12, v14
    v_cvt_pk_bf16_f32 v13, v13, v14
    v_and_b32 v14, 0xffff0000, v13
    v_lshlrev_b32 v13, 16, v13
    v_lshlrev_b32 v15, 16, v34
    v_and_b32 v16, 0xffff0000, v34
    v_add_f32 v13, v13, v15
    v_add_f32 v14, v14, v16
    v_cvt_pk_bf16_f32 v42, v13, v14
    v_cvt_pk_bf16_f32 v10, v70, v71
    v_lshlrev_b32 v11, 16, v31
    v_and_b32 v12, 0xffff0000, v31
    v_mul_f32 v11, v11, v36
    v_mul_f32 v12, v12, v36
    v_cvt_pk_bf16_f32 v11, v11, v12
    v_lshlrev_b32 v13, 16, v10
    v_and_b32 v14, 0xffff0000, v10
    v_lshlrev_b32 v15, 16, v11
    v_and_b32 v16, 0xffff0000, v11
    v_add_f32 v13, v13, v15
    v_add_f32 v14, v14, v16
    v_cvt_pk_bf16_f32 v13, v13, v14
    v_and_b32 v14, 0xffff0000, v13
    v_lshlrev_b32 v13, 16, v13
    v_mul_f32 v13, s12, v13
    v_mul_f32 v14, s12, v14
    v_cvt_pk_bf16_f32 v13, v13, v14
    v_and_b32 v14, 0xffff0000, v13
    v_lshlrev_b32 v13, 16, v13
    v_lshlrev_b32 v15, 16, v35
    v_and_b32 v16, 0xffff0000, v35
    v_add_f32 v13, v13, v15
    v_add_f32 v14, v14, v16
    v_cvt_pk_bf16_f32 v43, v13, v14
    v_add_u32 v5, 4734976, v4
    global_store_dwordx4 v5, v[40:43], s[18:19]
conv_end:
    s_endpgm
.text
.globl ln2_kernel
.p2align 8
.type ln2_kernel,@function
ln2_kernel:
    s_cmp_ge_u32 s2, 32
    s_cbranch_scc1 ln2_end
    s_load_dwordx2 s[18:19], s[0:1], 128
    v_and_b32 v1, 63, v0
    v_lshrrev_b32 v2, 6, v0
    s_lshl_b32 s22, s2, 6
    v_add_u32 v3, s22, v1
    v_mul_u32_u24 v4, 147456, v2
    v_lshl_add_u32 v4, v3, 1, v4
    v_add_u32 v4, 4734976, v4
    v_mul_u32_u24 v14, 144, v2
    v_add_u32 v15, 9216, v14
    v_add_u32 v16, 6912, v14
    s_waitcnt lgkmcnt(0)
    global_load_ushort v20, v4, s[18:19]
    v_add_u32 v4, 4096, v4
    global_load_ushort v21, v4, s[18:19]
    v_add_u32 v4, 4096, v4
    global_load_ushort v22, v4, s[18:19]
    v_add_u32 v4, 4096, v4
    global_load_ushort v23, v4, s[18:19]
    v_add_u32 v4, 4096, v4
    global_load_ushort v24, v4, s[18:19]
    v_add_u32 v4, 4096, v4
    global_load_ushort v25, v4, s[18:19]
    v_add_u32 v4, 4096, v4
    global_load_ushort v26, v4, s[18:19]
    v_add_u32 v4, 4096, v4
    global_load_ushort v27, v4, s[18:19]
    v_add_u32 v4, 4096, v4
    global_load_ushort v28, v4, s[18:19]
    v_add_u32 v4, 4096, v4
    global_load_ushort v29, v4, s[18:19]
    v_add_u32 v4, 4096, v4
    global_load_ushort v30, v4, s[18:19]
    v_add_u32 v4, 4096, v4
    global_load_ushort v31, v4, s[18:19]
    v_add_u32 v4, 4096, v4
    global_load_ushort v32, v4, s[18:19]
    v_add_u32 v4, 4096, v4
    global_load_ushort v33, v4, s[18:19]
    v_add_u32 v4, 4096, v4
    global_load_ushort v34, v4, s[18:19]
    v_add_u32 v4, 4096, v4
    global_load_ushort v35, v4, s[18:19]
    v_add_u32 v4, 4096, v4
    global_load_ushort v36, v4, s[18:19]
    v_add_u32 v4, 4096, v4
    global_load_ushort v37, v4, s[18:19]
    v_add_u32 v4, 4096, v4
    global_load_ushort v38, v4, s[18:19]
    v_add_u32 v4, 4096, v4
    global_load_ushort v39, v4, s[18:19]
    v_add_u32 v4, 4096, v4
    global_load_ushort v40, v4, s[18:19]
    v_add_u32 v4, 4096, v4
    global_load_ushort v41, v4, s[18:19]
    v_add_u32 v4, 4096, v4
    global_load_ushort v42, v4, s[18:19]
    v_add_u32 v4, 4096, v4
    global_load_ushort v43, v4, s[18:19]
    v_add_u32 v4, 4096, v4
    global_load_ushort v44, v4, s[18:19]
    v_add_u32 v4, 4096, v4
    global_load_ushort v45, v4, s[18:19]
    v_add_u32 v4, 4096, v4
    global_load_ushort v46, v4, s[18:19]
    v_add_u32 v4, 4096, v4
    global_load_ushort v47, v4, s[18:19]
    v_add_u32 v4, 4096, v4
    global_load_ushort v48, v4, s[18:19]
    v_add_u32 v4, 4096, v4
    global_load_ushort v49, v4, s[18:19]
    v_add_u32 v4, 4096, v4
    global_load_ushort v50, v4, s[18:19]
    v_add_u32 v4, 4096, v4
    global_load_ushort v51, v4, s[18:19]
    v_add_u32 v4, 4096, v4
    global_load_ushort v52, v4, s[18:19]
    v_add_u32 v4, 4096, v4
    global_load_ushort v53, v4, s[18:19]
    v_add_u32 v4, 4096, v4
    global_load_ushort v54, v4, s[18:19]
    v_add_u32 v4, 4096, v4
    global_load_ushort v55, v4, s[18:19]
    global_load_dwordx4 v[56:59], v15, s[18:19] offset:0
    global_load_dwordx4 v[92:95], v16, s[18:19] offset:0
    global_load_dwordx4 v[60:63], v15, s[18:19] offset:16
    global_load_dwordx4 v[96:99], v16, s[18:19] offset:16
    global_load_dwordx4 v[64:67], v15, s[18:19] offset:32
    global_load_dwordx4 v[100:103], v16, s[18:19] offset:32
    global_load_dwordx4 v[68:71], v15, s[18:19] offset:48
    global_load_dwordx4 v[104:107], v16, s[18:19] offset:48
    global_load_dwordx4 v[72:75], v15, s[18:19] offset:64
    global_load_dwordx4 v[108:111], v16, s[18:19] offset:64
    global_load_dwordx4 v[76:79], v15, s[18:19] offset:80
    global_load_dwordx4 v[112:115], v16, s[18:19] offset:80
    global_load_dwordx4 v[80:83], v15, s[18:19] offset:96
    global_load_dwordx4 v[116:119], v16, s[18:19] offset:96
    global_load_dwordx4 v[84:87], v15, s[18:19] offset:112
    global_load_dwordx4 v[120:123], v16, s[18:19] offset:112
    global_load_dwordx4 v[88:91], v15, s[18:19] offset:128
    global_load_dwordx4 v[124:127], v16, s[18:19] offset:128
    s_waitcnt vmcnt(18)
    v_mov_b32 v7, 0
    v_lshlrev_b32 v20, 16, v20
    v_add_f32 v7, v7, v20
    v_lshlrev_b32 v21, 16, v21
    v_add_f32 v7, v7, v21
    v_lshlrev_b32 v22, 16, v22
    v_add_f32 v7, v7, v22
    v_lshlrev_b32 v23, 16, v23
    v_add_f32 v7, v7, v23
    v_lshlrev_b32 v24, 16, v24
    v_add_f32 v7, v7, v24
    v_lshlrev_b32 v25, 16, v25
    v_add_f32 v7, v7, v25
    v_lshlrev_b32 v26, 16, v26
    v_add_f32 v7, v7, v26
    v_lshlrev_b32 v27, 16, v27
    v_add_f32 v7, v7, v27
    v_lshlrev_b32 v28, 16, v28
    v_add_f32 v7, v7, v28
    v_lshlrev_b32 v29, 16, v29
    v_add_f32 v7, v7, v29
    v_lshlrev_b32 v30, 16, v30
    v_add_f32 v7, v7, v30
    v_lshlrev_b32 v31, 16, v31
    v_add_f32 v7, v7, v31
    v_lshlrev_b32 v32, 16, v32
    v_add_f32 v7, v7, v32
    v_lshlrev_b32 v33, 16, v33
    v_add_f32 v7, v7, v33
    v_lshlrev_b32 v34, 16, v34
    v_add_f32 v7, v7, v34
    v_lshlrev_b32 v35, 16, v35
    v_add_f32 v7, v7, v35
    v_lshlrev_b32 v36, 16, v36
    v_add_f32 v7, v7, v36
    v_lshlrev_b32 v37, 16, v37
    v_add_f32 v7, v7, v37
    v_lshlrev_b32 v38, 16, v38
    v_add_f32 v7, v7, v38
    v_lshlrev_b32 v39, 16, v39
    v_add_f32 v7, v7, v39
    v_lshlrev_b32 v40, 16, v40
    v_add_f32 v7, v7, v40
    v_lshlrev_b32 v41, 16, v41
    v_add_f32 v7, v7, v41
    v_lshlrev_b32 v42, 16, v42
    v_add_f32 v7, v7, v42
    v_lshlrev_b32 v43, 16, v43
    v_add_f32 v7, v7, v43
    v_lshlrev_b32 v44, 16, v44
    v_add_f32 v7, v7, v44
    v_lshlrev_b32 v45, 16, v45
    v_add_f32 v7, v7, v45
    v_lshlrev_b32 v46, 16, v46
    v_add_f32 v7, v7, v46
    v_lshlrev_b32 v47, 16, v47
    v_add_f32 v7, v7, v47
    v_lshlrev_b32 v48, 16, v48
    v_add_f32 v7, v7, v48
    v_lshlrev_b32 v49, 16, v49
    v_add_f32 v7, v7, v49
    v_lshlrev_b32 v50, 16, v50
    v_add_f32 v7, v7, v50
    v_lshlrev_b32 v51, 16, v51
    v_add_f32 v7, v7, v51
    v_lshlrev_b32 v52, 16, v52
    v_add_f32 v7, v7, v52
    v_lshlrev_b32 v53, 16, v53
    v_add_f32 v7, v7, v53
    v_lshlrev_b32 v54, 16, v54
    v_add_f32 v7, v7, v54
    v_lshlrev_b32 v55, 16, v55
    v_add_f32 v7, v7, v55
    v_lshlrev_b32 v10, 2, v0
    v_lshlrev_b32 v11, 2, v1
    ds_write_b32 v10, v7
    s_waitcnt lgkmcnt(0)
    s_barrier
    v_mov_b32 v8, 0
    ds_read_b32 v9, v11 offset:0
    s_waitcnt lgkmcnt(0)
    v_add_f32 v8, v8, v9
    ds_read_b32 v9, v11 offset:256
    s_waitcnt lgkmcnt(0)
    v_add_f32 v8, v8, v9
    ds_read_b32 v9, v11 offset:512
    s_waitcnt lgkmcnt(0)
    v_add_f32 v8, v8, v9
    ds_read_b32 v9, v11 offset:768
    s_waitcnt lgkmcnt(0)
    v_add_f32 v8, v8, v9
    ds_read_b32 v9, v11 offset:1024
    s_waitcnt lgkmcnt(0)
    v_add_f32 v8, v8, v9
    ds_read_b32 v9, v11 offset:1280
    s_waitcnt lgkmcnt(0)
    v_add_f32 v8, v8, v9
    ds_read_b32 v9, v11 offset:1536
    s_waitcnt lgkmcnt(0)
    v_add_f32 v8, v8, v9
    ds_read_b32 v9, v11 offset:1792
    s_waitcnt lgkmcnt(0)
    v_add_f32 v8, v8, v9
    ds_read_b32 v9, v11 offset:2048
    s_waitcnt lgkmcnt(0)
    v_add_f32 v8, v8, v9
    ds_read_b32 v9, v11 offset:2304
    s_waitcnt lgkmcnt(0)
    v_add_f32 v8, v8, v9
    ds_read_b32 v9, v11 offset:2560
    s_waitcnt lgkmcnt(0)
    v_add_f32 v8, v8, v9
    ds_read_b32 v9, v11 offset:2816
    s_waitcnt lgkmcnt(0)
    v_add_f32 v8, v8, v9
    ds_read_b32 v9, v11 offset:3072
    s_waitcnt lgkmcnt(0)
    v_add_f32 v8, v8, v9
    ds_read_b32 v9, v11 offset:3328
    s_waitcnt lgkmcnt(0)
    v_add_f32 v8, v8, v9
    ds_read_b32 v9, v11 offset:3584
    s_waitcnt lgkmcnt(0)
    v_add_f32 v8, v8, v9
    ds_read_b32 v9, v11 offset:3840
    s_waitcnt lgkmcnt(0)
    v_add_f32 v8, v8, v9
    s_mov_b32 s10, 0x3ae38e39
    v_mul_f32 v12, s10, v8
    v_mov_b32 v7, 0
    v_sub_f32 v8, v20, v12
    v_fma_f32 v7, v8, v8, v7
    v_sub_f32 v8, v21, v12
    v_fma_f32 v7, v8, v8, v7
    v_sub_f32 v8, v22, v12
    v_fma_f32 v7, v8, v8, v7
    v_sub_f32 v8, v23, v12
    v_fma_f32 v7, v8, v8, v7
    v_sub_f32 v8, v24, v12
    v_fma_f32 v7, v8, v8, v7
    v_sub_f32 v8, v25, v12
    v_fma_f32 v7, v8, v8, v7
    v_sub_f32 v8, v26, v12
    v_fma_f32 v7, v8, v8, v7
    v_sub_f32 v8, v27, v12
    v_fma_f32 v7, v8, v8, v7
    v_sub_f32 v8, v28, v12
    v_fma_f32 v7, v8, v8, v7
    v_sub_f32 v8, v29, v12
    v_fma_f32 v7, v8, v8, v7
    v_sub_f32 v8, v30, v12
    v_fma_f32 v7, v8, v8, v7
    v_sub_f32 v8, v31, v12
    v_fma_f32 v7, v8, v8, v7
    v_sub_f32 v8, v32, v12
    v_fma_f32 v7, v8, v8, v7
    v_sub_f32 v8, v33, v12
    v_fma_f32 v7, v8, v8, v7
    v_sub_f32 v8, v34, v12
    v_fma_f32 v7, v8, v8, v7
    v_sub_f32 v8, v35, v12
    v_fma_f32 v7, v8, v8, v7
    v_sub_f32 v8, v36, v12
    v_fma_f32 v7, v8, v8, v7
    v_sub_f32 v8, v37, v12
    v_fma_f32 v7, v8, v8, v7
    v_sub_f32 v8, v38, v12
    v_fma_f32 v7, v8, v8, v7
    v_sub_f32 v8, v39, v12
    v_fma_f32 v7, v8, v8, v7
    v_sub_f32 v8, v40, v12
    v_fma_f32 v7, v8, v8, v7
    v_sub_f32 v8, v41, v12
    v_fma_f32 v7, v8, v8, v7
    v_sub_f32 v8, v42, v12
    v_fma_f32 v7, v8, v8, v7
    v_sub_f32 v8, v43, v12
    v_fma_f32 v7, v8, v8, v7
    v_sub_f32 v8, v44, v12
    v_fma_f32 v7, v8, v8, v7
    v_sub_f32 v8, v45, v12
    v_fma_f32 v7, v8, v8, v7
    v_sub_f32 v8, v46, v12
    v_fma_f32 v7, v8, v8, v7
    v_sub_f32 v8, v47, v12
    v_fma_f32 v7, v8, v8, v7
    v_sub_f32 v8, v48, v12
    v_fma_f32 v7, v8, v8, v7
    v_sub_f32 v8, v49, v12
    v_fma_f32 v7, v8, v8, v7
    v_sub_f32 v8, v50, v12
    v_fma_f32 v7, v8, v8, v7
    v_sub_f32 v8, v51, v12
    v_fma_f32 v7, v8, v8, v7
    v_sub_f32 v8, v52, v12
    v_fma_f32 v7, v8, v8, v7
    v_sub_f32 v8, v53, v12
    v_fma_f32 v7, v8, v8, v7
    v_sub_f32 v8, v54, v12
    v_fma_f32 v7, v8, v8, v7
    v_sub_f32 v8, v55, v12
    v_fma_f32 v7, v8, v8, v7
    ds_write_b32 v10, v7 offset:4096
    s_waitcnt lgkmcnt(0)
    s_barrier
    v_mov_b32 v8, 0
    ds_read_b32 v9, v11 offset:4096
    s_waitcnt lgkmcnt(0)
    v_add_f32 v8, v8, v9
    ds_read_b32 v9, v11 offset:4352
    s_waitcnt lgkmcnt(0)
    v_add_f32 v8, v8, v9
    ds_read_b32 v9, v11 offset:4608
    s_waitcnt lgkmcnt(0)
    v_add_f32 v8, v8, v9
    ds_read_b32 v9, v11 offset:4864
    s_waitcnt lgkmcnt(0)
    v_add_f32 v8, v8, v9
    ds_read_b32 v9, v11 offset:5120
    s_waitcnt lgkmcnt(0)
    v_add_f32 v8, v8, v9
    ds_read_b32 v9, v11 offset:5376
    s_waitcnt lgkmcnt(0)
    v_add_f32 v8, v8, v9
    ds_read_b32 v9, v11 offset:5632
    s_waitcnt lgkmcnt(0)
    v_add_f32 v8, v8, v9
    ds_read_b32 v9, v11 offset:5888
    s_waitcnt lgkmcnt(0)
    v_add_f32 v8, v8, v9
    ds_read_b32 v9, v11 offset:6144
    s_waitcnt lgkmcnt(0)
    v_add_f32 v8, v8, v9
    ds_read_b32 v9, v11 offset:6400
    s_waitcnt lgkmcnt(0)
    v_add_f32 v8, v8, v9
    ds_read_b32 v9, v11 offset:6656
    s_waitcnt lgkmcnt(0)
    v_add_f32 v8, v8, v9
    ds_read_b32 v9, v11 offset:6912
    s_waitcnt lgkmcnt(0)
    v_add_f32 v8, v8, v9
    ds_read_b32 v9, v11 offset:7168
    s_waitcnt lgkmcnt(0)
    v_add_f32 v8, v8, v9
    ds_read_b32 v9, v11 offset:7424
    s_waitcnt lgkmcnt(0)
    v_add_f32 v8, v8, v9
    ds_read_b32 v9, v11 offset:7680
    s_waitcnt lgkmcnt(0)
    v_add_f32 v8, v8, v9
    ds_read_b32 v9, v11 offset:7936
    s_waitcnt lgkmcnt(0)
    v_add_f32 v8, v8, v9
    v_mul_f32 v13, s10, v8
    v_cvt_pk_bf16_f32 v12, v12, v12
    v_lshlrev_b32 v12, 16, v12
    v_cvt_pk_bf16_f32 v13, v13, v13
    v_lshlrev_b32 v13, 16, v13
    v_add_f32 v13, 0x3727c5ac, v13
    v_cvt_pk_bf16_f32 v13, v13, v13
    v_lshlrev_b32 v13, 16, v13
    v_sqrt_f32 v13, v13
    s_nop 0
    v_cvt_pk_bf16_f32 v13, v13, v13
    v_lshlrev_b32 v13, 16, v13
    v_rcp_f32 v13, v13
    s_waitcnt vmcnt(0)
    v_mul_u32_u24 v17, 1152, v3
    v_mul_u32_u24 v18, 72, v2
    v_add_u32 v17, v17, v18
    v_add_u32 v18, 7094272, v17
    v_add_u32 v17, 9453568, v17
    v_add_f32 v5, 1.0, v56
    v_add_f32 v6, 1.0, v57
    v_cvt_pk_bf16_f32 v5, v5, v6
    v_and_b32 v6, 0xffff0000, v5
    v_lshlrev_b32 v5, 16, v5
    v_sub_f32 v8, v20, v12
    v_sub_f32 v9, v21, v12
    v_cvt_pk_bf16_f32 v8, v8, v9
    v_and_b32 v9, 0xffff0000, v8
    v_lshlrev_b32 v8, 16, v8
    v_mul_f32 v8, v8, v13
    v_mul_f32 v9, v9, v13
    v_cvt_pk_bf16_f32 v8, v8, v9
    v_and_b32 v9, 0xffff0000, v8
    v_lshlrev_b32 v8, 16, v8
    v_mul_f32 v8, v8, v5
    v_mul_f32 v9, v9, v6
    v_cvt_pk_bf16_f32 v8, v8, v9
    v_and_b32 v9, 0xffff0000, v8
    v_lshlrev_b32 v8, 16, v8
    v_add_f32 v8, v8, v92
    v_add_f32 v9, v9, v93
    v_cvt_pk_bf16_f32 v56, v8, v9
    v_cvt_pk_bf16_f32 v57, v20, v21
    v_add_f32 v5, 1.0, v58
    v_add_f32 v6, 1.0, v59
    v_cvt_pk_bf16_f32 v5, v5, v6
    v_and_b32 v6, 0xffff0000, v5
    v_lshlrev_b32 v5, 16, v5
    v_sub_f32 v8, v22, v12
    v_sub_f32 v9, v23, v12
    v_cvt_pk_bf16_f32 v8, v8, v9
    v_and_b32 v9, 0xffff0000, v8
    v_lshlrev_b32 v8, 16, v8
    v_mul_f32 v8, v8, v13
    v_mul_f32 v9, v9, v13
    v_cvt_pk_bf16_f32 v8, v8, v9
    v_and_b32 v9, 0xffff0000, v8
    v_lshlrev_b32 v8, 16, v8
    v_mul_f32 v8, v8, v5
    v_mul_f32 v9, v9, v6
    v_cvt_pk_bf16_f32 v8, v8, v9
    v_and_b32 v9, 0xffff0000, v8
    v_lshlrev_b32 v8, 16, v8
    v_add_f32 v8, v8, v94
    v_add_f32 v9, v9, v95
    v_cvt_pk_bf16_f32 v58, v8, v9
    v_cvt_pk_bf16_f32 v59, v22, v23
    v_add_f32 v5, 1.0, v60
    v_add_f32 v6, 1.0, v61
    v_cvt_pk_bf16_f32 v5, v5, v6
    v_and_b32 v6, 0xffff0000, v5
    v_lshlrev_b32 v5, 16, v5
    v_sub_f32 v8, v24, v12
    v_sub_f32 v9, v25, v12
    v_cvt_pk_bf16_f32 v8, v8, v9
    v_and_b32 v9, 0xffff0000, v8
    v_lshlrev_b32 v8, 16, v8
    v_mul_f32 v8, v8, v13
    v_mul_f32 v9, v9, v13
    v_cvt_pk_bf16_f32 v8, v8, v9
    v_and_b32 v9, 0xffff0000, v8
    v_lshlrev_b32 v8, 16, v8
    v_mul_f32 v8, v8, v5
    v_mul_f32 v9, v9, v6
    v_cvt_pk_bf16_f32 v8, v8, v9
    v_and_b32 v9, 0xffff0000, v8
    v_lshlrev_b32 v8, 16, v8
    v_add_f32 v8, v8, v96
    v_add_f32 v9, v9, v97
    v_cvt_pk_bf16_f32 v60, v8, v9
    v_cvt_pk_bf16_f32 v61, v24, v25
    v_add_f32 v5, 1.0, v62
    v_add_f32 v6, 1.0, v63
    v_cvt_pk_bf16_f32 v5, v5, v6
    v_and_b32 v6, 0xffff0000, v5
    v_lshlrev_b32 v5, 16, v5
    v_sub_f32 v8, v26, v12
    v_sub_f32 v9, v27, v12
    v_cvt_pk_bf16_f32 v8, v8, v9
    v_and_b32 v9, 0xffff0000, v8
    v_lshlrev_b32 v8, 16, v8
    v_mul_f32 v8, v8, v13
    v_mul_f32 v9, v9, v13
    v_cvt_pk_bf16_f32 v8, v8, v9
    v_and_b32 v9, 0xffff0000, v8
    v_lshlrev_b32 v8, 16, v8
    v_mul_f32 v8, v8, v5
    v_mul_f32 v9, v9, v6
    v_cvt_pk_bf16_f32 v8, v8, v9
    v_and_b32 v9, 0xffff0000, v8
    v_lshlrev_b32 v8, 16, v8
    v_add_f32 v8, v8, v98
    v_add_f32 v9, v9, v99
    v_cvt_pk_bf16_f32 v62, v8, v9
    v_cvt_pk_bf16_f32 v63, v26, v27
    v_add_f32 v5, 1.0, v64
    v_add_f32 v6, 1.0, v65
    v_cvt_pk_bf16_f32 v5, v5, v6
    v_and_b32 v6, 0xffff0000, v5
    v_lshlrev_b32 v5, 16, v5
    v_sub_f32 v8, v28, v12
    v_sub_f32 v9, v29, v12
    v_cvt_pk_bf16_f32 v8, v8, v9
    v_and_b32 v9, 0xffff0000, v8
    v_lshlrev_b32 v8, 16, v8
    v_mul_f32 v8, v8, v13
    v_mul_f32 v9, v9, v13
    v_cvt_pk_bf16_f32 v8, v8, v9
    v_and_b32 v9, 0xffff0000, v8
    v_lshlrev_b32 v8, 16, v8
    v_mul_f32 v8, v8, v5
    v_mul_f32 v9, v9, v6
    v_cvt_pk_bf16_f32 v8, v8, v9
    v_and_b32 v9, 0xffff0000, v8
    v_lshlrev_b32 v8, 16, v8
    v_add_f32 v8, v8, v100
    v_add_f32 v9, v9, v101
    v_cvt_pk_bf16_f32 v64, v8, v9
    v_cvt_pk_bf16_f32 v65, v28, v29
    v_add_f32 v5, 1.0, v66
    v_add_f32 v6, 1.0, v67
    v_cvt_pk_bf16_f32 v5, v5, v6
    v_and_b32 v6, 0xffff0000, v5
    v_lshlrev_b32 v5, 16, v5
    v_sub_f32 v8, v30, v12
    v_sub_f32 v9, v31, v12
    v_cvt_pk_bf16_f32 v8, v8, v9
    v_and_b32 v9, 0xffff0000, v8
    v_lshlrev_b32 v8, 16, v8
    v_mul_f32 v8, v8, v13
    v_mul_f32 v9, v9, v13
    v_cvt_pk_bf16_f32 v8, v8, v9
    v_and_b32 v9, 0xffff0000, v8
    v_lshlrev_b32 v8, 16, v8
    v_mul_f32 v8, v8, v5
    v_mul_f32 v9, v9, v6
    v_cvt_pk_bf16_f32 v8, v8, v9
    v_and_b32 v9, 0xffff0000, v8
    v_lshlrev_b32 v8, 16, v8
    v_add_f32 v8, v8, v102
    v_add_f32 v9, v9, v103
    v_cvt_pk_bf16_f32 v66, v8, v9
    v_cvt_pk_bf16_f32 v67, v30, v31
    v_add_f32 v5, 1.0, v68
    v_add_f32 v6, 1.0, v69
    v_cvt_pk_bf16_f32 v5, v5, v6
    v_and_b32 v6, 0xffff0000, v5
    v_lshlrev_b32 v5, 16, v5
    v_sub_f32 v8, v32, v12
    v_sub_f32 v9, v33, v12
    v_cvt_pk_bf16_f32 v8, v8, v9
    v_and_b32 v9, 0xffff0000, v8
    v_lshlrev_b32 v8, 16, v8
    v_mul_f32 v8, v8, v13
    v_mul_f32 v9, v9, v13
    v_cvt_pk_bf16_f32 v8, v8, v9
    v_and_b32 v9, 0xffff0000, v8
    v_lshlrev_b32 v8, 16, v8
    v_mul_f32 v8, v8, v5
    v_mul_f32 v9, v9, v6
    v_cvt_pk_bf16_f32 v8, v8, v9
    v_and_b32 v9, 0xffff0000, v8
    v_lshlrev_b32 v8, 16, v8
    v_add_f32 v8, v8, v104
    v_add_f32 v9, v9, v105
    v_cvt_pk_bf16_f32 v68, v8, v9
    v_cvt_pk_bf16_f32 v69, v32, v33
    v_add_f32 v5, 1.0, v70
    v_add_f32 v6, 1.0, v71
    v_cvt_pk_bf16_f32 v5, v5, v6
    v_and_b32 v6, 0xffff0000, v5
    v_lshlrev_b32 v5, 16, v5
    v_sub_f32 v8, v34, v12
    v_sub_f32 v9, v35, v12
    v_cvt_pk_bf16_f32 v8, v8, v9
    v_and_b32 v9, 0xffff0000, v8
    v_lshlrev_b32 v8, 16, v8
    v_mul_f32 v8, v8, v13
    v_mul_f32 v9, v9, v13
    v_cvt_pk_bf16_f32 v8, v8, v9
    v_and_b32 v9, 0xffff0000, v8
    v_lshlrev_b32 v8, 16, v8
    v_mul_f32 v8, v8, v5
    v_mul_f32 v9, v9, v6
    v_cvt_pk_bf16_f32 v8, v8, v9
    v_and_b32 v9, 0xffff0000, v8
    v_lshlrev_b32 v8, 16, v8
    v_add_f32 v8, v8, v106
    v_add_f32 v9, v9, v107
    v_cvt_pk_bf16_f32 v70, v8, v9
    v_cvt_pk_bf16_f32 v71, v34, v35
    v_add_f32 v5, 1.0, v72
    v_add_f32 v6, 1.0, v73
    v_cvt_pk_bf16_f32 v5, v5, v6
    v_and_b32 v6, 0xffff0000, v5
    v_lshlrev_b32 v5, 16, v5
    v_sub_f32 v8, v36, v12
    v_sub_f32 v9, v37, v12
    v_cvt_pk_bf16_f32 v8, v8, v9
    v_and_b32 v9, 0xffff0000, v8
    v_lshlrev_b32 v8, 16, v8
    v_mul_f32 v8, v8, v13
    v_mul_f32 v9, v9, v13
    v_cvt_pk_bf16_f32 v8, v8, v9
    v_and_b32 v9, 0xffff0000, v8
    v_lshlrev_b32 v8, 16, v8
    v_mul_f32 v8, v8, v5
    v_mul_f32 v9, v9, v6
    v_cvt_pk_bf16_f32 v8, v8, v9
    v_and_b32 v9, 0xffff0000, v8
    v_lshlrev_b32 v8, 16, v8
    v_add_f32 v8, v8, v108
    v_add_f32 v9, v9, v109
    v_cvt_pk_bf16_f32 v72, v8, v9
    v_cvt_pk_bf16_f32 v73, v36, v37
    v_add_f32 v5, 1.0, v74
    v_add_f32 v6, 1.0, v75
    v_cvt_pk_bf16_f32 v5, v5, v6
    v_and_b32 v6, 0xffff0000, v5
    v_lshlrev_b32 v5, 16, v5
    v_sub_f32 v8, v38, v12
    v_sub_f32 v9, v39, v12
    v_cvt_pk_bf16_f32 v8, v8, v9
    v_and_b32 v9, 0xffff0000, v8
    v_lshlrev_b32 v8, 16, v8
    v_mul_f32 v8, v8, v13
    v_mul_f32 v9, v9, v13
    v_cvt_pk_bf16_f32 v8, v8, v9
    v_and_b32 v9, 0xffff0000, v8
    v_lshlrev_b32 v8, 16, v8
    v_mul_f32 v8, v8, v5
    v_mul_f32 v9, v9, v6
    v_cvt_pk_bf16_f32 v8, v8, v9
    v_and_b32 v9, 0xffff0000, v8
    v_lshlrev_b32 v8, 16, v8
    v_add_f32 v8, v8, v110
    v_add_f32 v9, v9, v111
    v_cvt_pk_bf16_f32 v74, v8, v9
    v_cvt_pk_bf16_f32 v75, v38, v39
    v_add_f32 v5, 1.0, v76
    v_add_f32 v6, 1.0, v77
    v_cvt_pk_bf16_f32 v5, v5, v6
    v_and_b32 v6, 0xffff0000, v5
    v_lshlrev_b32 v5, 16, v5
    v_sub_f32 v8, v40, v12
    v_sub_f32 v9, v41, v12
    v_cvt_pk_bf16_f32 v8, v8, v9
    v_and_b32 v9, 0xffff0000, v8
    v_lshlrev_b32 v8, 16, v8
    v_mul_f32 v8, v8, v13
    v_mul_f32 v9, v9, v13
    v_cvt_pk_bf16_f32 v8, v8, v9
    v_and_b32 v9, 0xffff0000, v8
    v_lshlrev_b32 v8, 16, v8
    v_mul_f32 v8, v8, v5
    v_mul_f32 v9, v9, v6
    v_cvt_pk_bf16_f32 v8, v8, v9
    v_and_b32 v9, 0xffff0000, v8
    v_lshlrev_b32 v8, 16, v8
    v_add_f32 v8, v8, v112
    v_add_f32 v9, v9, v113
    v_cvt_pk_bf16_f32 v76, v8, v9
    v_cvt_pk_bf16_f32 v77, v40, v41
    v_add_f32 v5, 1.0, v78
    v_add_f32 v6, 1.0, v79
    v_cvt_pk_bf16_f32 v5, v5, v6
    v_and_b32 v6, 0xffff0000, v5
    v_lshlrev_b32 v5, 16, v5
    v_sub_f32 v8, v42, v12
    v_sub_f32 v9, v43, v12
    v_cvt_pk_bf16_f32 v8, v8, v9
    v_and_b32 v9, 0xffff0000, v8
    v_lshlrev_b32 v8, 16, v8
    v_mul_f32 v8, v8, v13
    v_mul_f32 v9, v9, v13
    v_cvt_pk_bf16_f32 v8, v8, v9
    v_and_b32 v9, 0xffff0000, v8
    v_lshlrev_b32 v8, 16, v8
    v_mul_f32 v8, v8, v5
    v_mul_f32 v9, v9, v6
    v_cvt_pk_bf16_f32 v8, v8, v9
    v_and_b32 v9, 0xffff0000, v8
    v_lshlrev_b32 v8, 16, v8
    v_add_f32 v8, v8, v114
    v_add_f32 v9, v9, v115
    v_cvt_pk_bf16_f32 v78, v8, v9
    v_cvt_pk_bf16_f32 v79, v42, v43
    v_add_f32 v5, 1.0, v80
    v_add_f32 v6, 1.0, v81
    v_cvt_pk_bf16_f32 v5, v5, v6
    v_and_b32 v6, 0xffff0000, v5
    v_lshlrev_b32 v5, 16, v5
    v_sub_f32 v8, v44, v12
    v_sub_f32 v9, v45, v12
    v_cvt_pk_bf16_f32 v8, v8, v9
    v_and_b32 v9, 0xffff0000, v8
    v_lshlrev_b32 v8, 16, v8
    v_mul_f32 v8, v8, v13
    v_mul_f32 v9, v9, v13
    v_cvt_pk_bf16_f32 v8, v8, v9
    v_and_b32 v9, 0xffff0000, v8
    v_lshlrev_b32 v8, 16, v8
    v_mul_f32 v8, v8, v5
    v_mul_f32 v9, v9, v6
    v_cvt_pk_bf16_f32 v8, v8, v9
    v_and_b32 v9, 0xffff0000, v8
    v_lshlrev_b32 v8, 16, v8
    v_add_f32 v8, v8, v116
    v_add_f32 v9, v9, v117
    v_cvt_pk_bf16_f32 v80, v8, v9
    v_cvt_pk_bf16_f32 v81, v44, v45
    v_add_f32 v5, 1.0, v82
    v_add_f32 v6, 1.0, v83
    v_cvt_pk_bf16_f32 v5, v5, v6
    v_and_b32 v6, 0xffff0000, v5
    v_lshlrev_b32 v5, 16, v5
    v_sub_f32 v8, v46, v12
    v_sub_f32 v9, v47, v12
    v_cvt_pk_bf16_f32 v8, v8, v9
    v_and_b32 v9, 0xffff0000, v8
    v_lshlrev_b32 v8, 16, v8
    v_mul_f32 v8, v8, v13
    v_mul_f32 v9, v9, v13
    v_cvt_pk_bf16_f32 v8, v8, v9
    v_and_b32 v9, 0xffff0000, v8
    v_lshlrev_b32 v8, 16, v8
    v_mul_f32 v8, v8, v5
    v_mul_f32 v9, v9, v6
    v_cvt_pk_bf16_f32 v8, v8, v9
    v_and_b32 v9, 0xffff0000, v8
    v_lshlrev_b32 v8, 16, v8
    v_add_f32 v8, v8, v118
    v_add_f32 v9, v9, v119
    v_cvt_pk_bf16_f32 v82, v8, v9
    v_cvt_pk_bf16_f32 v83, v46, v47
    v_add_f32 v5, 1.0, v84
    v_add_f32 v6, 1.0, v85
    v_cvt_pk_bf16_f32 v5, v5, v6
    v_and_b32 v6, 0xffff0000, v5
    v_lshlrev_b32 v5, 16, v5
    v_sub_f32 v8, v48, v12
    v_sub_f32 v9, v49, v12
    v_cvt_pk_bf16_f32 v8, v8, v9
    v_and_b32 v9, 0xffff0000, v8
    v_lshlrev_b32 v8, 16, v8
    v_mul_f32 v8, v8, v13
    v_mul_f32 v9, v9, v13
    v_cvt_pk_bf16_f32 v8, v8, v9
    v_and_b32 v9, 0xffff0000, v8
    v_lshlrev_b32 v8, 16, v8
    v_mul_f32 v8, v8, v5
    v_mul_f32 v9, v9, v6
    v_cvt_pk_bf16_f32 v8, v8, v9
    v_and_b32 v9, 0xffff0000, v8
    v_lshlrev_b32 v8, 16, v8
    v_add_f32 v8, v8, v120
    v_add_f32 v9, v9, v121
    v_cvt_pk_bf16_f32 v84, v8, v9
    v_cvt_pk_bf16_f32 v85, v48, v49
    v_add_f32 v5, 1.0, v86
    v_add_f32 v6, 1.0, v87
    v_cvt_pk_bf16_f32 v5, v5, v6
    v_and_b32 v6, 0xffff0000, v5
    v_lshlrev_b32 v5, 16, v5
    v_sub_f32 v8, v50, v12
    v_sub_f32 v9, v51, v12
    v_cvt_pk_bf16_f32 v8, v8, v9
    v_and_b32 v9, 0xffff0000, v8
    v_lshlrev_b32 v8, 16, v8
    v_mul_f32 v8, v8, v13
    v_mul_f32 v9, v9, v13
    v_cvt_pk_bf16_f32 v8, v8, v9
    v_and_b32 v9, 0xffff0000, v8
    v_lshlrev_b32 v8, 16, v8
    v_mul_f32 v8, v8, v5
    v_mul_f32 v9, v9, v6
    v_cvt_pk_bf16_f32 v8, v8, v9
    v_and_b32 v9, 0xffff0000, v8
    v_lshlrev_b32 v8, 16, v8
    v_add_f32 v8, v8, v122
    v_add_f32 v9, v9, v123
    v_cvt_pk_bf16_f32 v86, v8, v9
    v_cvt_pk_bf16_f32 v87, v50, v51
    v_add_f32 v5, 1.0, v88
    v_add_f32 v6, 1.0, v89
    v_cvt_pk_bf16_f32 v5, v5, v6
    v_and_b32 v6, 0xffff0000, v5
    v_lshlrev_b32 v5, 16, v5
    v_sub_f32 v8, v52, v12
    v_sub_f32 v9, v53, v12
    v_cvt_pk_bf16_f32 v8, v8, v9
    v_and_b32 v9, 0xffff0000, v8
    v_lshlrev_b32 v8, 16, v8
    v_mul_f32 v8, v8, v13
    v_mul_f32 v9, v9, v13
    v_cvt_pk_bf16_f32 v8, v8, v9
    v_and_b32 v9, 0xffff0000, v8
    v_lshlrev_b32 v8, 16, v8
    v_mul_f32 v8, v8, v5
    v_mul_f32 v9, v9, v6
    v_cvt_pk_bf16_f32 v8, v8, v9
    v_and_b32 v9, 0xffff0000, v8
    v_lshlrev_b32 v8, 16, v8
    v_add_f32 v8, v8, v124
    v_add_f32 v9, v9, v125
    v_cvt_pk_bf16_f32 v88, v8, v9
    v_cvt_pk_bf16_f32 v89, v52, v53
    v_add_f32 v5, 1.0, v90
    v_add_f32 v6, 1.0, v91
    v_cvt_pk_bf16_f32 v5, v5, v6
    v_and_b32 v6, 0xffff0000, v5
    v_lshlrev_b32 v5, 16, v5
    v_sub_f32 v8, v54, v12
    v_sub_f32 v9, v55, v12
    v_cvt_pk_bf16_f32 v8, v8, v9
    v_and_b32 v9, 0xffff0000, v8
    v_lshlrev_b32 v8, 16, v8
    v_mul_f32 v8, v8, v13
    v_mul_f32 v9, v9, v13
    v_cvt_pk_bf16_f32 v8, v8, v9
    v_and_b32 v9, 0xffff0000, v8
    v_lshlrev_b32 v8, 16, v8
    v_mul_f32 v8, v8, v5
    v_mul_f32 v9, v9, v6
    v_cvt_pk_bf16_f32 v8, v8, v9
    v_and_b32 v9, 0xffff0000, v8
    v_lshlrev_b32 v8, 16, v8
    v_add_f32 v8, v8, v126
    v_add_f32 v9, v9, v127
    v_cvt_pk_bf16_f32 v90, v8, v9
    v_cvt_pk_bf16_f32 v91, v54, v55
    v_mul_u32_u24 v17, 1168, v1
    v_mul_u32_u24 v18, 72, v2
    v_add_u32 v17, v17, v18
    v_add_u32 v17, 8192, v17
    v_add_u32 v18, 74752, v17
    ds_write_b32 v17, v56 offset:0
    ds_write_b32 v18, v57 offset:0
    ds_write_b32 v17, v58 offset:4
    ds_write_b32 v18, v59 offset:4
    ds_write_b32 v17, v60 offset:8
    ds_write_b32 v18, v61 offset:8
    ds_write_b32 v17, v62 offset:12
    ds_write_b32 v18, v63 offset:12
    ds_write_b32 v17, v64 offset:16
    ds_write_b32 v18, v65 offset:16
    ds_write_b32 v17, v66 offset:20
    ds_write_b32 v18, v67 offset:20
    ds_write_b32 v17, v68 offset:24
    ds_write_b32 v18, v69 offset:24
    ds_write_b32 v17, v70 offset:28
    ds_write_b32 v18, v71 offset:28
    ds_write_b32 v17, v72 offset:32
    ds_write_b32 v18, v73 offset:32
    ds_write_b32 v17, v74 offset:36
    ds_write_b32 v18, v75 offset:36
    ds_write_b32 v17, v76 offset:40
    ds_write_b32 v18, v77 offset:40
    ds_write_b32 v17, v78 offset:44
    ds_write_b32 v18, v79 offset:44
    ds_write_b32 v17, v80 offset:48
    ds_write_b32 v18, v81 offset:48
    ds_write_b32 v17, v82 offset:52
    ds_write_b32 v18, v83 offset:52
    ds_write_b32 v17, v84 offset:56
    ds_write_b32 v18, v85 offset:56
    ds_write_b32 v17, v86 offset:60
    ds_write_b32 v18, v87 offset:60
    ds_write_b32 v17, v88 offset:64
    ds_write_b32 v18, v89 offset:64
    ds_write_b32 v17, v90 offset:68
    ds_write_b32 v18, v91 offset:68
    s_waitcnt lgkmcnt(0)
    s_barrier
    s_mov_b32 s25, 59652324
    s_mul_i32 s24, s2, 73728
    v_add_u32 v5, 0, v0
    v_mul_hi_u32 v6, v5, s25
    v_mul_u32_u24 v7, 72, v6
    v_sub_u32 v7, v5, v7
    v_mul_u32_u24 v6, 1168, v6
    v_lshl_add_u32 v6, v7, 4, v6
    v_add_u32 v7, 74752, v6
    ds_read_b128 v[20:23], v6 offset:8192
    ds_read_b128 v[24:27], v7 offset:8192
    v_lshlrev_b32 v8, 4, v5
    v_add_u32 v8, s24, v8
    v_add_u32 v9, 7094272, v8
    v_add_u32 v8, 9453568, v8
    s_waitcnt lgkmcnt(0)
    global_store_dwordx4 v8, v[20:23], s[18:19]
    global_store_dwordx4 v9, v[24:27], s[18:19]
    v_add_u32 v5, 1024, v0
    v_mul_hi_u32 v6, v5, s25
    v_mul_u32_u24 v7, 72, v6
    v_sub_u32 v7, v5, v7
    v_mul_u32_u24 v6, 1168, v6
    v_lshl_add_u32 v6, v7, 4, v6
    v_add_u32 v7, 74752, v6
    ds_read_b128 v[20:23], v6 offset:8192
    ds_read_b128 v[24:27], v7 offset:8192
    v_lshlrev_b32 v8, 4, v5
    v_add_u32 v8, s24, v8
    v_add_u32 v9, 7094272, v8
    v_add_u32 v8, 9453568, v8
    s_waitcnt lgkmcnt(0)
    global_store_dwordx4 v8, v[20:23], s[18:19]
    global_store_dwordx4 v9, v[24:27], s[18:19]
    v_add_u32 v5, 2048, v0
    v_mul_hi_u32 v6, v5, s25
    v_mul_u32_u24 v7, 72, v6
    v_sub_u32 v7, v5, v7
    v_mul_u32_u24 v6, 1168, v6
    v_lshl_add_u32 v6, v7, 4, v6
    v_add_u32 v7, 74752, v6
    ds_read_b128 v[20:23], v6 offset:8192
    ds_read_b128 v[24:27], v7 offset:8192
    v_lshlrev_b32 v8, 4, v5
    v_add_u32 v8, s24, v8
    v_add_u32 v9, 7094272, v8
    v_add_u32 v8, 9453568, v8
    s_waitcnt lgkmcnt(0)
    global_store_dwordx4 v8, v[20:23], s[18:19]
    global_store_dwordx4 v9, v[24:27], s[18:19]
    v_add_u32 v5, 3072, v0
    v_mul_hi_u32 v6, v5, s25
    v_mul_u32_u24 v7, 72, v6
    v_sub_u32 v7, v5, v7
    v_mul_u32_u24 v6, 1168, v6
    v_lshl_add_u32 v6, v7, 4, v6
    v_add_u32 v7, 74752, v6
    ds_read_b128 v[20:23], v6 offset:8192
    ds_read_b128 v[24:27], v7 offset:8192
    v_lshlrev_b32 v8, 4, v5
    v_add_u32 v8, s24, v8
    v_add_u32 v9, 7094272, v8
    v_add_u32 v8, 9453568, v8
    s_waitcnt lgkmcnt(0)
    global_store_dwordx4 v8, v[20:23], s[18:19]
    global_store_dwordx4 v9, v[24:27], s[18:19]
    v_add_u32 v5, 4096, v0
    v_cmp_gt_u32 vcc, 4608, v5
    s_and_saveexec_b64 s[6:7], vcc
    v_mul_hi_u32 v6, v5, s25
    v_mul_u32_u24 v7, 72, v6
    v_sub_u32 v7, v5, v7
    v_mul_u32_u24 v6, 1168, v6
    v_lshl_add_u32 v6, v7, 4, v6
    v_add_u32 v7, 74752, v6
    ds_read_b128 v[20:23], v6 offset:8192
    ds_read_b128 v[24:27], v7 offset:8192
    v_lshlrev_b32 v8, 4, v5
    v_add_u32 v8, s24, v8
    v_add_u32 v9, 7094272, v8
    v_add_u32 v8, 9453568, v8
    s_waitcnt lgkmcnt(0)
    global_store_dwordx4 v8, v[20:23], s[18:19]
    global_store_dwordx4 v9, v[24:27], s[18:19]
    s_mov_b64 exec, s[6:7]
ln2_end:
    s_endpgm
.text
.globl mlp_kernel
.p2align 8
.type mlp_kernel,@function
mlp_kernel:
    s_cmp_ge_u32 s2, 256
    s_cbranch_scc1 mlp_end
    s_load_dwordx2 s[18:19], s[0:1], 128
    v_and_b32 v1, 63, v0
    v_lshrrev_b32 v2, 6, v0
    s_lshr_b32 s20, s2, 3
    s_and_b32 s21, s2, 7
    s_lshl_b32 s22, s20, 6
    v_readfirstlane_b32 s23, v2
    s_waitcnt lgkmcnt(0)
    s_mul_i32 s24, s20, 73728
    s_add_u32 s24, s24, 9453568
    v_lshlrev_b32 v4, 4, v0
    v_add_u32 v4, s24, v4
    global_load_dwordx4 v[24:27], v4, s[18:19]
    v_add_u32 v4, 4096, v4
    global_load_dwordx4 v[28:31], v4, s[18:19]
    v_add_u32 v4, 4096, v4
    global_load_dwordx4 v[32:35], v4, s[18:19]
    v_add_u32 v4, 4096, v4
    global_load_dwordx4 v[36:39], v4, s[18:19]
    v_add_u32 v4, 4096, v4
    global_load_dwordx4 v[40:43], v4, s[18:19]
    v_add_u32 v4, 4096, v4
    global_load_dwordx4 v[44:47], v4, s[18:19]
    v_add_u32 v4, 4096, v4
    global_load_dwordx4 v[48:51], v4, s[18:19]
    v_add_u32 v4, 4096, v4
    global_load_dwordx4 v[52:55], v4, s[18:19]
    v_add_u32 v4, 4096, v4
    global_load_dwordx4 v[56:59], v4, s[18:19]
    v_add_u32 v4, 4096, v4
    global_load_dwordx4 v[60:63], v4, s[18:19]
    v_add_u32 v4, 4096, v4
    global_load_dwordx4 v[64:67], v4, s[18:19]
    v_add_u32 v4, 4096, v4
    global_load_dwordx4 v[68:71], v4, s[18:19]
    v_add_u32 v4, 4096, v4
    global_load_dwordx4 v[72:75], v4, s[18:19]
    v_add_u32 v4, 4096, v4
    global_load_dwordx4 v[76:79], v4, s[18:19]
    v_add_u32 v4, 4096, v4
    global_load_dwordx4 v[80:83], v4, s[18:19]
    v_add_u32 v4, 4096, v4
    global_load_dwordx4 v[84:87], v4, s[18:19]
    v_add_u32 v4, 4096, v4
    global_load_dwordx4 v[88:91], v4, s[18:19]
    v_add_u32 v4, 4096, v4
    global_load_dwordx4 v[92:95], v4, s[18:19]
    s_mov_b32 s25, 59652324
    v_add_u32 v5, 0, v0
    v_mul_hi_u32 v6, v5, s25
    v_mul_u32_u24 v7, 72, v6
    v_sub_u32 v7, v5, v7
    v_mul_u32_u24 v6, 1168, v6
    v_lshl_add_u32 v100, v7, 4, v6
    v_add_u32 v5, 256, v0
    v_mul_hi_u32 v6, v5, s25
    v_mul_u32_u24 v7, 72, v6
    v_sub_u32 v7, v5, v7
    v_mul_u32_u24 v6, 1168, v6
    v_lshl_add_u32 v101, v7, 4, v6
    v_add_u32 v5, 512, v0
    v_mul_hi_u32 v6, v5, s25
    v_mul_u32_u24 v7, 72, v6
    v_sub_u32 v7, v5, v7
    v_mul_u32_u24 v6, 1168, v6
    v_lshl_add_u32 v102, v7, 4, v6
    v_add_u32 v5, 768, v0
    v_mul_hi_u32 v6, v5, s25
    v_mul_u32_u24 v7, 72, v6
    v_sub_u32 v7, v5, v7
    v_mul_u32_u24 v6, 1168, v6
    v_lshl_add_u32 v103, v7, 4, v6
    v_add_u32 v5, 1024, v0
    v_mul_hi_u32 v6, v5, s25
    v_mul_u32_u24 v7, 72, v6
    v_sub_u32 v7, v5, v7
    v_mul_u32_u24 v6, 1168, v6
    v_lshl_add_u32 v104, v7, 4, v6
    v_add_u32 v5, 1280, v0
    v_mul_hi_u32 v6, v5, s25
    v_mul_u32_u24 v7, 72, v6
    v_sub_u32 v7, v5, v7
    v_mul_u32_u24 v6, 1168, v6
    v_lshl_add_u32 v105, v7, 4, v6
    v_add_u32 v5, 1536, v0
    v_mul_hi_u32 v6, v5, s25
    v_mul_u32_u24 v7, 72, v6
    v_sub_u32 v7, v5, v7
    v_mul_u32_u24 v6, 1168, v6
    v_lshl_add_u32 v106, v7, 4, v6
    v_add_u32 v5, 1792, v0
    v_mul_hi_u32 v6, v5, s25
    v_mul_u32_u24 v7, 72, v6
    v_sub_u32 v7, v5, v7
    v_mul_u32_u24 v6, 1168, v6
    v_lshl_add_u32 v107, v7, 4, v6
    v_add_u32 v5, 2048, v0
    v_mul_hi_u32 v6, v5, s25
    v_mul_u32_u24 v7, 72, v6
    v_sub_u32 v7, v5, v7
    v_mul_u32_u24 v6, 1168, v6
    v_lshl_add_u32 v108, v7, 4, v6
    v_add_u32 v5, 2304, v0
    v_mul_hi_u32 v6, v5, s25
    v_mul_u32_u24 v7, 72, v6
    v_sub_u32 v7, v5, v7
    v_mul_u32_u24 v6, 1168, v6
    v_lshl_add_u32 v109, v7, 4, v6
    v_add_u32 v5, 2560, v0
    v_mul_hi_u32 v6, v5, s25
    v_mul_u32_u24 v7, 72, v6
    v_sub_u32 v7, v5, v7
    v_mul_u32_u24 v6, 1168, v6
    v_lshl_add_u32 v110, v7, 4, v6
    v_add_u32 v5, 2816, v0
    v_mul_hi_u32 v6, v5, s25
    v_mul_u32_u24 v7, 72, v6
    v_sub_u32 v7, v5, v7
    v_mul_u32_u24 v6, 1168, v6
    v_lshl_add_u32 v111, v7, 4, v6
    v_add_u32 v5, 3072, v0
    v_mul_hi_u32 v6, v5, s25
    v_mul_u32_u24 v7, 72, v6
    v_sub_u32 v7, v5, v7
    v_mul_u32_u24 v6, 1168, v6
    v_lshl_add_u32 v112, v7, 4, v6
    v_add_u32 v5, 3328, v0
    v_mul_hi_u32 v6, v5, s25
    v_mul_u32_u24 v7, 72, v6
    v_sub_u32 v7, v5, v7
    v_mul_u32_u24 v6, 1168, v6
    v_lshl_add_u32 v113, v7, 4, v6
    v_add_u32 v5, 3584, v0
    v_mul_hi_u32 v6, v5, s25
    v_mul_u32_u24 v7, 72, v6
    v_sub_u32 v7, v5, v7
    v_mul_u32_u24 v6, 1168, v6
    v_lshl_add_u32 v114, v7, 4, v6
    v_add_u32 v5, 3840, v0
    v_mul_hi_u32 v6, v5, s25
    v_mul_u32_u24 v7, 72, v6
    v_sub_u32 v7, v5, v7
    v_mul_u32_u24 v6, 1168, v6
    v_lshl_add_u32 v115, v7, 4, v6
    v_add_u32 v5, 4096, v0
    v_mul_hi_u32 v6, v5, s25
    v_mul_u32_u24 v7, 72, v6
    v_sub_u32 v7, v5, v7
    v_mul_u32_u24 v6, 1168, v6
    v_lshl_add_u32 v116, v7, 4, v6
    v_add_u32 v5, 4352, v0
    v_mul_hi_u32 v6, v5, s25
    v_mul_u32_u24 v7, 72, v6
    v_sub_u32 v7, v5, v7
    v_mul_u32_u24 v6, 1168, v6
    v_lshl_add_u32 v117, v7, 4, v6
    s_waitcnt vmcnt(0)
    ds_write_b128 v100, v[24:27] offset:0
    ds_write_b128 v101, v[28:31] offset:0
    ds_write_b128 v102, v[32:35] offset:0
    ds_write_b128 v103, v[36:39] offset:0
    ds_write_b128 v104, v[40:43] offset:0
    ds_write_b128 v105, v[44:47] offset:0
    ds_write_b128 v106, v[48:51] offset:0
    ds_write_b128 v107, v[52:55] offset:0
    ds_write_b128 v108, v[56:59] offset:0
    ds_write_b128 v109, v[60:63] offset:0
    ds_write_b128 v110, v[64:67] offset:0
    ds_write_b128 v111, v[68:71] offset:0
    ds_write_b128 v112, v[72:75] offset:0
    ds_write_b128 v113, v[76:79] offset:0
    ds_write_b128 v114, v[80:83] offset:0
    ds_write_b128 v115, v[84:87] offset:0
    ds_write_b128 v116, v[88:91] offset:0
    ds_write_b128 v117, v[92:95] offset:0
    s_waitcnt lgkmcnt(0)
    s_barrier
    v_and_b32 v16, 15, v1
    v_lshrrev_b32 v17, 4, v1
    v_mul_u32_u24 v18, 1168, v16
    v_lshl_add_u32 v18, v17, 4, v18
    v_lshlrev_b32 v19, 4, v1
    s_mul_i32 s24, s21, 36
    s_mul_i32 s25, s23, 9
    s_add_u32 s24, s24, s25
    s_mul_i32 s24, s24, 18432
    s_add_u32 s24, s24, 16531456
    v_accvgpr_write_b32 a0, 0
    v_accvgpr_write_b32 a1, 0
    v_accvgpr_write_b32 a2, 0
    v_accvgpr_write_b32 a3, 0
    v_accvgpr_write_b32 a4, 0
    v_accvgpr_write_b32 a5, 0
    v_accvgpr_write_b32 a6, 0
    v_accvgpr_write_b32 a7, 0
    v_accvgpr_write_b32 a8, 0
    v_accvgpr_write_b32 a9, 0
    v_accvgpr_write_b32 a10, 0
    v_accvgpr_write_b32 a11, 0
    v_accvgpr_write_b32 a12, 0
    v_accvgpr_write_b32 a13, 0
    v_accvgpr_write_b32 a14, 0
    v_accvgpr_write_b32 a15, 0
    v_accvgpr_write_b32 a16, 0
    v_accvgpr_write_b32 a17, 0
    v_accvgpr_write_b32 a18, 0
    v_accvgpr_write_b32 a19, 0
    v_accvgpr_write_b32 a20, 0
    v_accvgpr_write_b32 a21, 0
    v_accvgpr_write_b32 a22, 0
    v_accvgpr_write_b32 a23, 0
    v_accvgpr_write_b32 a24, 0
    v_accvgpr_write_b32 a25, 0
    v_accvgpr_write_b32 a26, 0
    v_accvgpr_write_b32 a27, 0
    v_accvgpr_write_b32 a28, 0
    v_accvgpr_write_b32 a29, 0
    v_accvgpr_write_b32 a30, 0
    v_accvgpr_write_b32 a31, 0
    v_accvgpr_write_b32 a32, 0
    v_accvgpr_write_b32 a33, 0
    v_accvgpr_write_b32 a34, 0
    v_accvgpr_write_b32 a35, 0
    v_accvgpr_write_b32 a36, 0
    v_accvgpr_write_b32 a37, 0
    v_accvgpr_write_b32 a38, 0
    v_accvgpr_write_b32 a39, 0
    v_accvgpr_write_b32 a40, 0
    v_accvgpr_write_b32 a41, 0
    v_accvgpr_write_b32 a42, 0
    v_accvgpr_write_b32 a43, 0
    v_accvgpr_write_b32 a44, 0
    v_accvgpr_write_b32 a45, 0
    v_accvgpr_write_b32 a46, 0
    v_accvgpr_write_b32 a47, 0
    v_accvgpr_write_b32 a48, 0
    v_accvgpr_write_b32 a49, 0
    v_accvgpr_write_b32 a50, 0
    v_accvgpr_write_b32 a51, 0
    v_accvgpr_write_b32 a52, 0
    v_accvgpr_write_b32 a53, 0
    v_accvgpr_write_b32 a54, 0
    v_accvgpr_write_b32 a55, 0
    v_accvgpr_write_b32 a56, 0
    v_accvgpr_write_b32 a57, 0
    v_accvgpr_write_b32 a58, 0
    v_accvgpr_write_b32 a59, 0
    v_accvgpr_write_b32 a60, 0
    v_accvgpr_write_b32 a61, 0
    v_accvgpr_write_b32 a62, 0
    v_accvgpr_write_b32 a63, 0
    v_accvgpr_write_b32 a64, 0
    v_accvgpr_write_b32 a65, 0
    v_accvgpr_write_b32 a66, 0
    v_accvgpr_write_b32 a67, 0
    v_accvgpr_write_b32 a68, 0
    v_accvgpr_write_b32 a69, 0
    v_accvgpr_write_b32 a70, 0
    v_accvgpr_write_b32 a71, 0
    v_accvgpr_write_b32 a72, 0
    v_accvgpr_write_b32 a73, 0
    v_accvgpr_write_b32 a74, 0
    v_accvgpr_write_b32 a75, 0
    v_accvgpr_write_b32 a76, 0
    v_accvgpr_write_b32 a77, 0
    v_accvgpr_write_b32 a78, 0
    v_accvgpr_write_b32 a79, 0
    v_accvgpr_write_b32 a80, 0
    v_accvgpr_write_b32 a81, 0
    v_accvgpr_write_b32 a82, 0
    v_accvgpr_write_b32 a83, 0
    v_accvgpr_write_b32 a84, 0
    v_accvgpr_write_b32 a85, 0
    v_accvgpr_write_b32 a86, 0
    v_accvgpr_write_b32 a87, 0
    v_accvgpr_write_b32 a88, 0
    v_accvgpr_write_b32 a89, 0
    v_accvgpr_write_b32 a90, 0
    v_accvgpr_write_b32 a91, 0
    v_accvgpr_write_b32 a92, 0
    v_accvgpr_write_b32 a93, 0
    v_accvgpr_write_b32 a94, 0
    v_accvgpr_write_b32 a95, 0
    v_accvgpr_write_b32 a96, 0
    v_accvgpr_write_b32 a97, 0
    v_accvgpr_write_b32 a98, 0
    v_accvgpr_write_b32 a99, 0
    v_accvgpr_write_b32 a100, 0
    v_accvgpr_write_b32 a101, 0
    v_accvgpr_write_b32 a102, 0
    v_accvgpr_write_b32 a103, 0
    v_accvgpr_write_b32 a104, 0
    v_accvgpr_write_b32 a105, 0
    v_accvgpr_write_b32 a106, 0
    v_accvgpr_write_b32 a107, 0
    v_accvgpr_write_b32 a108, 0
    v_accvgpr_write_b32 a109, 0
    v_accvgpr_write_b32 a110, 0
    v_accvgpr_write_b32 a111, 0
    v_accvgpr_write_b32 a112, 0
    v_accvgpr_write_b32 a113, 0
    v_accvgpr_write_b32 a114, 0
    v_accvgpr_write_b32 a115, 0
    v_accvgpr_write_b32 a116, 0
    v_accvgpr_write_b32 a117, 0
    v_accvgpr_write_b32 a118, 0
    v_accvgpr_write_b32 a119, 0
    v_accvgpr_write_b32 a120, 0
    v_accvgpr_write_b32 a121, 0
    v_accvgpr_write_b32 a122, 0
    v_accvgpr_write_b32 a123, 0
    v_accvgpr_write_b32 a124, 0
    v_accvgpr_write_b32 a125, 0
    v_accvgpr_write_b32 a126, 0
    v_accvgpr_write_b32 a127, 0
    v_accvgpr_write_b32 a128, 0
    v_accvgpr_write_b32 a129, 0
    v_accvgpr_write_b32 a130, 0
    v_accvgpr_write_b32 a131, 0
    v_accvgpr_write_b32 a132, 0
    v_accvgpr_write_b32 a133, 0
    v_accvgpr_write_b32 a134, 0
    v_accvgpr_write_b32 a135, 0
    v_accvgpr_write_b32 a136, 0
    v_accvgpr_write_b32 a137, 0
    v_accvgpr_write_b32 a138, 0
    v_accvgpr_write_b32 a139, 0
    v_accvgpr_write_b32 a140, 0
    v_accvgpr_write_b32 a141, 0
    v_accvgpr_write_b32 a142, 0
    v_accvgpr_write_b32 a143, 0
    v_add_u32 v22, s24, v19
    v_add_u32 v23, 0, v18
    v_add_u32 v164, 0, v22
    v_add_u32 v165, 18432, v22
    v_add_u32 v166, 36864, v22
    v_add_u32 v167, 55296, v22
    v_add_u32 v168, 73728, v22
    v_add_u32 v169, 92160, v22
    v_add_u32 v170, 110592, v22
    v_add_u32 v171, 129024, v22
    v_add_u32 v172, 147456, v22
    global_load_dwordx4 v[24:27], v164, s[18:19] offset:0
    global_load_dwordx4 v[28:31], v165, s[18:19] offset:0
    global_load_dwordx4 v[32:35], v166, s[18:19] offset:0
    global_load_dwordx4 v[36:39], v167, s[18:19] offset:0
    global_load_dwordx4 v[40:43], v168, s[18:19] offset:0
    global_load_dwordx4 v[44:47], v169, s[18:19] offset:0
    global_load_dwordx4 v[48:51], v170, s[18:19] offset:0
    global_load_dwordx4 v[52:55], v171, s[18:19] offset:0
    global_load_dwordx4 v[56:59], v172, s[18:19] offset:0
    global_load_dwordx4 v[60:63], v164, s[18:19] offset:1024
    global_load_dwordx4 v[64:67], v165, s[18:19] offset:1024
    global_load_dwordx4 v[68:71], v166, s[18:19] offset:1024
    global_load_dwordx4 v[72:75], v167, s[18:19] offset:1024
    global_load_dwordx4 v[76:79], v168, s[18:19] offset:1024
    global_load_dwordx4 v[80:83], v169, s[18:19] offset:1024
    global_load_dwordx4 v[84:87], v170, s[18:19] offset:1024
    global_load_dwordx4 v[88:91], v171, s[18:19] offset:1024
    global_load_dwordx4 v[92:95], v172, s[18:19] offset:1024
    ds_read_b128 v[132:135], v23 offset:0
    ds_read_b128 v[136:139], v23 offset:18688
    ds_read_b128 v[140:143], v23 offset:37376
    ds_read_b128 v[144:147], v23 offset:56064
    global_load_dwordx4 v[96:99], v164, s[18:19] offset:2048
    global_load_dwordx4 v[100:103], v165, s[18:19] offset:2048
    global_load_dwordx4 v[104:107], v166, s[18:19] offset:2048
    global_load_dwordx4 v[108:111], v167, s[18:19] offset:2048
    global_load_dwordx4 v[112:115], v168, s[18:19] offset:2048
    global_load_dwordx4 v[116:119], v169, s[18:19] offset:2048
    global_load_dwordx4 v[120:123], v170, s[18:19] offset:2048
    global_load_dwordx4 v[124:127], v171, s[18:19] offset:2048
    global_load_dwordx4 v[128:131], v172, s[18:19] offset:2048
    ds_read_b128 v[148:151], v23 offset:64
    ds_read_b128 v[152:155], v23 offset:18752
    ds_read_b128 v[156:159], v23 offset:37440
    ds_read_b128 v[160:163], v23 offset:56128
    s_waitcnt vmcnt(18) lgkmcnt(4)
    v_mfma_f32_16x16x32_bf16 a[0:3], v[24:27], v[132:135], a[0:3]
    v_mfma_f32_16x16x32_bf16 a[4:7], v[24:27], v[136:139], a[4:7]
    v_mfma_f32_16x16x32_bf16 a[8:11], v[24:27], v[140:143], a[8:11]
    v_mfma_f32_16x16x32_bf16 a[12:15], v[24:27], v[144:147], a[12:15]
    v_mfma_f32_16x16x32_bf16 a[16:19], v[28:31], v[132:135], a[16:19]
    v_mfma_f32_16x16x32_bf16 a[20:23], v[28:31], v[136:139], a[20:23]
    v_mfma_f32_16x16x32_bf16 a[24:27], v[28:31], v[140:143], a[24:27]
    v_mfma_f32_16x16x32_bf16 a[28:31], v[28:31], v[144:147], a[28:31]
    v_mfma_f32_16x16x32_bf16 a[32:35], v[32:35], v[132:135], a[32:35]
    v_mfma_f32_16x16x32_bf16 a[36:39], v[32:35], v[136:139], a[36:39]
    v_mfma_f32_16x16x32_bf16 a[40:43], v[32:35], v[140:143], a[40:43]
    v_mfma_f32_16x16x32_bf16 a[44:47], v[32:35], v[144:147], a[44:47]
    v_mfma_f32_16x16x32_bf16 a[48:51], v[36:39], v[132:135], a[48:51]
    v_mfma_f32_16x16x32_bf16 a[52:55], v[36:39], v[136:139], a[52:55]
    v_mfma_f32_16x16x32_bf16 a[56:59], v[36:39], v[140:143], a[56:59]
    v_mfma_f32_16x16x32_bf16 a[60:63], v[36:39], v[144:147], a[60:63]
    v_mfma_f32_16x16x32_bf16 a[64:67], v[40:43], v[132:135], a[64:67]
    v_mfma_f32_16x16x32_bf16 a[68:71], v[40:43], v[136:139], a[68:71]
    v_mfma_f32_16x16x32_bf16 a[72:75], v[40:43], v[140:143], a[72:75]
    v_mfma_f32_16x16x32_bf16 a[76:79], v[40:43], v[144:147], a[76:79]
    v_mfma_f32_16x16x32_bf16 a[80:83], v[44:47], v[132:135], a[80:83]
    v_mfma_f32_16x16x32_bf16 a[84:87], v[44:47], v[136:139], a[84:87]
    v_mfma_f32_16x16x32_bf16 a[88:91], v[44:47], v[140:143], a[88:91]
    v_mfma_f32_16x16x32_bf16 a[92:95], v[44:47], v[144:147], a[92:95]
    v_mfma_f32_16x16x32_bf16 a[96:99], v[48:51], v[132:135], a[96:99]
    v_mfma_f32_16x16x32_bf16 a[100:103], v[48:51], v[136:139], a[100:103]
    v_mfma_f32_16x16x32_bf16 a[104:107], v[48:51], v[140:143], a[104:107]
    v_mfma_f32_16x16x32_bf16 a[108:111], v[48:51], v[144:147], a[108:111]
    v_mfma_f32_16x16x32_bf16 a[112:115], v[52:55], v[132:135], a[112:115]
    v_mfma_f32_16x16x32_bf16 a[116:119], v[52:55], v[136:139], a[116:119]
    v_mfma_f32_16x16x32_bf16 a[120:123], v[52:55], v[140:143], a[120:123]
    v_mfma_f32_16x16x32_bf16 a[124:127], v[52:55], v[144:147], a[124:127]
    v_mfma_f32_16x16x32_bf16 a[128:131], v[56:59], v[132:135], a[128:131]
    v_mfma_f32_16x16x32_bf16 a[132:135], v[56:59], v[136:139], a[132:135]
    v_mfma_f32_16x16x32_bf16 a[136:139], v[56:59], v[140:143], a[136:139]
    v_mfma_f32_16x16x32_bf16 a[140:143], v[56:59], v[144:147], a[140:143]
    global_load_dwordx4 v[24:27], v164, s[18:19] offset:3072
    global_load_dwordx4 v[28:31], v165, s[18:19] offset:3072
    global_load_dwordx4 v[32:35], v166, s[18:19] offset:3072
    global_load_dwordx4 v[36:39], v167, s[18:19] offset:3072
    global_load_dwordx4 v[40:43], v168, s[18:19] offset:3072
    global_load_dwordx4 v[44:47], v169, s[18:19] offset:3072
    global_load_dwordx4 v[48:51], v170, s[18:19] offset:3072
    global_load_dwordx4 v[52:55], v171, s[18:19] offset:3072
    global_load_dwordx4 v[56:59], v172, s[18:19] offset:3072
    v_add_u32 v164, 4096, v164
    v_add_u32 v165, 4096, v165
    v_add_u32 v166, 4096, v166
    v_add_u32 v167, 4096, v167
    v_add_u32 v168, 4096, v168
    v_add_u32 v169, 4096, v169
    v_add_u32 v170, 4096, v170
    v_add_u32 v171, 4096, v171
    v_add_u32 v172, 4096, v172
    ds_read_b128 v[132:135], v23 offset:128
    ds_read_b128 v[136:139], v23 offset:18816
    ds_read_b128 v[140:143], v23 offset:37504
    ds_read_b128 v[144:147], v23 offset:56192
    s_waitcnt vmcnt(18) lgkmcnt(4)
    v_mfma_f32_16x16x32_bf16 a[0:3], v[60:63], v[148:151], a[0:3]
    v_mfma_f32_16x16x32_bf16 a[4:7], v[60:63], v[152:155], a[4:7]
    v_mfma_f32_16x16x32_bf16 a[8:11], v[60:63], v[156:159], a[8:11]
    v_mfma_f32_16x16x32_bf16 a[12:15], v[60:63], v[160:163], a[12:15]
    v_mfma_f32_16x16x32_bf16 a[16:19], v[64:67], v[148:151], a[16:19]
    v_mfma_f32_16x16x32_bf16 a[20:23], v[64:67], v[152:155], a[20:23]
    v_mfma_f32_16x16x32_bf16 a[24:27], v[64:67], v[156:159], a[24:27]
    v_mfma_f32_16x16x32_bf16 a[28:31], v[64:67], v[160:163], a[28:31]
    v_mfma_f32_16x16x32_bf16 a[32:35], v[68:71], v[148:151], a[32:35]
    v_mfma_f32_16x16x32_bf16 a[36:39], v[68:71], v[152:155], a[36:39]
    v_mfma_f32_16x16x32_bf16 a[40:43], v[68:71], v[156:159], a[40:43]
    v_mfma_f32_16x16x32_bf16 a[44:47], v[68:71], v[160:163], a[44:47]
    v_mfma_f32_16x16x32_bf16 a[48:51], v[72:75], v[148:151], a[48:51]
    v_mfma_f32_16x16x32_bf16 a[52:55], v[72:75], v[152:155], a[52:55]
    v_mfma_f32_16x16x32_bf16 a[56:59], v[72:75], v[156:159], a[56:59]
    v_mfma_f32_16x16x32_bf16 a[60:63], v[72:75], v[160:163], a[60:63]
    v_mfma_f32_16x16x32_bf16 a[64:67], v[76:79], v[148:151], a[64:67]
    v_mfma_f32_16x16x32_bf16 a[68:71], v[76:79], v[152:155], a[68:71]
    v_mfma_f32_16x16x32_bf16 a[72:75], v[76:79], v[156:159], a[72:75]
    v_mfma_f32_16x16x32_bf16 a[76:79], v[76:79], v[160:163], a[76:79]
    v_mfma_f32_16x16x32_bf16 a[80:83], v[80:83], v[148:151], a[80:83]
    v_mfma_f32_16x16x32_bf16 a[84:87], v[80:83], v[152:155], a[84:87]
    v_mfma_f32_16x16x32_bf16 a[88:91], v[80:83], v[156:159], a[88:91]
    v_mfma_f32_16x16x32_bf16 a[92:95], v[80:83], v[160:163], a[92:95]
    v_mfma_f32_16x16x32_bf16 a[96:99], v[84:87], v[148:151], a[96:99]
    v_mfma_f32_16x16x32_bf16 a[100:103], v[84:87], v[152:155], a[100:103]
    v_mfma_f32_16x16x32_bf16 a[104:107], v[84:87], v[156:159], a[104:107]
    v_mfma_f32_16x16x32_bf16 a[108:111], v[84:87], v[160:163], a[108:111]
    v_mfma_f32_16x16x32_bf16 a[112:115], v[88:91], v[148:151], a[112:115]
    v_mfma_f32_16x16x32_bf16 a[116:119], v[88:91], v[152:155], a[116:119]
    v_mfma_f32_16x16x32_bf16 a[120:123], v[88:91], v[156:159], a[120:123]
    v_mfma_f32_16x16x32_bf16 a[124:127], v[88:91], v[160:163], a[124:127]
    v_mfma_f32_16x16x32_bf16 a[128:131], v[92:95], v[148:151], a[128:131]
    v_mfma_f32_16x16x32_bf16 a[132:135], v[92:95], v[152:155], a[132:135]
    v_mfma_f32_16x16x32_bf16 a[136:139], v[92:95], v[156:159], a[136:139]
    v_mfma_f32_16x16x32_bf16 a[140:143], v[92:95], v[160:163], a[140:143]
    global_load_dwordx4 v[60:63], v164, s[18:19] offset:0
    global_load_dwordx4 v[64:67], v165, s[18:19] offset:0
    global_load_dwordx4 v[68:71], v166, s[18:19] offset:0
    global_load_dwordx4 v[72:75], v167, s[18:19] offset:0
    global_load_dwordx4 v[76:79], v168, s[18:19] offset:0
    global_load_dwordx4 v[80:83], v169, s[18:19] offset:0
    global_load_dwordx4 v[84:87], v170, s[18:19] offset:0
    global_load_dwordx4 v[88:91], v171, s[18:19] offset:0
    global_load_dwordx4 v[92:95], v172, s[18:19] offset:0
    ds_read_b128 v[148:151], v23 offset:192
    ds_read_b128 v[152:155], v23 offset:18880
    ds_read_b128 v[156:159], v23 offset:37568
    ds_read_b128 v[160:163], v23 offset:56256
    s_waitcnt vmcnt(18) lgkmcnt(4)
    v_mfma_f32_16x16x32_bf16 a[0:3], v[96:99], v[132:135], a[0:3]
    v_mfma_f32_16x16x32_bf16 a[4:7], v[96:99], v[136:139], a[4:7]
    v_mfma_f32_16x16x32_bf16 a[8:11], v[96:99], v[140:143], a[8:11]
    v_mfma_f32_16x16x32_bf16 a[12:15], v[96:99], v[144:147], a[12:15]
    v_mfma_f32_16x16x32_bf16 a[16:19], v[100:103], v[132:135], a[16:19]
    v_mfma_f32_16x16x32_bf16 a[20:23], v[100:103], v[136:139], a[20:23]
    v_mfma_f32_16x16x32_bf16 a[24:27], v[100:103], v[140:143], a[24:27]
    v_mfma_f32_16x16x32_bf16 a[28:31], v[100:103], v[144:147], a[28:31]
    v_mfma_f32_16x16x32_bf16 a[32:35], v[104:107], v[132:135], a[32:35]
    v_mfma_f32_16x16x32_bf16 a[36:39], v[104:107], v[136:139], a[36:39]
    v_mfma_f32_16x16x32_bf16 a[40:43], v[104:107], v[140:143], a[40:43]
    v_mfma_f32_16x16x32_bf16 a[44:47], v[104:107], v[144:147], a[44:47]
    v_mfma_f32_16x16x32_bf16 a[48:51], v[108:111], v[132:135], a[48:51]
    v_mfma_f32_16x16x32_bf16 a[52:55], v[108:111], v[136:139], a[52:55]
    v_mfma_f32_16x16x32_bf16 a[56:59], v[108:111], v[140:143], a[56:59]
    v_mfma_f32_16x16x32_bf16 a[60:63], v[108:111], v[144:147], a[60:63]
    v_mfma_f32_16x16x32_bf16 a[64:67], v[112:115], v[132:135], a[64:67]
    v_mfma_f32_16x16x32_bf16 a[68:71], v[112:115], v[136:139], a[68:71]
    v_mfma_f32_16x16x32_bf16 a[72:75], v[112:115], v[140:143], a[72:75]
    v_mfma_f32_16x16x32_bf16 a[76:79], v[112:115], v[144:147], a[76:79]
    v_mfma_f32_16x16x32_bf16 a[80:83], v[116:119], v[132:135], a[80:83]
    v_mfma_f32_16x16x32_bf16 a[84:87], v[116:119], v[136:139], a[84:87]
    v_mfma_f32_16x16x32_bf16 a[88:91], v[116:119], v[140:143], a[88:91]
    v_mfma_f32_16x16x32_bf16 a[92:95], v[116:119], v[144:147], a[92:95]
    v_mfma_f32_16x16x32_bf16 a[96:99], v[120:123], v[132:135], a[96:99]
    v_mfma_f32_16x16x32_bf16 a[100:103], v[120:123], v[136:139], a[100:103]
    v_mfma_f32_16x16x32_bf16 a[104:107], v[120:123], v[140:143], a[104:107]
    v_mfma_f32_16x16x32_bf16 a[108:111], v[120:123], v[144:147], a[108:111]
    v_mfma_f32_16x16x32_bf16 a[112:115], v[124:127], v[132:135], a[112:115]
    v_mfma_f32_16x16x32_bf16 a[116:119], v[124:127], v[136:139], a[116:119]
    v_mfma_f32_16x16x32_bf16 a[120:123], v[124:127], v[140:143], a[120:123]
    v_mfma_f32_16x16x32_bf16 a[124:127], v[124:127], v[144:147], a[124:127]
    v_mfma_f32_16x16x32_bf16 a[128:131], v[128:131], v[132:135], a[128:131]
    v_mfma_f32_16x16x32_bf16 a[132:135], v[128:131], v[136:139], a[132:135]
    v_mfma_f32_16x16x32_bf16 a[136:139], v[128:131], v[140:143], a[136:139]
    v_mfma_f32_16x16x32_bf16 a[140:143], v[128:131], v[144:147], a[140:143]
    global_load_dwordx4 v[96:99], v164, s[18:19] offset:1024
    global_load_dwordx4 v[100:103], v165, s[18:19] offset:1024
    global_load_dwordx4 v[104:107], v166, s[18:19] offset:1024
    global_load_dwordx4 v[108:111], v167, s[18:19] offset:1024
    global_load_dwordx4 v[112:115], v168, s[18:19] offset:1024
    global_load_dwordx4 v[116:119], v169, s[18:19] offset:1024
    global_load_dwordx4 v[120:123], v170, s[18:19] offset:1024
    global_load_dwordx4 v[124:127], v171, s[18:19] offset:1024
    global_load_dwordx4 v[128:131], v172, s[18:19] offset:1024
    ds_read_b128 v[132:135], v23 offset:256
    ds_read_b128 v[136:139], v23 offset:18944
    ds_read_b128 v[140:143], v23 offset:37632
    ds_read_b128 v[144:147], v23 offset:56320
    s_waitcnt vmcnt(18) lgkmcnt(4)
    v_mfma_f32_16x16x32_bf16 a[0:3], v[24:27], v[148:151], a[0:3]
    v_mfma_f32_16x16x32_bf16 a[4:7], v[24:27], v[152:155], a[4:7]
    v_mfma_f32_16x16x32_bf16 a[8:11], v[24:27], v[156:159], a[8:11]
    v_mfma_f32_16x16x32_bf16 a[12:15], v[24:27], v[160:163], a[12:15]
    v_mfma_f32_16x16x32_bf16 a[16:19], v[28:31], v[148:151], a[16:19]
    v_mfma_f32_16x16x32_bf16 a[20:23], v[28:31], v[152:155], a[20:23]
    v_mfma_f32_16x16x32_bf16 a[24:27], v[28:31], v[156:159], a[24:27]
    v_mfma_f32_16x16x32_bf16 a[28:31], v[28:31], v[160:163], a[28:31]
    v_mfma_f32_16x16x32_bf16 a[32:35], v[32:35], v[148:151], a[32:35]
    v_mfma_f32_16x16x32_bf16 a[36:39], v[32:35], v[152:155], a[36:39]
    v_mfma_f32_16x16x32_bf16 a[40:43], v[32:35], v[156:159], a[40:43]
    v_mfma_f32_16x16x32_bf16 a[44:47], v[32:35], v[160:163], a[44:47]
    v_mfma_f32_16x16x32_bf16 a[48:51], v[36:39], v[148:151], a[48:51]
    v_mfma_f32_16x16x32_bf16 a[52:55], v[36:39], v[152:155], a[52:55]
    v_mfma_f32_16x16x32_bf16 a[56:59], v[36:39], v[156:159], a[56:59]
    v_mfma_f32_16x16x32_bf16 a[60:63], v[36:39], v[160:163], a[60:63]
    v_mfma_f32_16x16x32_bf16 a[64:67], v[40:43], v[148:151], a[64:67]
    v_mfma_f32_16x16x32_bf16 a[68:71], v[40:43], v[152:155], a[68:71]
    v_mfma_f32_16x16x32_bf16 a[72:75], v[40:43], v[156:159], a[72:75]
    v_mfma_f32_16x16x32_bf16 a[76:79], v[40:43], v[160:163], a[76:79]
    v_mfma_f32_16x16x32_bf16 a[80:83], v[44:47], v[148:151], a[80:83]
    v_mfma_f32_16x16x32_bf16 a[84:87], v[44:47], v[152:155], a[84:87]
    v_mfma_f32_16x16x32_bf16 a[88:91], v[44:47], v[156:159], a[88:91]
    v_mfma_f32_16x16x32_bf16 a[92:95], v[44:47], v[160:163], a[92:95]
    v_mfma_f32_16x16x32_bf16 a[96:99], v[48:51], v[148:151], a[96:99]
    v_mfma_f32_16x16x32_bf16 a[100:103], v[48:51], v[152:155], a[100:103]
    v_mfma_f32_16x16x32_bf16 a[104:107], v[48:51], v[156:159], a[104:107]
    v_mfma_f32_16x16x32_bf16 a[108:111], v[48:51], v[160:163], a[108:111]
    v_mfma_f32_16x16x32_bf16 a[112:115], v[52:55], v[148:151], a[112:115]
    v_mfma_f32_16x16x32_bf16 a[116:119], v[52:55], v[152:155], a[116:119]
    v_mfma_f32_16x16x32_bf16 a[120:123], v[52:55], v[156:159], a[120:123]
    v_mfma_f32_16x16x32_bf16 a[124:127], v[52:55], v[160:163], a[124:127]
    v_mfma_f32_16x16x32_bf16 a[128:131], v[56:59], v[148:151], a[128:131]
    v_mfma_f32_16x16x32_bf16 a[132:135], v[56:59], v[152:155], a[132:135]
    v_mfma_f32_16x16x32_bf16 a[136:139], v[56:59], v[156:159], a[136:139]
    v_mfma_f32_16x16x32_bf16 a[140:143], v[56:59], v[160:163], a[140:143]
    global_load_dwordx4 v[24:27], v164, s[18:19] offset:2048
    global_load_dwordx4 v[28:31], v165, s[18:19] offset:2048
    global_load_dwordx4 v[32:35], v166, s[18:19] offset:2048
    global_load_dwordx4 v[36:39], v167, s[18:19] offset:2048
    global_load_dwordx4 v[40:43], v168, s[18:19] offset:2048
    global_load_dwordx4 v[44:47], v169, s[18:19] offset:2048
    global_load_dwordx4 v[48:51], v170, s[18:19] offset:2048
    global_load_dwordx4 v[52:55], v171, s[18:19] offset:2048
    global_load_dwordx4 v[56:59], v172, s[18:19] offset:2048
    ds_read_b128 v[148:151], v23 offset:320
    ds_read_b128 v[152:155], v23 offset:19008
    ds_read_b128 v[156:159], v23 offset:37696
    ds_read_b128 v[160:163], v23 offset:56384
    s_waitcnt vmcnt(18) lgkmcnt(4)
    v_mfma_f32_16x16x32_bf16 a[0:3], v[60:63], v[132:135], a[0:3]
    v_mfma_f32_16x16x32_bf16 a[4:7], v[60:63], v[136:139], a[4:7]
    v_mfma_f32_16x16x32_bf16 a[8:11], v[60:63], v[140:143], a[8:11]
    v_mfma_f32_16x16x32_bf16 a[12:15], v[60:63], v[144:147], a[12:15]
    v_mfma_f32_16x16x32_bf16 a[16:19], v[64:67], v[132:135], a[16:19]
    v_mfma_f32_16x16x32_bf16 a[20:23], v[64:67], v[136:139], a[20:23]
    v_mfma_f32_16x16x32_bf16 a[24:27], v[64:67], v[140:143], a[24:27]
    v_mfma_f32_16x16x32_bf16 a[28:31], v[64:67], v[144:147], a[28:31]
    v_mfma_f32_16x16x32_bf16 a[32:35], v[68:71], v[132:135], a[32:35]
    v_mfma_f32_16x16x32_bf16 a[36:39], v[68:71], v[136:139], a[36:39]
    v_mfma_f32_16x16x32_bf16 a[40:43], v[68:71], v[140:143], a[40:43]
    v_mfma_f32_16x16x32_bf16 a[44:47], v[68:71], v[144:147], a[44:47]
    v_mfma_f32_16x16x32_bf16 a[48:51], v[72:75], v[132:135], a[48:51]
    v_mfma_f32_16x16x32_bf16 a[52:55], v[72:75], v[136:139], a[52:55]
    v_mfma_f32_16x16x32_bf16 a[56:59], v[72:75], v[140:143], a[56:59]
    v_mfma_f32_16x16x32_bf16 a[60:63], v[72:75], v[144:147], a[60:63]
    v_mfma_f32_16x16x32_bf16 a[64:67], v[76:79], v[132:135], a[64:67]
    v_mfma_f32_16x16x32_bf16 a[68:71], v[76:79], v[136:139], a[68:71]
    v_mfma_f32_16x16x32_bf16 a[72:75], v[76:79], v[140:143], a[72:75]
    v_mfma_f32_16x16x32_bf16 a[76:79], v[76:79], v[144:147], a[76:79]
    v_mfma_f32_16x16x32_bf16 a[80:83], v[80:83], v[132:135], a[80:83]
    v_mfma_f32_16x16x32_bf16 a[84:87], v[80:83], v[136:139], a[84:87]
    v_mfma_f32_16x16x32_bf16 a[88:91], v[80:83], v[140:143], a[88:91]
    v_mfma_f32_16x16x32_bf16 a[92:95], v[80:83], v[144:147], a[92:95]
    v_mfma_f32_16x16x32_bf16 a[96:99], v[84:87], v[132:135], a[96:99]
    v_mfma_f32_16x16x32_bf16 a[100:103], v[84:87], v[136:139], a[100:103]
    v_mfma_f32_16x16x32_bf16 a[104:107], v[84:87], v[140:143], a[104:107]
    v_mfma_f32_16x16x32_bf16 a[108:111], v[84:87], v[144:147], a[108:111]
    v_mfma_f32_16x16x32_bf16 a[112:115], v[88:91], v[132:135], a[112:115]
    v_mfma_f32_16x16x32_bf16 a[116:119], v[88:91], v[136:139], a[116:119]
    v_mfma_f32_16x16x32_bf16 a[120:123], v[88:91], v[140:143], a[120:123]
    v_mfma_f32_16x16x32_bf16 a[124:127], v[88:91], v[144:147], a[124:127]
    v_mfma_f32_16x16x32_bf16 a[128:131], v[92:95], v[132:135], a[128:131]
    v_mfma_f32_16x16x32_bf16 a[132:135], v[92:95], v[136:139], a[132:135]
    v_mfma_f32_16x16x32_bf16 a[136:139], v[92:95], v[140:143], a[136:139]
    v_mfma_f32_16x16x32_bf16 a[140:143], v[92:95], v[144:147], a[140:143]
    global_load_dwordx4 v[60:63], v164, s[18:19] offset:3072
    global_load_dwordx4 v[64:67], v165, s[18:19] offset:3072
    global_load_dwordx4 v[68:71], v166, s[18:19] offset:3072
    global_load_dwordx4 v[72:75], v167, s[18:19] offset:3072
    global_load_dwordx4 v[76:79], v168, s[18:19] offset:3072
    global_load_dwordx4 v[80:83], v169, s[18:19] offset:3072
    global_load_dwordx4 v[84:87], v170, s[18:19] offset:3072
    global_load_dwordx4 v[88:91], v171, s[18:19] offset:3072
    global_load_dwordx4 v[92:95], v172, s[18:19] offset:3072
    v_add_u32 v164, 4096, v164
    v_add_u32 v165, 4096, v165
    v_add_u32 v166, 4096, v166
    v_add_u32 v167, 4096, v167
    v_add_u32 v168, 4096, v168
    v_add_u32 v169, 4096, v169
    v_add_u32 v170, 4096, v170
    v_add_u32 v171, 4096, v171
    v_add_u32 v172, 4096, v172
    ds_read_b128 v[132:135], v23 offset:384
    ds_read_b128 v[136:139], v23 offset:19072
    ds_read_b128 v[140:143], v23 offset:37760
    ds_read_b128 v[144:147], v23 offset:56448
    s_waitcnt vmcnt(18) lgkmcnt(4)
    v_mfma_f32_16x16x32_bf16 a[0:3], v[96:99], v[148:151], a[0:3]
    v_mfma_f32_16x16x32_bf16 a[4:7], v[96:99], v[152:155], a[4:7]
    v_mfma_f32_16x16x32_bf16 a[8:11], v[96:99], v[156:159], a[8:11]
    v_mfma_f32_16x16x32_bf16 a[12:15], v[96:99], v[160:163], a[12:15]
    v_mfma_f32_16x16x32_bf16 a[16:19], v[100:103], v[148:151], a[16:19]
    v_mfma_f32_16x16x32_bf16 a[20:23], v[100:103], v[152:155], a[20:23]
    v_mfma_f32_16x16x32_bf16 a[24:27], v[100:103], v[156:159], a[24:27]
    v_mfma_f32_16x16x32_bf16 a[28:31], v[100:103], v[160:163], a[28:31]
    v_mfma_f32_16x16x32_bf16 a[32:35], v[104:107], v[148:151], a[32:35]
    v_mfma_f32_16x16x32_bf16 a[36:39], v[104:107], v[152:155], a[36:39]
    v_mfma_f32_16x16x32_bf16 a[40:43], v[104:107], v[156:159], a[40:43]
    v_mfma_f32_16x16x32_bf16 a[44:47], v[104:107], v[160:163], a[44:47]
    v_mfma_f32_16x16x32_bf16 a[48:51], v[108:111], v[148:151], a[48:51]
    v_mfma_f32_16x16x32_bf16 a[52:55], v[108:111], v[152:155], a[52:55]
    v_mfma_f32_16x16x32_bf16 a[56:59], v[108:111], v[156:159], a[56:59]
    v_mfma_f32_16x16x32_bf16 a[60:63], v[108:111], v[160:163], a[60:63]
    v_mfma_f32_16x16x32_bf16 a[64:67], v[112:115], v[148:151], a[64:67]
    v_mfma_f32_16x16x32_bf16 a[68:71], v[112:115], v[152:155], a[68:71]
    v_mfma_f32_16x16x32_bf16 a[72:75], v[112:115], v[156:159], a[72:75]
    v_mfma_f32_16x16x32_bf16 a[76:79], v[112:115], v[160:163], a[76:79]
    v_mfma_f32_16x16x32_bf16 a[80:83], v[116:119], v[148:151], a[80:83]
    v_mfma_f32_16x16x32_bf16 a[84:87], v[116:119], v[152:155], a[84:87]
    v_mfma_f32_16x16x32_bf16 a[88:91], v[116:119], v[156:159], a[88:91]
    v_mfma_f32_16x16x32_bf16 a[92:95], v[116:119], v[160:163], a[92:95]
    v_mfma_f32_16x16x32_bf16 a[96:99], v[120:123], v[148:151], a[96:99]
    v_mfma_f32_16x16x32_bf16 a[100:103], v[120:123], v[152:155], a[100:103]
    v_mfma_f32_16x16x32_bf16 a[104:107], v[120:123], v[156:159], a[104:107]
    v_mfma_f32_16x16x32_bf16 a[108:111], v[120:123], v[160:163], a[108:111]
    v_mfma_f32_16x16x32_bf16 a[112:115], v[124:127], v[148:151], a[112:115]
    v_mfma_f32_16x16x32_bf16 a[116:119], v[124:127], v[152:155], a[116:119]
    v_mfma_f32_16x16x32_bf16 a[120:123], v[124:127], v[156:159], a[120:123]
    v_mfma_f32_16x16x32_bf16 a[124:127], v[124:127], v[160:163], a[124:127]
    v_mfma_f32_16x16x32_bf16 a[128:131], v[128:131], v[148:151], a[128:131]
    v_mfma_f32_16x16x32_bf16 a[132:135], v[128:131], v[152:155], a[132:135]
    v_mfma_f32_16x16x32_bf16 a[136:139], v[128:131], v[156:159], a[136:139]
    v_mfma_f32_16x16x32_bf16 a[140:143], v[128:131], v[160:163], a[140:143]
    global_load_dwordx4 v[96:99], v164, s[18:19] offset:0
    global_load_dwordx4 v[100:103], v165, s[18:19] offset:0
    global_load_dwordx4 v[104:107], v166, s[18:19] offset:0
    global_load_dwordx4 v[108:111], v167, s[18:19] offset:0
    global_load_dwordx4 v[112:115], v168, s[18:19] offset:0
    global_load_dwordx4 v[116:119], v169, s[18:19] offset:0
    global_load_dwordx4 v[120:123], v170, s[18:19] offset:0
    global_load_dwordx4 v[124:127], v171, s[18:19] offset:0
    global_load_dwordx4 v[128:131], v172, s[18:19] offset:0
    ds_read_b128 v[148:151], v23 offset:448
    ds_read_b128 v[152:155], v23 offset:19136
    ds_read_b128 v[156:159], v23 offset:37824
    ds_read_b128 v[160:163], v23 offset:56512
    s_waitcnt vmcnt(18) lgkmcnt(4)
    v_mfma_f32_16x16x32_bf16 a[0:3], v[24:27], v[132:135], a[0:3]
    v_mfma_f32_16x16x32_bf16 a[4:7], v[24:27], v[136:139], a[4:7]
    v_mfma_f32_16x16x32_bf16 a[8:11], v[24:27], v[140:143], a[8:11]
    v_mfma_f32_16x16x32_bf16 a[12:15], v[24:27], v[144:147], a[12:15]
    v_mfma_f32_16x16x32_bf16 a[16:19], v[28:31], v[132:135], a[16:19]
    v_mfma_f32_16x16x32_bf16 a[20:23], v[28:31], v[136:139], a[20:23]
    v_mfma_f32_16x16x32_bf16 a[24:27], v[28:31], v[140:143], a[24:27]
    v_mfma_f32_16x16x32_bf16 a[28:31], v[28:31], v[144:147], a[28:31]
    v_mfma_f32_16x16x32_bf16 a[32:35], v[32:35], v[132:135], a[32:35]
    v_mfma_f32_16x16x32_bf16 a[36:39], v[32:35], v[136:139], a[36:39]
    v_mfma_f32_16x16x32_bf16 a[40:43], v[32:35], v[140:143], a[40:43]
    v_mfma_f32_16x16x32_bf16 a[44:47], v[32:35], v[144:147], a[44:47]
    v_mfma_f32_16x16x32_bf16 a[48:51], v[36:39], v[132:135], a[48:51]
    v_mfma_f32_16x16x32_bf16 a[52:55], v[36:39], v[136:139], a[52:55]
    v_mfma_f32_16x16x32_bf16 a[56:59], v[36:39], v[140:143], a[56:59]
    v_mfma_f32_16x16x32_bf16 a[60:63], v[36:39], v[144:147], a[60:63]
    v_mfma_f32_16x16x32_bf16 a[64:67], v[40:43], v[132:135], a[64:67]
    v_mfma_f32_16x16x32_bf16 a[68:71], v[40:43], v[136:139], a[68:71]
    v_mfma_f32_16x16x32_bf16 a[72:75], v[40:43], v[140:143], a[72:75]
    v_mfma_f32_16x16x32_bf16 a[76:79], v[40:43], v[144:147], a[76:79]
    v_mfma_f32_16x16x32_bf16 a[80:83], v[44:47], v[132:135], a[80:83]
    v_mfma_f32_16x16x32_bf16 a[84:87], v[44:47], v[136:139], a[84:87]
    v_mfma_f32_16x16x32_bf16 a[88:91], v[44:47], v[140:143], a[88:91]
    v_mfma_f32_16x16x32_bf16 a[92:95], v[44:47], v[144:147], a[92:95]
    v_mfma_f32_16x16x32_bf16 a[96:99], v[48:51], v[132:135], a[96:99]
    v_mfma_f32_16x16x32_bf16 a[100:103], v[48:51], v[136:139], a[100:103]
    v_mfma_f32_16x16x32_bf16 a[104:107], v[48:51], v[140:143], a[104:107]
    v_mfma_f32_16x16x32_bf16 a[108:111], v[48:51], v[144:147], a[108:111]
    v_mfma_f32_16x16x32_bf16 a[112:115], v[52:55], v[132:135], a[112:115]
    v_mfma_f32_16x16x32_bf16 a[116:119], v[52:55], v[136:139], a[116:119]
    v_mfma_f32_16x16x32_bf16 a[120:123], v[52:55], v[140:143], a[120:123]
    v_mfma_f32_16x16x32_bf16 a[124:127], v[52:55], v[144:147], a[124:127]
    v_mfma_f32_16x16x32_bf16 a[128:131], v[56:59], v[132:135], a[128:131]
    v_mfma_f32_16x16x32_bf16 a[132:135], v[56:59], v[136:139], a[132:135]
    v_mfma_f32_16x16x32_bf16 a[136:139], v[56:59], v[140:143], a[136:139]
    v_mfma_f32_16x16x32_bf16 a[140:143], v[56:59], v[144:147], a[140:143]
    global_load_dwordx4 v[24:27], v164, s[18:19] offset:1024
    global_load_dwordx4 v[28:31], v165, s[18:19] offset:1024
    global_load_dwordx4 v[32:35], v166, s[18:19] offset:1024
    global_load_dwordx4 v[36:39], v167, s[18:19] offset:1024
    global_load_dwordx4 v[40:43], v168, s[18:19] offset:1024
    global_load_dwordx4 v[44:47], v169, s[18:19] offset:1024
    global_load_dwordx4 v[48:51], v170, s[18:19] offset:1024
    global_load_dwordx4 v[52:55], v171, s[18:19] offset:1024
    global_load_dwordx4 v[56:59], v172, s[18:19] offset:1024
    ds_read_b128 v[132:135], v23 offset:512
    ds_read_b128 v[136:139], v23 offset:19200
    ds_read_b128 v[140:143], v23 offset:37888
    ds_read_b128 v[144:147], v23 offset:56576
    s_waitcnt vmcnt(18) lgkmcnt(4)
    v_mfma_f32_16x16x32_bf16 a[0:3], v[60:63], v[148:151], a[0:3]
    v_mfma_f32_16x16x32_bf16 a[4:7], v[60:63], v[152:155], a[4:7]
    v_mfma_f32_16x16x32_bf16 a[8:11], v[60:63], v[156:159], a[8:11]
    v_mfma_f32_16x16x32_bf16 a[12:15], v[60:63], v[160:163], a[12:15]
    v_mfma_f32_16x16x32_bf16 a[16:19], v[64:67], v[148:151], a[16:19]
    v_mfma_f32_16x16x32_bf16 a[20:23], v[64:67], v[152:155], a[20:23]
    v_mfma_f32_16x16x32_bf16 a[24:27], v[64:67], v[156:159], a[24:27]
    v_mfma_f32_16x16x32_bf16 a[28:31], v[64:67], v[160:163], a[28:31]
    v_mfma_f32_16x16x32_bf16 a[32:35], v[68:71], v[148:151], a[32:35]
    v_mfma_f32_16x16x32_bf16 a[36:39], v[68:71], v[152:155], a[36:39]
    v_mfma_f32_16x16x32_bf16 a[40:43], v[68:71], v[156:159], a[40:43]
    v_mfma_f32_16x16x32_bf16 a[44:47], v[68:71], v[160:163], a[44:47]
    v_mfma_f32_16x16x32_bf16 a[48:51], v[72:75], v[148:151], a[48:51]
    v_mfma_f32_16x16x32_bf16 a[52:55], v[72:75], v[152:155], a[52:55]
    v_mfma_f32_16x16x32_bf16 a[56:59], v[72:75], v[156:159], a[56:59]
    v_mfma_f32_16x16x32_bf16 a[60:63], v[72:75], v[160:163], a[60:63]
    v_mfma_f32_16x16x32_bf16 a[64:67], v[76:79], v[148:151], a[64:67]
    v_mfma_f32_16x16x32_bf16 a[68:71], v[76:79], v[152:155], a[68:71]
    v_mfma_f32_16x16x32_bf16 a[72:75], v[76:79], v[156:159], a[72:75]
    v_mfma_f32_16x16x32_bf16 a[76:79], v[76:79], v[160:163], a[76:79]
    v_mfma_f32_16x16x32_bf16 a[80:83], v[80:83], v[148:151], a[80:83]
    v_mfma_f32_16x16x32_bf16 a[84:87], v[80:83], v[152:155], a[84:87]
    v_mfma_f32_16x16x32_bf16 a[88:91], v[80:83], v[156:159], a[88:91]
    v_mfma_f32_16x16x32_bf16 a[92:95], v[80:83], v[160:163], a[92:95]
    v_mfma_f32_16x16x32_bf16 a[96:99], v[84:87], v[148:151], a[96:99]
    v_mfma_f32_16x16x32_bf16 a[100:103], v[84:87], v[152:155], a[100:103]
    v_mfma_f32_16x16x32_bf16 a[104:107], v[84:87], v[156:159], a[104:107]
    v_mfma_f32_16x16x32_bf16 a[108:111], v[84:87], v[160:163], a[108:111]
    v_mfma_f32_16x16x32_bf16 a[112:115], v[88:91], v[148:151], a[112:115]
    v_mfma_f32_16x16x32_bf16 a[116:119], v[88:91], v[152:155], a[116:119]
    v_mfma_f32_16x16x32_bf16 a[120:123], v[88:91], v[156:159], a[120:123]
    v_mfma_f32_16x16x32_bf16 a[124:127], v[88:91], v[160:163], a[124:127]
    v_mfma_f32_16x16x32_bf16 a[128:131], v[92:95], v[148:151], a[128:131]
    v_mfma_f32_16x16x32_bf16 a[132:135], v[92:95], v[152:155], a[132:135]
    v_mfma_f32_16x16x32_bf16 a[136:139], v[92:95], v[156:159], a[136:139]
    v_mfma_f32_16x16x32_bf16 a[140:143], v[92:95], v[160:163], a[140:143]
    global_load_dwordx4 v[60:63], v164, s[18:19] offset:2048
    global_load_dwordx4 v[64:67], v165, s[18:19] offset:2048
    global_load_dwordx4 v[68:71], v166, s[18:19] offset:2048
    global_load_dwordx4 v[72:75], v167, s[18:19] offset:2048
    global_load_dwordx4 v[76:79], v168, s[18:19] offset:2048
    global_load_dwordx4 v[80:83], v169, s[18:19] offset:2048
    global_load_dwordx4 v[84:87], v170, s[18:19] offset:2048
    global_load_dwordx4 v[88:91], v171, s[18:19] offset:2048
    global_load_dwordx4 v[92:95], v172, s[18:19] offset:2048
    ds_read_b128 v[148:151], v23 offset:576
    ds_read_b128 v[152:155], v23 offset:19264
    ds_read_b128 v[156:159], v23 offset:37952
    ds_read_b128 v[160:163], v23 offset:56640
    s_waitcnt vmcnt(18) lgkmcnt(4)
    v_mfma_f32_16x16x32_bf16 a[0:3], v[96:99], v[132:135], a[0:3]
    v_mfma_f32_16x16x32_bf16 a[4:7], v[96:99], v[136:139], a[4:7]
    v_mfma_f32_16x16x32_bf16 a[8:11], v[96:99], v[140:143], a[8:11]
    v_mfma_f32_16x16x32_bf16 a[12:15], v[96:99], v[144:147], a[12:15]
    v_mfma_f32_16x16x32_bf16 a[16:19], v[100:103], v[132:135], a[16:19]
    v_mfma_f32_16x16x32_bf16 a[20:23], v[100:103], v[136:139], a[20:23]
    v_mfma_f32_16x16x32_bf16 a[24:27], v[100:103], v[140:143], a[24:27]
    v_mfma_f32_16x16x32_bf16 a[28:31], v[100:103], v[144:147], a[28:31]
    v_mfma_f32_16x16x32_bf16 a[32:35], v[104:107], v[132:135], a[32:35]
    v_mfma_f32_16x16x32_bf16 a[36:39], v[104:107], v[136:139], a[36:39]
    v_mfma_f32_16x16x32_bf16 a[40:43], v[104:107], v[140:143], a[40:43]
    v_mfma_f32_16x16x32_bf16 a[44:47], v[104:107], v[144:147], a[44:47]
    v_mfma_f32_16x16x32_bf16 a[48:51], v[108:111], v[132:135], a[48:51]
    v_mfma_f32_16x16x32_bf16 a[52:55], v[108:111], v[136:139], a[52:55]
    v_mfma_f32_16x16x32_bf16 a[56:59], v[108:111], v[140:143], a[56:59]
    v_mfma_f32_16x16x32_bf16 a[60:63], v[108:111], v[144:147], a[60:63]
    v_mfma_f32_16x16x32_bf16 a[64:67], v[112:115], v[132:135], a[64:67]
    v_mfma_f32_16x16x32_bf16 a[68:71], v[112:115], v[136:139], a[68:71]
    v_mfma_f32_16x16x32_bf16 a[72:75], v[112:115], v[140:143], a[72:75]
    v_mfma_f32_16x16x32_bf16 a[76:79], v[112:115], v[144:147], a[76:79]
    v_mfma_f32_16x16x32_bf16 a[80:83], v[116:119], v[132:135], a[80:83]
    v_mfma_f32_16x16x32_bf16 a[84:87], v[116:119], v[136:139], a[84:87]
    v_mfma_f32_16x16x32_bf16 a[88:91], v[116:119], v[140:143], a[88:91]
    v_mfma_f32_16x16x32_bf16 a[92:95], v[116:119], v[144:147], a[92:95]
    v_mfma_f32_16x16x32_bf16 a[96:99], v[120:123], v[132:135], a[96:99]
    v_mfma_f32_16x16x32_bf16 a[100:103], v[120:123], v[136:139], a[100:103]
    v_mfma_f32_16x16x32_bf16 a[104:107], v[120:123], v[140:143], a[104:107]
    v_mfma_f32_16x16x32_bf16 a[108:111], v[120:123], v[144:147], a[108:111]
    v_mfma_f32_16x16x32_bf16 a[112:115], v[124:127], v[132:135], a[112:115]
    v_mfma_f32_16x16x32_bf16 a[116:119], v[124:127], v[136:139], a[116:119]
    v_mfma_f32_16x16x32_bf16 a[120:123], v[124:127], v[140:143], a[120:123]
    v_mfma_f32_16x16x32_bf16 a[124:127], v[124:127], v[144:147], a[124:127]
    v_mfma_f32_16x16x32_bf16 a[128:131], v[128:131], v[132:135], a[128:131]
    v_mfma_f32_16x16x32_bf16 a[132:135], v[128:131], v[136:139], a[132:135]
    v_mfma_f32_16x16x32_bf16 a[136:139], v[128:131], v[140:143], a[136:139]
    v_mfma_f32_16x16x32_bf16 a[140:143], v[128:131], v[144:147], a[140:143]
    global_load_dwordx4 v[96:99], v164, s[18:19] offset:3072
    global_load_dwordx4 v[100:103], v165, s[18:19] offset:3072
    global_load_dwordx4 v[104:107], v166, s[18:19] offset:3072
    global_load_dwordx4 v[108:111], v167, s[18:19] offset:3072
    global_load_dwordx4 v[112:115], v168, s[18:19] offset:3072
    global_load_dwordx4 v[116:119], v169, s[18:19] offset:3072
    global_load_dwordx4 v[120:123], v170, s[18:19] offset:3072
    global_load_dwordx4 v[124:127], v171, s[18:19] offset:3072
    global_load_dwordx4 v[128:131], v172, s[18:19] offset:3072
    v_add_u32 v164, 4096, v164
    v_add_u32 v165, 4096, v165
    v_add_u32 v166, 4096, v166
    v_add_u32 v167, 4096, v167
    v_add_u32 v168, 4096, v168
    v_add_u32 v169, 4096, v169
    v_add_u32 v170, 4096, v170
    v_add_u32 v171, 4096, v171
    v_add_u32 v172, 4096, v172
    ds_read_b128 v[132:135], v23 offset:640
    ds_read_b128 v[136:139], v23 offset:19328
    ds_read_b128 v[140:143], v23 offset:38016
    ds_read_b128 v[144:147], v23 offset:56704
    s_waitcnt vmcnt(18) lgkmcnt(4)
    v_mfma_f32_16x16x32_bf16 a[0:3], v[24:27], v[148:151], a[0:3]
    v_mfma_f32_16x16x32_bf16 a[4:7], v[24:27], v[152:155], a[4:7]
    v_mfma_f32_16x16x32_bf16 a[8:11], v[24:27], v[156:159], a[8:11]
    v_mfma_f32_16x16x32_bf16 a[12:15], v[24:27], v[160:163], a[12:15]
    v_mfma_f32_16x16x32_bf16 a[16:19], v[28:31], v[148:151], a[16:19]
    v_mfma_f32_16x16x32_bf16 a[20:23], v[28:31], v[152:155], a[20:23]
    v_mfma_f32_16x16x32_bf16 a[24:27], v[28:31], v[156:159], a[24:27]
    v_mfma_f32_16x16x32_bf16 a[28:31], v[28:31], v[160:163], a[28:31]
    v_mfma_f32_16x16x32_bf16 a[32:35], v[32:35], v[148:151], a[32:35]
    v_mfma_f32_16x16x32_bf16 a[36:39], v[32:35], v[152:155], a[36:39]
    v_mfma_f32_16x16x32_bf16 a[40:43], v[32:35], v[156:159], a[40:43]
    v_mfma_f32_16x16x32_bf16 a[44:47], v[32:35], v[160:163], a[44:47]
    v_mfma_f32_16x16x32_bf16 a[48:51], v[36:39], v[148:151], a[48:51]
    v_mfma_f32_16x16x32_bf16 a[52:55], v[36:39], v[152:155], a[52:55]
    v_mfma_f32_16x16x32_bf16 a[56:59], v[36:39], v[156:159], a[56:59]
    v_mfma_f32_16x16x32_bf16 a[60:63], v[36:39], v[160:163], a[60:63]
    v_mfma_f32_16x16x32_bf16 a[64:67], v[40:43], v[148:151], a[64:67]
    v_mfma_f32_16x16x32_bf16 a[68:71], v[40:43], v[152:155], a[68:71]
    v_mfma_f32_16x16x32_bf16 a[72:75], v[40:43], v[156:159], a[72:75]
    v_mfma_f32_16x16x32_bf16 a[76:79], v[40:43], v[160:163], a[76:79]
    v_mfma_f32_16x16x32_bf16 a[80:83], v[44:47], v[148:151], a[80:83]
    v_mfma_f32_16x16x32_bf16 a[84:87], v[44:47], v[152:155], a[84:87]
    v_mfma_f32_16x16x32_bf16 a[88:91], v[44:47], v[156:159], a[88:91]
    v_mfma_f32_16x16x32_bf16 a[92:95], v[44:47], v[160:163], a[92:95]
    v_mfma_f32_16x16x32_bf16 a[96:99], v[48:51], v[148:151], a[96:99]
    v_mfma_f32_16x16x32_bf16 a[100:103], v[48:51], v[152:155], a[100:103]
    v_mfma_f32_16x16x32_bf16 a[104:107], v[48:51], v[156:159], a[104:107]
    v_mfma_f32_16x16x32_bf16 a[108:111], v[48:51], v[160:163], a[108:111]
    v_mfma_f32_16x16x32_bf16 a[112:115], v[52:55], v[148:151], a[112:115]
    v_mfma_f32_16x16x32_bf16 a[116:119], v[52:55], v[152:155], a[116:119]
    v_mfma_f32_16x16x32_bf16 a[120:123], v[52:55], v[156:159], a[120:123]
    v_mfma_f32_16x16x32_bf16 a[124:127], v[52:55], v[160:163], a[124:127]
    v_mfma_f32_16x16x32_bf16 a[128:131], v[56:59], v[148:151], a[128:131]
    v_mfma_f32_16x16x32_bf16 a[132:135], v[56:59], v[152:155], a[132:135]
    v_mfma_f32_16x16x32_bf16 a[136:139], v[56:59], v[156:159], a[136:139]
    v_mfma_f32_16x16x32_bf16 a[140:143], v[56:59], v[160:163], a[140:143]
    global_load_dwordx4 v[24:27], v164, s[18:19] offset:0
    global_load_dwordx4 v[28:31], v165, s[18:19] offset:0
    global_load_dwordx4 v[32:35], v166, s[18:19] offset:0
    global_load_dwordx4 v[36:39], v167, s[18:19] offset:0
    global_load_dwordx4 v[40:43], v168, s[18:19] offset:0
    global_load_dwordx4 v[44:47], v169, s[18:19] offset:0
    global_load_dwordx4 v[48:51], v170, s[18:19] offset:0
    global_load_dwordx4 v[52:55], v171, s[18:19] offset:0
    global_load_dwordx4 v[56:59], v172, s[18:19] offset:0
    ds_read_b128 v[148:151], v23 offset:704
    ds_read_b128 v[152:155], v23 offset:19392
    ds_read_b128 v[156:159], v23 offset:38080
    ds_read_b128 v[160:163], v23 offset:56768
    s_waitcnt vmcnt(18) lgkmcnt(4)
    v_mfma_f32_16x16x32_bf16 a[0:3], v[60:63], v[132:135], a[0:3]
    v_mfma_f32_16x16x32_bf16 a[4:7], v[60:63], v[136:139], a[4:7]
    v_mfma_f32_16x16x32_bf16 a[8:11], v[60:63], v[140:143], a[8:11]
    v_mfma_f32_16x16x32_bf16 a[12:15], v[60:63], v[144:147], a[12:15]
    v_mfma_f32_16x16x32_bf16 a[16:19], v[64:67], v[132:135], a[16:19]
    v_mfma_f32_16x16x32_bf16 a[20:23], v[64:67], v[136:139], a[20:23]
    v_mfma_f32_16x16x32_bf16 a[24:27], v[64:67], v[140:143], a[24:27]
    v_mfma_f32_16x16x32_bf16 a[28:31], v[64:67], v[144:147], a[28:31]
    v_mfma_f32_16x16x32_bf16 a[32:35], v[68:71], v[132:135], a[32:35]
    v_mfma_f32_16x16x32_bf16 a[36:39], v[68:71], v[136:139], a[36:39]
    v_mfma_f32_16x16x32_bf16 a[40:43], v[68:71], v[140:143], a[40:43]
    v_mfma_f32_16x16x32_bf16 a[44:47], v[68:71], v[144:147], a[44:47]
    v_mfma_f32_16x16x32_bf16 a[48:51], v[72:75], v[132:135], a[48:51]
    v_mfma_f32_16x16x32_bf16 a[52:55], v[72:75], v[136:139], a[52:55]
    v_mfma_f32_16x16x32_bf16 a[56:59], v[72:75], v[140:143], a[56:59]
    v_mfma_f32_16x16x32_bf16 a[60:63], v[72:75], v[144:147], a[60:63]
    v_mfma_f32_16x16x32_bf16 a[64:67], v[76:79], v[132:135], a[64:67]
    v_mfma_f32_16x16x32_bf16 a[68:71], v[76:79], v[136:139], a[68:71]
    v_mfma_f32_16x16x32_bf16 a[72:75], v[76:79], v[140:143], a[72:75]
    v_mfma_f32_16x16x32_bf16 a[76:79], v[76:79], v[144:147], a[76:79]
    v_mfma_f32_16x16x32_bf16 a[80:83], v[80:83], v[132:135], a[80:83]
    v_mfma_f32_16x16x32_bf16 a[84:87], v[80:83], v[136:139], a[84:87]
    v_mfma_f32_16x16x32_bf16 a[88:91], v[80:83], v[140:143], a[88:91]
    v_mfma_f32_16x16x32_bf16 a[92:95], v[80:83], v[144:147], a[92:95]
    v_mfma_f32_16x16x32_bf16 a[96:99], v[84:87], v[132:135], a[96:99]
    v_mfma_f32_16x16x32_bf16 a[100:103], v[84:87], v[136:139], a[100:103]
    v_mfma_f32_16x16x32_bf16 a[104:107], v[84:87], v[140:143], a[104:107]
    v_mfma_f32_16x16x32_bf16 a[108:111], v[84:87], v[144:147], a[108:111]
    v_mfma_f32_16x16x32_bf16 a[112:115], v[88:91], v[132:135], a[112:115]
    v_mfma_f32_16x16x32_bf16 a[116:119], v[88:91], v[136:139], a[116:119]
    v_mfma_f32_16x16x32_bf16 a[120:123], v[88:91], v[140:143], a[120:123]
    v_mfma_f32_16x16x32_bf16 a[124:127], v[88:91], v[144:147], a[124:127]
    v_mfma_f32_16x16x32_bf16 a[128:131], v[92:95], v[132:135], a[128:131]
    v_mfma_f32_16x16x32_bf16 a[132:135], v[92:95], v[136:139], a[132:135]
    v_mfma_f32_16x16x32_bf16 a[136:139], v[92:95], v[140:143], a[136:139]
    v_mfma_f32_16x16x32_bf16 a[140:143], v[92:95], v[144:147], a[140:143]
    global_load_dwordx4 v[60:63], v164, s[18:19] offset:1024
    global_load_dwordx4 v[64:67], v165, s[18:19] offset:1024
    global_load_dwordx4 v[68:71], v166, s[18:19] offset:1024
    global_load_dwordx4 v[72:75], v167, s[18:19] offset:1024
    global_load_dwordx4 v[76:79], v168, s[18:19] offset:1024
    global_load_dwordx4 v[80:83], v169, s[18:19] offset:1024
    global_load_dwordx4 v[84:87], v170, s[18:19] offset:1024
    global_load_dwordx4 v[88:91], v171, s[18:19] offset:1024
    global_load_dwordx4 v[92:95], v172, s[18:19] offset:1024
    ds_read_b128 v[132:135], v23 offset:768
    ds_read_b128 v[136:139], v23 offset:19456
    ds_read_b128 v[140:143], v23 offset:38144
    ds_read_b128 v[144:147], v23 offset:56832
    s_waitcnt vmcnt(18) lgkmcnt(4)
    v_mfma_f32_16x16x32_bf16 a[0:3], v[96:99], v[148:151], a[0:3]
    v_mfma_f32_16x16x32_bf16 a[4:7], v[96:99], v[152:155], a[4:7]
    v_mfma_f32_16x16x32_bf16 a[8:11], v[96:99], v[156:159], a[8:11]
    v_mfma_f32_16x16x32_bf16 a[12:15], v[96:99], v[160:163], a[12:15]
    v_mfma_f32_16x16x32_bf16 a[16:19], v[100:103], v[148:151], a[16:19]
    v_mfma_f32_16x16x32_bf16 a[20:23], v[100:103], v[152:155], a[20:23]
    v_mfma_f32_16x16x32_bf16 a[24:27], v[100:103], v[156:159], a[24:27]
    v_mfma_f32_16x16x32_bf16 a[28:31], v[100:103], v[160:163], a[28:31]
    v_mfma_f32_16x16x32_bf16 a[32:35], v[104:107], v[148:151], a[32:35]
    v_mfma_f32_16x16x32_bf16 a[36:39], v[104:107], v[152:155], a[36:39]
    v_mfma_f32_16x16x32_bf16 a[40:43], v[104:107], v[156:159], a[40:43]
    v_mfma_f32_16x16x32_bf16 a[44:47], v[104:107], v[160:163], a[44:47]
    v_mfma_f32_16x16x32_bf16 a[48:51], v[108:111], v[148:151], a[48:51]
    v_mfma_f32_16x16x32_bf16 a[52:55], v[108:111], v[152:155], a[52:55]
    v_mfma_f32_16x16x32_bf16 a[56:59], v[108:111], v[156:159], a[56:59]
    v_mfma_f32_16x16x32_bf16 a[60:63], v[108:111], v[160:163], a[60:63]
    v_mfma_f32_16x16x32_bf16 a[64:67], v[112:115], v[148:151], a[64:67]
    v_mfma_f32_16x16x32_bf16 a[68:71], v[112:115], v[152:155], a[68:71]
    v_mfma_f32_16x16x32_bf16 a[72:75], v[112:115], v[156:159], a[72:75]
    v_mfma_f32_16x16x32_bf16 a[76:79], v[112:115], v[160:163], a[76:79]
    v_mfma_f32_16x16x32_bf16 a[80:83], v[116:119], v[148:151], a[80:83]
    v_mfma_f32_16x16x32_bf16 a[84:87], v[116:119], v[152:155], a[84:87]
    v_mfma_f32_16x16x32_bf16 a[88:91], v[116:119], v[156:159], a[88:91]
    v_mfma_f32_16x16x32_bf16 a[92:95], v[116:119], v[160:163], a[92:95]
    v_mfma_f32_16x16x32_bf16 a[96:99], v[120:123], v[148:151], a[96:99]
    v_mfma_f32_16x16x32_bf16 a[100:103], v[120:123], v[152:155], a[100:103]
    v_mfma_f32_16x16x32_bf16 a[104:107], v[120:123], v[156:159], a[104:107]
    v_mfma_f32_16x16x32_bf16 a[108:111], v[120:123], v[160:163], a[108:111]
    v_mfma_f32_16x16x32_bf16 a[112:115], v[124:127], v[148:151], a[112:115]
    v_mfma_f32_16x16x32_bf16 a[116:119], v[124:127], v[152:155], a[116:119]
    v_mfma_f32_16x16x32_bf16 a[120:123], v[124:127], v[156:159], a[120:123]
    v_mfma_f32_16x16x32_bf16 a[124:127], v[124:127], v[160:163], a[124:127]
    v_mfma_f32_16x16x32_bf16 a[128:131], v[128:131], v[148:151], a[128:131]
    v_mfma_f32_16x16x32_bf16 a[132:135], v[128:131], v[152:155], a[132:135]
    v_mfma_f32_16x16x32_bf16 a[136:139], v[128:131], v[156:159], a[136:139]
    v_mfma_f32_16x16x32_bf16 a[140:143], v[128:131], v[160:163], a[140:143]
    global_load_dwordx4 v[96:99], v164, s[18:19] offset:2048
    global_load_dwordx4 v[100:103], v165, s[18:19] offset:2048
    global_load_dwordx4 v[104:107], v166, s[18:19] offset:2048
    global_load_dwordx4 v[108:111], v167, s[18:19] offset:2048
    global_load_dwordx4 v[112:115], v168, s[18:19] offset:2048
    global_load_dwordx4 v[116:119], v169, s[18:19] offset:2048
    global_load_dwordx4 v[120:123], v170, s[18:19] offset:2048
    global_load_dwordx4 v[124:127], v171, s[18:19] offset:2048
    global_load_dwordx4 v[128:131], v172, s[18:19] offset:2048
    ds_read_b128 v[148:151], v23 offset:832
    ds_read_b128 v[152:155], v23 offset:19520
    ds_read_b128 v[156:159], v23 offset:38208
    ds_read_b128 v[160:163], v23 offset:56896
    s_waitcnt vmcnt(18) lgkmcnt(4)
    v_mfma_f32_16x16x32_bf16 a[0:3], v[24:27], v[132:135], a[0:3]
    v_mfma_f32_16x16x32_bf16 a[4:7], v[24:27], v[136:139], a[4:7]
    v_mfma_f32_16x16x32_bf16 a[8:11], v[24:27], v[140:143], a[8:11]
    v_mfma_f32_16x16x32_bf16 a[12:15], v[24:27], v[144:147], a[12:15]
    v_mfma_f32_16x16x32_bf16 a[16:19], v[28:31], v[132:135], a[16:19]
    v_mfma_f32_16x16x32_bf16 a[20:23], v[28:31], v[136:139], a[20:23]
    v_mfma_f32_16x16x32_bf16 a[24:27], v[28:31], v[140:143], a[24:27]
    v_mfma_f32_16x16x32_bf16 a[28:31], v[28:31], v[144:147], a[28:31]
    v_mfma_f32_16x16x32_bf16 a[32:35], v[32:35], v[132:135], a[32:35]
    v_mfma_f32_16x16x32_bf16 a[36:39], v[32:35], v[136:139], a[36:39]
    v_mfma_f32_16x16x32_bf16 a[40:43], v[32:35], v[140:143], a[40:43]
    v_mfma_f32_16x16x32_bf16 a[44:47], v[32:35], v[144:147], a[44:47]
    v_mfma_f32_16x16x32_bf16 a[48:51], v[36:39], v[132:135], a[48:51]
    v_mfma_f32_16x16x32_bf16 a[52:55], v[36:39], v[136:139], a[52:55]
    v_mfma_f32_16x16x32_bf16 a[56:59], v[36:39], v[140:143], a[56:59]
    v_mfma_f32_16x16x32_bf16 a[60:63], v[36:39], v[144:147], a[60:63]
    v_mfma_f32_16x16x32_bf16 a[64:67], v[40:43], v[132:135], a[64:67]
    v_mfma_f32_16x16x32_bf16 a[68:71], v[40:43], v[136:139], a[68:71]
    v_mfma_f32_16x16x32_bf16 a[72:75], v[40:43], v[140:143], a[72:75]
    v_mfma_f32_16x16x32_bf16 a[76:79], v[40:43], v[144:147], a[76:79]
    v_mfma_f32_16x16x32_bf16 a[80:83], v[44:47], v[132:135], a[80:83]
    v_mfma_f32_16x16x32_bf16 a[84:87], v[44:47], v[136:139], a[84:87]
    v_mfma_f32_16x16x32_bf16 a[88:91], v[44:47], v[140:143], a[88:91]
    v_mfma_f32_16x16x32_bf16 a[92:95], v[44:47], v[144:147], a[92:95]
    v_mfma_f32_16x16x32_bf16 a[96:99], v[48:51], v[132:135], a[96:99]
    v_mfma_f32_16x16x32_bf16 a[100:103], v[48:51], v[136:139], a[100:103]
    v_mfma_f32_16x16x32_bf16 a[104:107], v[48:51], v[140:143], a[104:107]
    v_mfma_f32_16x16x32_bf16 a[108:111], v[48:51], v[144:147], a[108:111]
    v_mfma_f32_16x16x32_bf16 a[112:115], v[52:55], v[132:135], a[112:115]
    v_mfma_f32_16x16x32_bf16 a[116:119], v[52:55], v[136:139], a[116:119]
    v_mfma_f32_16x16x32_bf16 a[120:123], v[52:55], v[140:143], a[120:123]
    v_mfma_f32_16x16x32_bf16 a[124:127], v[52:55], v[144:147], a[124:127]
    v_mfma_f32_16x16x32_bf16 a[128:131], v[56:59], v[132:135], a[128:131]
    v_mfma_f32_16x16x32_bf16 a[132:135], v[56:59], v[136:139], a[132:135]
    v_mfma_f32_16x16x32_bf16 a[136:139], v[56:59], v[140:143], a[136:139]
    v_mfma_f32_16x16x32_bf16 a[140:143], v[56:59], v[144:147], a[140:143]
    global_load_dwordx4 v[24:27], v164, s[18:19] offset:3072
    global_load_dwordx4 v[28:31], v165, s[18:19] offset:3072
    global_load_dwordx4 v[32:35], v166, s[18:19] offset:3072
    global_load_dwordx4 v[36:39], v167, s[18:19] offset:3072
    global_load_dwordx4 v[40:43], v168, s[18:19] offset:3072
    global_load_dwordx4 v[44:47], v169, s[18:19] offset:3072
    global_load_dwordx4 v[48:51], v170, s[18:19] offset:3072
    global_load_dwordx4 v[52:55], v171, s[18:19] offset:3072
    global_load_dwordx4 v[56:59], v172, s[18:19] offset:3072
    v_add_u32 v164, 4096, v164
    v_add_u32 v165, 4096, v165
    v_add_u32 v166, 4096, v166
    v_add_u32 v167, 4096, v167
    v_add_u32 v168, 4096, v168
    v_add_u32 v169, 4096, v169
    v_add_u32 v170, 4096, v170
    v_add_u32 v171, 4096, v171
    v_add_u32 v172, 4096, v172
    ds_read_b128 v[132:135], v23 offset:896
    ds_read_b128 v[136:139], v23 offset:19584
    ds_read_b128 v[140:143], v23 offset:38272
    ds_read_b128 v[144:147], v23 offset:56960
    s_waitcnt vmcnt(18) lgkmcnt(4)
    v_mfma_f32_16x16x32_bf16 a[0:3], v[60:63], v[148:151], a[0:3]
    v_mfma_f32_16x16x32_bf16 a[4:7], v[60:63], v[152:155], a[4:7]
    v_mfma_f32_16x16x32_bf16 a[8:11], v[60:63], v[156:159], a[8:11]
    v_mfma_f32_16x16x32_bf16 a[12:15], v[60:63], v[160:163], a[12:15]
    v_mfma_f32_16x16x32_bf16 a[16:19], v[64:67], v[148:151], a[16:19]
    v_mfma_f32_16x16x32_bf16 a[20:23], v[64:67], v[152:155], a[20:23]
    v_mfma_f32_16x16x32_bf16 a[24:27], v[64:67], v[156:159], a[24:27]
    v_mfma_f32_16x16x32_bf16 a[28:31], v[64:67], v[160:163], a[28:31]
    v_mfma_f32_16x16x32_bf16 a[32:35], v[68:71], v[148:151], a[32:35]
    v_mfma_f32_16x16x32_bf16 a[36:39], v[68:71], v[152:155], a[36:39]
    v_mfma_f32_16x16x32_bf16 a[40:43], v[68:71], v[156:159], a[40:43]
    v_mfma_f32_16x16x32_bf16 a[44:47], v[68:71], v[160:163], a[44:47]
    v_mfma_f32_16x16x32_bf16 a[48:51], v[72:75], v[148:151], a[48:51]
    v_mfma_f32_16x16x32_bf16 a[52:55], v[72:75], v[152:155], a[52:55]
    v_mfma_f32_16x16x32_bf16 a[56:59], v[72:75], v[156:159], a[56:59]
    v_mfma_f32_16x16x32_bf16 a[60:63], v[72:75], v[160:163], a[60:63]
    v_mfma_f32_16x16x32_bf16 a[64:67], v[76:79], v[148:151], a[64:67]
    v_mfma_f32_16x16x32_bf16 a[68:71], v[76:79], v[152:155], a[68:71]
    v_mfma_f32_16x16x32_bf16 a[72:75], v[76:79], v[156:159], a[72:75]
    v_mfma_f32_16x16x32_bf16 a[76:79], v[76:79], v[160:163], a[76:79]
    v_mfma_f32_16x16x32_bf16 a[80:83], v[80:83], v[148:151], a[80:83]
    v_mfma_f32_16x16x32_bf16 a[84:87], v[80:83], v[152:155], a[84:87]
    v_mfma_f32_16x16x32_bf16 a[88:91], v[80:83], v[156:159], a[88:91]
    v_mfma_f32_16x16x32_bf16 a[92:95], v[80:83], v[160:163], a[92:95]
    v_mfma_f32_16x16x32_bf16 a[96:99], v[84:87], v[148:151], a[96:99]
    v_mfma_f32_16x16x32_bf16 a[100:103], v[84:87], v[152:155], a[100:103]
    v_mfma_f32_16x16x32_bf16 a[104:107], v[84:87], v[156:159], a[104:107]
    v_mfma_f32_16x16x32_bf16 a[108:111], v[84:87], v[160:163], a[108:111]
    v_mfma_f32_16x16x32_bf16 a[112:115], v[88:91], v[148:151], a[112:115]
    v_mfma_f32_16x16x32_bf16 a[116:119], v[88:91], v[152:155], a[116:119]
    v_mfma_f32_16x16x32_bf16 a[120:123], v[88:91], v[156:159], a[120:123]
    v_mfma_f32_16x16x32_bf16 a[124:127], v[88:91], v[160:163], a[124:127]
    v_mfma_f32_16x16x32_bf16 a[128:131], v[92:95], v[148:151], a[128:131]
    v_mfma_f32_16x16x32_bf16 a[132:135], v[92:95], v[152:155], a[132:135]
    v_mfma_f32_16x16x32_bf16 a[136:139], v[92:95], v[156:159], a[136:139]
    v_mfma_f32_16x16x32_bf16 a[140:143], v[92:95], v[160:163], a[140:143]
    global_load_dwordx4 v[60:63], v164, s[18:19] offset:0
    global_load_dwordx4 v[64:67], v165, s[18:19] offset:0
    global_load_dwordx4 v[68:71], v166, s[18:19] offset:0
    global_load_dwordx4 v[72:75], v167, s[18:19] offset:0
    global_load_dwordx4 v[76:79], v168, s[18:19] offset:0
    global_load_dwordx4 v[80:83], v169, s[18:19] offset:0
    global_load_dwordx4 v[84:87], v170, s[18:19] offset:0
    global_load_dwordx4 v[88:91], v171, s[18:19] offset:0
    global_load_dwordx4 v[92:95], v172, s[18:19] offset:0
    ds_read_b128 v[148:151], v23 offset:960
    ds_read_b128 v[152:155], v23 offset:19648
    ds_read_b128 v[156:159], v23 offset:38336
    ds_read_b128 v[160:163], v23 offset:57024
    s_waitcnt vmcnt(18) lgkmcnt(4)
    v_mfma_f32_16x16x32_bf16 a[0:3], v[96:99], v[132:135], a[0:3]
    v_mfma_f32_16x16x32_bf16 a[4:7], v[96:99], v[136:139], a[4:7]
    v_mfma_f32_16x16x32_bf16 a[8:11], v[96:99], v[140:143], a[8:11]
    v_mfma_f32_16x16x32_bf16 a[12:15], v[96:99], v[144:147], a[12:15]
    v_mfma_f32_16x16x32_bf16 a[16:19], v[100:103], v[132:135], a[16:19]
    v_mfma_f32_16x16x32_bf16 a[20:23], v[100:103], v[136:139], a[20:23]
    v_mfma_f32_16x16x32_bf16 a[24:27], v[100:103], v[140:143], a[24:27]
    v_mfma_f32_16x16x32_bf16 a[28:31], v[100:103], v[144:147], a[28:31]
    v_mfma_f32_16x16x32_bf16 a[32:35], v[104:107], v[132:135], a[32:35]
    v_mfma_f32_16x16x32_bf16 a[36:39], v[104:107], v[136:139], a[36:39]
    v_mfma_f32_16x16x32_bf16 a[40:43], v[104:107], v[140:143], a[40:43]
    v_mfma_f32_16x16x32_bf16 a[44:47], v[104:107], v[144:147], a[44:47]
    v_mfma_f32_16x16x32_bf16 a[48:51], v[108:111], v[132:135], a[48:51]
    v_mfma_f32_16x16x32_bf16 a[52:55], v[108:111], v[136:139], a[52:55]
    v_mfma_f32_16x16x32_bf16 a[56:59], v[108:111], v[140:143], a[56:59]
    v_mfma_f32_16x16x32_bf16 a[60:63], v[108:111], v[144:147], a[60:63]
    v_mfma_f32_16x16x32_bf16 a[64:67], v[112:115], v[132:135], a[64:67]
    v_mfma_f32_16x16x32_bf16 a[68:71], v[112:115], v[136:139], a[68:71]
    v_mfma_f32_16x16x32_bf16 a[72:75], v[112:115], v[140:143], a[72:75]
    v_mfma_f32_16x16x32_bf16 a[76:79], v[112:115], v[144:147], a[76:79]
    v_mfma_f32_16x16x32_bf16 a[80:83], v[116:119], v[132:135], a[80:83]
    v_mfma_f32_16x16x32_bf16 a[84:87], v[116:119], v[136:139], a[84:87]
    v_mfma_f32_16x16x32_bf16 a[88:91], v[116:119], v[140:143], a[88:91]
    v_mfma_f32_16x16x32_bf16 a[92:95], v[116:119], v[144:147], a[92:95]
    v_mfma_f32_16x16x32_bf16 a[96:99], v[120:123], v[132:135], a[96:99]
    v_mfma_f32_16x16x32_bf16 a[100:103], v[120:123], v[136:139], a[100:103]
    v_mfma_f32_16x16x32_bf16 a[104:107], v[120:123], v[140:143], a[104:107]
    v_mfma_f32_16x16x32_bf16 a[108:111], v[120:123], v[144:147], a[108:111]
    v_mfma_f32_16x16x32_bf16 a[112:115], v[124:127], v[132:135], a[112:115]
    v_mfma_f32_16x16x32_bf16 a[116:119], v[124:127], v[136:139], a[116:119]
    v_mfma_f32_16x16x32_bf16 a[120:123], v[124:127], v[140:143], a[120:123]
    v_mfma_f32_16x16x32_bf16 a[124:127], v[124:127], v[144:147], a[124:127]
    v_mfma_f32_16x16x32_bf16 a[128:131], v[128:131], v[132:135], a[128:131]
    v_mfma_f32_16x16x32_bf16 a[132:135], v[128:131], v[136:139], a[132:135]
    v_mfma_f32_16x16x32_bf16 a[136:139], v[128:131], v[140:143], a[136:139]
    v_mfma_f32_16x16x32_bf16 a[140:143], v[128:131], v[144:147], a[140:143]
    global_load_dwordx4 v[96:99], v164, s[18:19] offset:1024
    global_load_dwordx4 v[100:103], v165, s[18:19] offset:1024
    global_load_dwordx4 v[104:107], v166, s[18:19] offset:1024
    global_load_dwordx4 v[108:111], v167, s[18:19] offset:1024
    global_load_dwordx4 v[112:115], v168, s[18:19] offset:1024
    global_load_dwordx4 v[116:119], v169, s[18:19] offset:1024
    global_load_dwordx4 v[120:123], v170, s[18:19] offset:1024
    global_load_dwordx4 v[124:127], v171, s[18:19] offset:1024
    global_load_dwordx4 v[128:131], v172, s[18:19] offset:1024
    ds_read_b128 v[132:135], v23 offset:1024
    ds_read_b128 v[136:139], v23 offset:19712
    ds_read_b128 v[140:143], v23 offset:38400
    ds_read_b128 v[144:147], v23 offset:57088
    s_waitcnt vmcnt(18) lgkmcnt(4)
    v_mfma_f32_16x16x32_bf16 a[0:3], v[24:27], v[148:151], a[0:3]
    v_mfma_f32_16x16x32_bf16 a[4:7], v[24:27], v[152:155], a[4:7]
    v_mfma_f32_16x16x32_bf16 a[8:11], v[24:27], v[156:159], a[8:11]
    v_mfma_f32_16x16x32_bf16 a[12:15], v[24:27], v[160:163], a[12:15]
    v_mfma_f32_16x16x32_bf16 a[16:19], v[28:31], v[148:151], a[16:19]
    v_mfma_f32_16x16x32_bf16 a[20:23], v[28:31], v[152:155], a[20:23]
    v_mfma_f32_16x16x32_bf16 a[24:27], v[28:31], v[156:159], a[24:27]
    v_mfma_f32_16x16x32_bf16 a[28:31], v[28:31], v[160:163], a[28:31]
    v_mfma_f32_16x16x32_bf16 a[32:35], v[32:35], v[148:151], a[32:35]
    v_mfma_f32_16x16x32_bf16 a[36:39], v[32:35], v[152:155], a[36:39]
    v_mfma_f32_16x16x32_bf16 a[40:43], v[32:35], v[156:159], a[40:43]
    v_mfma_f32_16x16x32_bf16 a[44:47], v[32:35], v[160:163], a[44:47]
    v_mfma_f32_16x16x32_bf16 a[48:51], v[36:39], v[148:151], a[48:51]
    v_mfma_f32_16x16x32_bf16 a[52:55], v[36:39], v[152:155], a[52:55]
    v_mfma_f32_16x16x32_bf16 a[56:59], v[36:39], v[156:159], a[56:59]
    v_mfma_f32_16x16x32_bf16 a[60:63], v[36:39], v[160:163], a[60:63]
    v_mfma_f32_16x16x32_bf16 a[64:67], v[40:43], v[148:151], a[64:67]
    v_mfma_f32_16x16x32_bf16 a[68:71], v[40:43], v[152:155], a[68:71]
    v_mfma_f32_16x16x32_bf16 a[72:75], v[40:43], v[156:159], a[72:75]
    v_mfma_f32_16x16x32_bf16 a[76:79], v[40:43], v[160:163], a[76:79]
    v_mfma_f32_16x16x32_bf16 a[80:83], v[44:47], v[148:151], a[80:83]
    v_mfma_f32_16x16x32_bf16 a[84:87], v[44:47], v[152:155], a[84:87]
    v_mfma_f32_16x16x32_bf16 a[88:91], v[44:47], v[156:159], a[88:91]
    v_mfma_f32_16x16x32_bf16 a[92:95], v[44:47], v[160:163], a[92:95]
    v_mfma_f32_16x16x32_bf16 a[96:99], v[48:51], v[148:151], a[96:99]
    v_mfma_f32_16x16x32_bf16 a[100:103], v[48:51], v[152:155], a[100:103]
    v_mfma_f32_16x16x32_bf16 a[104:107], v[48:51], v[156:159], a[104:107]
    v_mfma_f32_16x16x32_bf16 a[108:111], v[48:51], v[160:163], a[108:111]
    v_mfma_f32_16x16x32_bf16 a[112:115], v[52:55], v[148:151], a[112:115]
    v_mfma_f32_16x16x32_bf16 a[116:119], v[52:55], v[152:155], a[116:119]
    v_mfma_f32_16x16x32_bf16 a[120:123], v[52:55], v[156:159], a[120:123]
    v_mfma_f32_16x16x32_bf16 a[124:127], v[52:55], v[160:163], a[124:127]
    v_mfma_f32_16x16x32_bf16 a[128:131], v[56:59], v[148:151], a[128:131]
    v_mfma_f32_16x16x32_bf16 a[132:135], v[56:59], v[152:155], a[132:135]
    v_mfma_f32_16x16x32_bf16 a[136:139], v[56:59], v[156:159], a[136:139]
    v_mfma_f32_16x16x32_bf16 a[140:143], v[56:59], v[160:163], a[140:143]
    ds_read_b128 v[148:151], v23 offset:1088
    ds_read_b128 v[152:155], v23 offset:19776
    ds_read_b128 v[156:159], v23 offset:38464
    ds_read_b128 v[160:163], v23 offset:57152
    s_waitcnt vmcnt(9) lgkmcnt(4)
    v_mfma_f32_16x16x32_bf16 a[0:3], v[60:63], v[132:135], a[0:3]
    v_mfma_f32_16x16x32_bf16 a[4:7], v[60:63], v[136:139], a[4:7]
    v_mfma_f32_16x16x32_bf16 a[8:11], v[60:63], v[140:143], a[8:11]
    v_mfma_f32_16x16x32_bf16 a[12:15], v[60:63], v[144:147], a[12:15]
    v_mfma_f32_16x16x32_bf16 a[16:19], v[64:67], v[132:135], a[16:19]
    v_mfma_f32_16x16x32_bf16 a[20:23], v[64:67], v[136:139], a[20:23]
    v_mfma_f32_16x16x32_bf16 a[24:27], v[64:67], v[140:143], a[24:27]
    v_mfma_f32_16x16x32_bf16 a[28:31], v[64:67], v[144:147], a[28:31]
    v_mfma_f32_16x16x32_bf16 a[32:35], v[68:71], v[132:135], a[32:35]
    v_mfma_f32_16x16x32_bf16 a[36:39], v[68:71], v[136:139], a[36:39]
    v_mfma_f32_16x16x32_bf16 a[40:43], v[68:71], v[140:143], a[40:43]
    v_mfma_f32_16x16x32_bf16 a[44:47], v[68:71], v[144:147], a[44:47]
    v_mfma_f32_16x16x32_bf16 a[48:51], v[72:75], v[132:135], a[48:51]
    v_mfma_f32_16x16x32_bf16 a[52:55], v[72:75], v[136:139], a[52:55]
    v_mfma_f32_16x16x32_bf16 a[56:59], v[72:75], v[140:143], a[56:59]
    v_mfma_f32_16x16x32_bf16 a[60:63], v[72:75], v[144:147], a[60:63]
    v_mfma_f32_16x16x32_bf16 a[64:67], v[76:79], v[132:135], a[64:67]
    v_mfma_f32_16x16x32_bf16 a[68:71], v[76:79], v[136:139], a[68:71]
    v_mfma_f32_16x16x32_bf16 a[72:75], v[76:79], v[140:143], a[72:75]
    v_mfma_f32_16x16x32_bf16 a[76:79], v[76:79], v[144:147], a[76:79]
    v_mfma_f32_16x16x32_bf16 a[80:83], v[80:83], v[132:135], a[80:83]
    v_mfma_f32_16x16x32_bf16 a[84:87], v[80:83], v[136:139], a[84:87]
    v_mfma_f32_16x16x32_bf16 a[88:91], v[80:83], v[140:143], a[88:91]
    v_mfma_f32_16x16x32_bf16 a[92:95], v[80:83], v[144:147], a[92:95]
    v_mfma_f32_16x16x32_bf16 a[96:99], v[84:87], v[132:135], a[96:99]
    v_mfma_f32_16x16x32_bf16 a[100:103], v[84:87], v[136:139], a[100:103]
    v_mfma_f32_16x16x32_bf16 a[104:107], v[84:87], v[140:143], a[104:107]
    v_mfma_f32_16x16x32_bf16 a[108:111], v[84:87], v[144:147], a[108:111]
    v_mfma_f32_16x16x32_bf16 a[112:115], v[88:91], v[132:135], a[112:115]
    v_mfma_f32_16x16x32_bf16 a[116:119], v[88:91], v[136:139], a[116:119]
    v_mfma_f32_16x16x32_bf16 a[120:123], v[88:91], v[140:143], a[120:123]
    v_mfma_f32_16x16x32_bf16 a[124:127], v[88:91], v[144:147], a[124:127]
    v_mfma_f32_16x16x32_bf16 a[128:131], v[92:95], v[132:135], a[128:131]
    v_mfma_f32_16x16x32_bf16 a[132:135], v[92:95], v[136:139], a[132:135]
    v_mfma_f32_16x16x32_bf16 a[136:139], v[92:95], v[140:143], a[136:139]
    v_mfma_f32_16x16x32_bf16 a[140:143], v[92:95], v[144:147], a[140:143]
    s_waitcnt vmcnt(0) lgkmcnt(0)
    v_mfma_f32_16x16x32_bf16 a[0:3], v[96:99], v[148:151], a[0:3]
    v_mfma_f32_16x16x32_bf16 a[4:7], v[96:99], v[152:155], a[4:7]
    v_mfma_f32_16x16x32_bf16 a[8:11], v[96:99], v[156:159], a[8:11]
    v_mfma_f32_16x16x32_bf16 a[12:15], v[96:99], v[160:163], a[12:15]
    v_mfma_f32_16x16x32_bf16 a[16:19], v[100:103], v[148:151], a[16:19]
    v_mfma_f32_16x16x32_bf16 a[20:23], v[100:103], v[152:155], a[20:23]
    v_mfma_f32_16x16x32_bf16 a[24:27], v[100:103], v[156:159], a[24:27]
    v_mfma_f32_16x16x32_bf16 a[28:31], v[100:103], v[160:163], a[28:31]
    v_mfma_f32_16x16x32_bf16 a[32:35], v[104:107], v[148:151], a[32:35]
    v_mfma_f32_16x16x32_bf16 a[36:39], v[104:107], v[152:155], a[36:39]
    v_mfma_f32_16x16x32_bf16 a[40:43], v[104:107], v[156:159], a[40:43]
    v_mfma_f32_16x16x32_bf16 a[44:47], v[104:107], v[160:163], a[44:47]
    v_mfma_f32_16x16x32_bf16 a[48:51], v[108:111], v[148:151], a[48:51]
    v_mfma_f32_16x16x32_bf16 a[52:55], v[108:111], v[152:155], a[52:55]
    v_mfma_f32_16x16x32_bf16 a[56:59], v[108:111], v[156:159], a[56:59]
    v_mfma_f32_16x16x32_bf16 a[60:63], v[108:111], v[160:163], a[60:63]
    v_mfma_f32_16x16x32_bf16 a[64:67], v[112:115], v[148:151], a[64:67]
    v_mfma_f32_16x16x32_bf16 a[68:71], v[112:115], v[152:155], a[68:71]
    v_mfma_f32_16x16x32_bf16 a[72:75], v[112:115], v[156:159], a[72:75]
    v_mfma_f32_16x16x32_bf16 a[76:79], v[112:115], v[160:163], a[76:79]
    v_mfma_f32_16x16x32_bf16 a[80:83], v[116:119], v[148:151], a[80:83]
    v_mfma_f32_16x16x32_bf16 a[84:87], v[116:119], v[152:155], a[84:87]
    v_mfma_f32_16x16x32_bf16 a[88:91], v[116:119], v[156:159], a[88:91]
    v_mfma_f32_16x16x32_bf16 a[92:95], v[116:119], v[160:163], a[92:95]
    v_mfma_f32_16x16x32_bf16 a[96:99], v[120:123], v[148:151], a[96:99]
    v_mfma_f32_16x16x32_bf16 a[100:103], v[120:123], v[152:155], a[100:103]
    v_mfma_f32_16x16x32_bf16 a[104:107], v[120:123], v[156:159], a[104:107]
    v_mfma_f32_16x16x32_bf16 a[108:111], v[120:123], v[160:163], a[108:111]
    v_mfma_f32_16x16x32_bf16 a[112:115], v[124:127], v[148:151], a[112:115]
    v_mfma_f32_16x16x32_bf16 a[116:119], v[124:127], v[152:155], a[116:119]
    v_mfma_f32_16x16x32_bf16 a[120:123], v[124:127], v[156:159], a[120:123]
    v_mfma_f32_16x16x32_bf16 a[124:127], v[124:127], v[160:163], a[124:127]
    v_mfma_f32_16x16x32_bf16 a[128:131], v[128:131], v[148:151], a[128:131]
    v_mfma_f32_16x16x32_bf16 a[132:135], v[128:131], v[152:155], a[132:135]
    v_mfma_f32_16x16x32_bf16 a[136:139], v[128:131], v[156:159], a[136:139]
    v_mfma_f32_16x16x32_bf16 a[140:143], v[128:131], v[160:163], a[140:143]
    s_nop 15
    v_mul_u32_u24 v20, 1168, v16
    v_lshl_add_u32 v20, v17, 3, v20
    v_mul_u32_u24 v21, 288, v2
    v_add_u32 v20, v20, v21
    v_add_u32 v20, 74752, v20
    s_mov_b32 s11, 0xbfb8aa3b
    v_accvgpr_read_b32 v24, a0
    v_accvgpr_read_b32 v25, a1
    v_accvgpr_read_b32 v26, a2
    v_accvgpr_read_b32 v27, a3
    v_cvt_pk_bf16_f32 v24, v24, v25
    v_cvt_pk_bf16_f32 v26, v26, v27
    v_and_b32 v25, 0xffff0000, v24
    v_lshlrev_b32 v24, 16, v24
    v_and_b32 v27, 0xffff0000, v26
    v_lshlrev_b32 v26, 16, v26
    v_mul_f32 v28, s11, v24
    v_mul_f32 v29, s11, v25
    v_mul_f32 v30, s11, v26
    v_mul_f32 v31, s11, v27
    v_exp_f32 v28, v28
    v_exp_f32 v29, v29
    v_exp_f32 v30, v30
    v_exp_f32 v31, v31
    s_nop 0
    v_add_f32 v28, 1.0, v28
    v_add_f32 v29, 1.0, v29
    v_add_f32 v30, 1.0, v30
    v_add_f32 v31, 1.0, v31
    v_rcp_f32 v28, v28
    v_rcp_f32 v29, v29
    v_rcp_f32 v30, v30
    v_rcp_f32 v31, v31
    s_nop 0
    v_mul_f32 v24, v24, v28
    v_mul_f32 v25, v25, v29
    v_mul_f32 v26, v26, v30
    v_mul_f32 v27, v27, v31
    v_cvt_pk_bf16_f32 v24, v24, v25
    v_cvt_pk_bf16_f32 v25, v26, v27
    ds_write_b64 v20, v[24:25] offset:0
    v_accvgpr_read_b32 v24, a4
    v_accvgpr_read_b32 v25, a5
    v_accvgpr_read_b32 v26, a6
    v_accvgpr_read_b32 v27, a7
    v_cvt_pk_bf16_f32 v24, v24, v25
    v_cvt_pk_bf16_f32 v26, v26, v27
    v_and_b32 v25, 0xffff0000, v24
    v_lshlrev_b32 v24, 16, v24
    v_and_b32 v27, 0xffff0000, v26
    v_lshlrev_b32 v26, 16, v26
    v_mul_f32 v28, s11, v24
    v_mul_f32 v29, s11, v25
    v_mul_f32 v30, s11, v26
    v_mul_f32 v31, s11, v27
    v_exp_f32 v28, v28
    v_exp_f32 v29, v29
    v_exp_f32 v30, v30
    v_exp_f32 v31, v31
    s_nop 0
    v_add_f32 v28, 1.0, v28
    v_add_f32 v29, 1.0, v29
    v_add_f32 v30, 1.0, v30
    v_add_f32 v31, 1.0, v31
    v_rcp_f32 v28, v28
    v_rcp_f32 v29, v29
    v_rcp_f32 v30, v30
    v_rcp_f32 v31, v31
    s_nop 0
    v_mul_f32 v24, v24, v28
    v_mul_f32 v25, v25, v29
    v_mul_f32 v26, v26, v30
    v_mul_f32 v27, v27, v31
    v_cvt_pk_bf16_f32 v24, v24, v25
    v_cvt_pk_bf16_f32 v25, v26, v27
    ds_write_b64 v20, v[24:25] offset:18688
    v_accvgpr_read_b32 v24, a8
    v_accvgpr_read_b32 v25, a9
    v_accvgpr_read_b32 v26, a10
    v_accvgpr_read_b32 v27, a11
    v_cvt_pk_bf16_f32 v24, v24, v25
    v_cvt_pk_bf16_f32 v26, v26, v27
    v_and_b32 v25, 0xffff0000, v24
    v_lshlrev_b32 v24, 16, v24
    v_and_b32 v27, 0xffff0000, v26
    v_lshlrev_b32 v26, 16, v26
    v_mul_f32 v28, s11, v24
    v_mul_f32 v29, s11, v25
    v_mul_f32 v30, s11, v26
    v_mul_f32 v31, s11, v27
    v_exp_f32 v28, v28
    v_exp_f32 v29, v29
    v_exp_f32 v30, v30
    v_exp_f32 v31, v31
    s_nop 0
    v_add_f32 v28, 1.0, v28
    v_add_f32 v29, 1.0, v29
    v_add_f32 v30, 1.0, v30
    v_add_f32 v31, 1.0, v31
    v_rcp_f32 v28, v28
    v_rcp_f32 v29, v29
    v_rcp_f32 v30, v30
    v_rcp_f32 v31, v31
    s_nop 0
    v_mul_f32 v24, v24, v28
    v_mul_f32 v25, v25, v29
    v_mul_f32 v26, v26, v30
    v_mul_f32 v27, v27, v31
    v_cvt_pk_bf16_f32 v24, v24, v25
    v_cvt_pk_bf16_f32 v25, v26, v27
    ds_write_b64 v20, v[24:25] offset:37376
    v_accvgpr_read_b32 v24, a12
    v_accvgpr_read_b32 v25, a13
    v_accvgpr_read_b32 v26, a14
    v_accvgpr_read_b32 v27, a15
    v_cvt_pk_bf16_f32 v24, v24, v25
    v_cvt_pk_bf16_f32 v26, v26, v27
    v_and_b32 v25, 0xffff0000, v24
    v_lshlrev_b32 v24, 16, v24
    v_and_b32 v27, 0xffff0000, v26
    v_lshlrev_b32 v26, 16, v26
    v_mul_f32 v28, s11, v24
    v_mul_f32 v29, s11, v25
    v_mul_f32 v30, s11, v26
    v_mul_f32 v31, s11, v27
    v_exp_f32 v28, v28
    v_exp_f32 v29, v29
    v_exp_f32 v30, v30
    v_exp_f32 v31, v31
    s_nop 0
    v_add_f32 v28, 1.0, v28
    v_add_f32 v29, 1.0, v29
    v_add_f32 v30, 1.0, v30
    v_add_f32 v31, 1.0, v31
    v_rcp_f32 v28, v28
    v_rcp_f32 v29, v29
    v_rcp_f32 v30, v30
    v_rcp_f32 v31, v31
    s_nop 0
    v_mul_f32 v24, v24, v28
    v_mul_f32 v25, v25, v29
    v_mul_f32 v26, v26, v30
    v_mul_f32 v27, v27, v31
    v_cvt_pk_bf16_f32 v24, v24, v25
    v_cvt_pk_bf16_f32 v25, v26, v27
    ds_write_b64 v20, v[24:25] offset:56064
    v_accvgpr_read_b32 v24, a16
    v_accvgpr_read_b32 v25, a17
    v_accvgpr_read_b32 v26, a18
    v_accvgpr_read_b32 v27, a19
    v_cvt_pk_bf16_f32 v24, v24, v25
    v_cvt_pk_bf16_f32 v26, v26, v27
    v_and_b32 v25, 0xffff0000, v24
    v_lshlrev_b32 v24, 16, v24
    v_and_b32 v27, 0xffff0000, v26
    v_lshlrev_b32 v26, 16, v26
    v_mul_f32 v28, s11, v24
    v_mul_f32 v29, s11, v25
    v_mul_f32 v30, s11, v26
    v_mul_f32 v31, s11, v27
    v_exp_f32 v28, v28
    v_exp_f32 v29, v29
    v_exp_f32 v30, v30
    v_exp_f32 v31, v31
    s_nop 0
    v_add_f32 v28, 1.0, v28
    v_add_f32 v29, 1.0, v29
    v_add_f32 v30, 1.0, v30
    v_add_f32 v31, 1.0, v31
    v_rcp_f32 v28, v28
    v_rcp_f32 v29, v29
    v_rcp_f32 v30, v30
    v_rcp_f32 v31, v31
    s_nop 0
    v_mul_f32 v24, v24, v28
    v_mul_f32 v25, v25, v29
    v_mul_f32 v26, v26, v30
    v_mul_f32 v27, v27, v31
    v_cvt_pk_bf16_f32 v24, v24, v25
    v_cvt_pk_bf16_f32 v25, v26, v27
    ds_write_b64 v20, v[24:25] offset:32
    v_accvgpr_read_b32 v24, a20
    v_accvgpr_read_b32 v25, a21
    v_accvgpr_read_b32 v26, a22
    v_accvgpr_read_b32 v27, a23
    v_cvt_pk_bf16_f32 v24, v24, v25
    v_cvt_pk_bf16_f32 v26, v26, v27
    v_and_b32 v25, 0xffff0000, v24
    v_lshlrev_b32 v24, 16, v24
    v_and_b32 v27, 0xffff0000, v26
    v_lshlrev_b32 v26, 16, v26
    v_mul_f32 v28, s11, v24
    v_mul_f32 v29, s11, v25
    v_mul_f32 v30, s11, v26
    v_mul_f32 v31, s11, v27
    v_exp_f32 v28, v28
    v_exp_f32 v29, v29
    v_exp_f32 v30, v30
    v_exp_f32 v31, v31
    s_nop 0
    v_add_f32 v28, 1.0, v28
    v_add_f32 v29, 1.0, v29
    v_add_f32 v30, 1.0, v30
    v_add_f32 v31, 1.0, v31
    v_rcp_f32 v28, v28
    v_rcp_f32 v29, v29
    v_rcp_f32 v30, v30
    v_rcp_f32 v31, v31
    s_nop 0
    v_mul_f32 v24, v24, v28
    v_mul_f32 v25, v25, v29
    v_mul_f32 v26, v26, v30
    v_mul_f32 v27, v27, v31
    v_cvt_pk_bf16_f32 v24, v24, v25
    v_cvt_pk_bf16_f32 v25, v26, v27
    ds_write_b64 v20, v[24:25] offset:18720
    v_accvgpr_read_b32 v24, a24
    v_accvgpr_read_b32 v25, a25
    v_accvgpr_read_b32 v26, a26
    v_accvgpr_read_b32 v27, a27
    v_cvt_pk_bf16_f32 v24, v24, v25
    v_cvt_pk_bf16_f32 v26, v26, v27
    v_and_b32 v25, 0xffff0000, v24
    v_lshlrev_b32 v24, 16, v24
    v_and_b32 v27, 0xffff0000, v26
    v_lshlrev_b32 v26, 16, v26
    v_mul_f32 v28, s11, v24
    v_mul_f32 v29, s11, v25
    v_mul_f32 v30, s11, v26
    v_mul_f32 v31, s11, v27
    v_exp_f32 v28, v28
    v_exp_f32 v29, v29
    v_exp_f32 v30, v30
    v_exp_f32 v31, v31
    s_nop 0
    v_add_f32 v28, 1.0, v28
    v_add_f32 v29, 1.0, v29
    v_add_f32 v30, 1.0, v30
    v_add_f32 v31, 1.0, v31
    v_rcp_f32 v28, v28
    v_rcp_f32 v29, v29
    v_rcp_f32 v30, v30
    v_rcp_f32 v31, v31
    s_nop 0
    v_mul_f32 v24, v24, v28
    v_mul_f32 v25, v25, v29
    v_mul_f32 v26, v26, v30
    v_mul_f32 v27, v27, v31
    v_cvt_pk_bf16_f32 v24, v24, v25
    v_cvt_pk_bf16_f32 v25, v26, v27
    ds_write_b64 v20, v[24:25] offset:37408
    v_accvgpr_read_b32 v24, a28
    v_accvgpr_read_b32 v25, a29
    v_accvgpr_read_b32 v26, a30
    v_accvgpr_read_b32 v27, a31
    v_cvt_pk_bf16_f32 v24, v24, v25
    v_cvt_pk_bf16_f32 v26, v26, v27
    v_and_b32 v25, 0xffff0000, v24
    v_lshlrev_b32 v24, 16, v24
    v_and_b32 v27, 0xffff0000, v26
    v_lshlrev_b32 v26, 16, v26
    v_mul_f32 v28, s11, v24
    v_mul_f32 v29, s11, v25
    v_mul_f32 v30, s11, v26
    v_mul_f32 v31, s11, v27
    v_exp_f32 v28, v28
    v_exp_f32 v29, v29
    v_exp_f32 v30, v30
    v_exp_f32 v31, v31
    s_nop 0
    v_add_f32 v28, 1.0, v28
    v_add_f32 v29, 1.0, v29
    v_add_f32 v30, 1.0, v30
    v_add_f32 v31, 1.0, v31
    v_rcp_f32 v28, v28
    v_rcp_f32 v29, v29
    v_rcp_f32 v30, v30
    v_rcp_f32 v31, v31
    s_nop 0
    v_mul_f32 v24, v24, v28
    v_mul_f32 v25, v25, v29
    v_mul_f32 v26, v26, v30
    v_mul_f32 v27, v27, v31
    v_cvt_pk_bf16_f32 v24, v24, v25
    v_cvt_pk_bf16_f32 v25, v26, v27
    ds_write_b64 v20, v[24:25] offset:56096
    v_accvgpr_read_b32 v24, a32
    v_accvgpr_read_b32 v25, a33
    v_accvgpr_read_b32 v26, a34
    v_accvgpr_read_b32 v27, a35
    v_cvt_pk_bf16_f32 v24, v24, v25
    v_cvt_pk_bf16_f32 v26, v26, v27
    v_and_b32 v25, 0xffff0000, v24
    v_lshlrev_b32 v24, 16, v24
    v_and_b32 v27, 0xffff0000, v26
    v_lshlrev_b32 v26, 16, v26
    v_mul_f32 v28, s11, v24
    v_mul_f32 v29, s11, v25
    v_mul_f32 v30, s11, v26
    v_mul_f32 v31, s11, v27
    v_exp_f32 v28, v28
    v_exp_f32 v29, v29
    v_exp_f32 v30, v30
    v_exp_f32 v31, v31
    s_nop 0
    v_add_f32 v28, 1.0, v28
    v_add_f32 v29, 1.0, v29
    v_add_f32 v30, 1.0, v30
    v_add_f32 v31, 1.0, v31
    v_rcp_f32 v28, v28
    v_rcp_f32 v29, v29
    v_rcp_f32 v30, v30
    v_rcp_f32 v31, v31
    s_nop 0
    v_mul_f32 v24, v24, v28
    v_mul_f32 v25, v25, v29
    v_mul_f32 v26, v26, v30
    v_mul_f32 v27, v27, v31
    v_cvt_pk_bf16_f32 v24, v24, v25
    v_cvt_pk_bf16_f32 v25, v26, v27
    ds_write_b64 v20, v[24:25] offset:64
    v_accvgpr_read_b32 v24, a36
    v_accvgpr_read_b32 v25, a37
    v_accvgpr_read_b32 v26, a38
    v_accvgpr_read_b32 v27, a39
    v_cvt_pk_bf16_f32 v24, v24, v25
    v_cvt_pk_bf16_f32 v26, v26, v27
    v_and_b32 v25, 0xffff0000, v24
    v_lshlrev_b32 v24, 16, v24
    v_and_b32 v27, 0xffff0000, v26
    v_lshlrev_b32 v26, 16, v26
    v_mul_f32 v28, s11, v24
    v_mul_f32 v29, s11, v25
    v_mul_f32 v30, s11, v26
    v_mul_f32 v31, s11, v27
    v_exp_f32 v28, v28
    v_exp_f32 v29, v29
    v_exp_f32 v30, v30
    v_exp_f32 v31, v31
    s_nop 0
    v_add_f32 v28, 1.0, v28
    v_add_f32 v29, 1.0, v29
    v_add_f32 v30, 1.0, v30
    v_add_f32 v31, 1.0, v31
    v_rcp_f32 v28, v28
    v_rcp_f32 v29, v29
    v_rcp_f32 v30, v30
    v_rcp_f32 v31, v31
    s_nop 0
    v_mul_f32 v24, v24, v28
    v_mul_f32 v25, v25, v29
    v_mul_f32 v26, v26, v30
    v_mul_f32 v27, v27, v31
    v_cvt_pk_bf16_f32 v24, v24, v25
    v_cvt_pk_bf16_f32 v25, v26, v27
    ds_write_b64 v20, v[24:25] offset:18752
    v_accvgpr_read_b32 v24, a40
    v_accvgpr_read_b32 v25, a41
    v_accvgpr_read_b32 v26, a42
    v_accvgpr_read_b32 v27, a43
    v_cvt_pk_bf16_f32 v24, v24, v25
    v_cvt_pk_bf16_f32 v26, v26, v27
    v_and_b32 v25, 0xffff0000, v24
    v_lshlrev_b32 v24, 16, v24
    v_and_b32 v27, 0xffff0000, v26
    v_lshlrev_b32 v26, 16, v26
    v_mul_f32 v28, s11, v24
    v_mul_f32 v29, s11, v25
    v_mul_f32 v30, s11, v26
    v_mul_f32 v31, s11, v27
    v_exp_f32 v28, v28
    v_exp_f32 v29, v29
    v_exp_f32 v30, v30
    v_exp_f32 v31, v31
    s_nop 0
    v_add_f32 v28, 1.0, v28
    v_add_f32 v29, 1.0, v29
    v_add_f32 v30, 1.0, v30
    v_add_f32 v31, 1.0, v31
    v_rcp_f32 v28, v28
    v_rcp_f32 v29, v29
    v_rcp_f32 v30, v30
    v_rcp_f32 v31, v31
    s_nop 0
    v_mul_f32 v24, v24, v28
    v_mul_f32 v25, v25, v29
    v_mul_f32 v26, v26, v30
    v_mul_f32 v27, v27, v31
    v_cvt_pk_bf16_f32 v24, v24, v25
    v_cvt_pk_bf16_f32 v25, v26, v27
    ds_write_b64 v20, v[24:25] offset:37440
    v_accvgpr_read_b32 v24, a44
    v_accvgpr_read_b32 v25, a45
    v_accvgpr_read_b32 v26, a46
    v_accvgpr_read_b32 v27, a47
    v_cvt_pk_bf16_f32 v24, v24, v25
    v_cvt_pk_bf16_f32 v26, v26, v27
    v_and_b32 v25, 0xffff0000, v24
    v_lshlrev_b32 v24, 16, v24
    v_and_b32 v27, 0xffff0000, v26
    v_lshlrev_b32 v26, 16, v26
    v_mul_f32 v28, s11, v24
    v_mul_f32 v29, s11, v25
    v_mul_f32 v30, s11, v26
    v_mul_f32 v31, s11, v27
    v_exp_f32 v28, v28
    v_exp_f32 v29, v29
    v_exp_f32 v30, v30
    v_exp_f32 v31, v31
    s_nop 0
    v_add_f32 v28, 1.0, v28
    v_add_f32 v29, 1.0, v29
    v_add_f32 v30, 1.0, v30
    v_add_f32 v31, 1.0, v31
    v_rcp_f32 v28, v28
    v_rcp_f32 v29, v29
    v_rcp_f32 v30, v30
    v_rcp_f32 v31, v31
    s_nop 0
    v_mul_f32 v24, v24, v28
    v_mul_f32 v25, v25, v29
    v_mul_f32 v26, v26, v30
    v_mul_f32 v27, v27, v31
    v_cvt_pk_bf16_f32 v24, v24, v25
    v_cvt_pk_bf16_f32 v25, v26, v27
    ds_write_b64 v20, v[24:25] offset:56128
    v_accvgpr_read_b32 v24, a48
    v_accvgpr_read_b32 v25, a49
    v_accvgpr_read_b32 v26, a50
    v_accvgpr_read_b32 v27, a51
    v_cvt_pk_bf16_f32 v24, v24, v25
    v_cvt_pk_bf16_f32 v26, v26, v27
    v_and_b32 v25, 0xffff0000, v24
    v_lshlrev_b32 v24, 16, v24
    v_and_b32 v27, 0xffff0000, v26
    v_lshlrev_b32 v26, 16, v26
    v_mul_f32 v28, s11, v24
    v_mul_f32 v29, s11, v25
    v_mul_f32 v30, s11, v26
    v_mul_f32 v31, s11, v27
    v_exp_f32 v28, v28
    v_exp_f32 v29, v29
    v_exp_f32 v30, v30
    v_exp_f32 v31, v31
    s_nop 0
    v_add_f32 v28, 1.0, v28
    v_add_f32 v29, 1.0, v29
    v_add_f32 v30, 1.0, v30
    v_add_f32 v31, 1.0, v31
    v_rcp_f32 v28, v28
    v_rcp_f32 v29, v29
    v_rcp_f32 v30, v30
    v_rcp_f32 v31, v31
    s_nop 0
    v_mul_f32 v24, v24, v28
    v_mul_f32 v25, v25, v29
    v_mul_f32 v26, v26, v30
    v_mul_f32 v27, v27, v31
    v_cvt_pk_bf16_f32 v24, v24, v25
    v_cvt_pk_bf16_f32 v25, v26, v27
    ds_write_b64 v20, v[24:25] offset:96
    v_accvgpr_read_b32 v24, a52
    v_accvgpr_read_b32 v25, a53
    v_accvgpr_read_b32 v26, a54
    v_accvgpr_read_b32 v27, a55
    v_cvt_pk_bf16_f32 v24, v24, v25
    v_cvt_pk_bf16_f32 v26, v26, v27
    v_and_b32 v25, 0xffff0000, v24
    v_lshlrev_b32 v24, 16, v24
    v_and_b32 v27, 0xffff0000, v26
    v_lshlrev_b32 v26, 16, v26
    v_mul_f32 v28, s11, v24
    v_mul_f32 v29, s11, v25
    v_mul_f32 v30, s11, v26
    v_mul_f32 v31, s11, v27
    v_exp_f32 v28, v28
    v_exp_f32 v29, v29
    v_exp_f32 v30, v30
    v_exp_f32 v31, v31
    s_nop 0
    v_add_f32 v28, 1.0, v28
    v_add_f32 v29, 1.0, v29
    v_add_f32 v30, 1.0, v30
    v_add_f32 v31, 1.0, v31
    v_rcp_f32 v28, v28
    v_rcp_f32 v29, v29
    v_rcp_f32 v30, v30
    v_rcp_f32 v31, v31
    s_nop 0
    v_mul_f32 v24, v24, v28
    v_mul_f32 v25, v25, v29
    v_mul_f32 v26, v26, v30
    v_mul_f32 v27, v27, v31
    v_cvt_pk_bf16_f32 v24, v24, v25
    v_cvt_pk_bf16_f32 v25, v26, v27
    ds_write_b64 v20, v[24:25] offset:18784
    v_accvgpr_read_b32 v24, a56
    v_accvgpr_read_b32 v25, a57
    v_accvgpr_read_b32 v26, a58
    v_accvgpr_read_b32 v27, a59
    v_cvt_pk_bf16_f32 v24, v24, v25
    v_cvt_pk_bf16_f32 v26, v26, v27
    v_and_b32 v25, 0xffff0000, v24
    v_lshlrev_b32 v24, 16, v24
    v_and_b32 v27, 0xffff0000, v26
    v_lshlrev_b32 v26, 16, v26
    v_mul_f32 v28, s11, v24
    v_mul_f32 v29, s11, v25
    v_mul_f32 v30, s11, v26
    v_mul_f32 v31, s11, v27
    v_exp_f32 v28, v28
    v_exp_f32 v29, v29
    v_exp_f32 v30, v30
    v_exp_f32 v31, v31
    s_nop 0
    v_add_f32 v28, 1.0, v28
    v_add_f32 v29, 1.0, v29
    v_add_f32 v30, 1.0, v30
    v_add_f32 v31, 1.0, v31
    v_rcp_f32 v28, v28
    v_rcp_f32 v29, v29
    v_rcp_f32 v30, v30
    v_rcp_f32 v31, v31
    s_nop 0
    v_mul_f32 v24, v24, v28
    v_mul_f32 v25, v25, v29
    v_mul_f32 v26, v26, v30
    v_mul_f32 v27, v27, v31
    v_cvt_pk_bf16_f32 v24, v24, v25
    v_cvt_pk_bf16_f32 v25, v26, v27
    ds_write_b64 v20, v[24:25] offset:37472
    v_accvgpr_read_b32 v24, a60
    v_accvgpr_read_b32 v25, a61
    v_accvgpr_read_b32 v26, a62
    v_accvgpr_read_b32 v27, a63
    v_cvt_pk_bf16_f32 v24, v24, v25
    v_cvt_pk_bf16_f32 v26, v26, v27
    v_and_b32 v25, 0xffff0000, v24
    v_lshlrev_b32 v24, 16, v24
    v_and_b32 v27, 0xffff0000, v26
    v_lshlrev_b32 v26, 16, v26
    v_mul_f32 v28, s11, v24
    v_mul_f32 v29, s11, v25
    v_mul_f32 v30, s11, v26
    v_mul_f32 v31, s11, v27
    v_exp_f32 v28, v28
    v_exp_f32 v29, v29
    v_exp_f32 v30, v30
    v_exp_f32 v31, v31
    s_nop 0
    v_add_f32 v28, 1.0, v28
    v_add_f32 v29, 1.0, v29
    v_add_f32 v30, 1.0, v30
    v_add_f32 v31, 1.0, v31
    v_rcp_f32 v28, v28
    v_rcp_f32 v29, v29
    v_rcp_f32 v30, v30
    v_rcp_f32 v31, v31
    s_nop 0
    v_mul_f32 v24, v24, v28
    v_mul_f32 v25, v25, v29
    v_mul_f32 v26, v26, v30
    v_mul_f32 v27, v27, v31
    v_cvt_pk_bf16_f32 v24, v24, v25
    v_cvt_pk_bf16_f32 v25, v26, v27
    ds_write_b64 v20, v[24:25] offset:56160
    v_accvgpr_read_b32 v24, a64
    v_accvgpr_read_b32 v25, a65
    v_accvgpr_read_b32 v26, a66
    v_accvgpr_read_b32 v27, a67
    v_cvt_pk_bf16_f32 v24, v24, v25
    v_cvt_pk_bf16_f32 v26, v26, v27
    v_and_b32 v25, 0xffff0000, v24
    v_lshlrev_b32 v24, 16, v24
    v_and_b32 v27, 0xffff0000, v26
    v_lshlrev_b32 v26, 16, v26
    v_mul_f32 v28, s11, v24
    v_mul_f32 v29, s11, v25
    v_mul_f32 v30, s11, v26
    v_mul_f32 v31, s11, v27
    v_exp_f32 v28, v28
    v_exp_f32 v29, v29
    v_exp_f32 v30, v30
    v_exp_f32 v31, v31
    s_nop 0
    v_add_f32 v28, 1.0, v28
    v_add_f32 v29, 1.0, v29
    v_add_f32 v30, 1.0, v30
    v_add_f32 v31, 1.0, v31
    v_rcp_f32 v28, v28
    v_rcp_f32 v29, v29
    v_rcp_f32 v30, v30
    v_rcp_f32 v31, v31
    s_nop 0
    v_mul_f32 v24, v24, v28
    v_mul_f32 v25, v25, v29
    v_mul_f32 v26, v26, v30
    v_mul_f32 v27, v27, v31
    v_cvt_pk_bf16_f32 v24, v24, v25
    v_cvt_pk_bf16_f32 v25, v26, v27
    ds_write_b64 v20, v[24:25] offset:128
    v_accvgpr_read_b32 v24, a68
    v_accvgpr_read_b32 v25, a69
    v_accvgpr_read_b32 v26, a70
    v_accvgpr_read_b32 v27, a71
    v_cvt_pk_bf16_f32 v24, v24, v25
    v_cvt_pk_bf16_f32 v26, v26, v27
    v_and_b32 v25, 0xffff0000, v24
    v_lshlrev_b32 v24, 16, v24
    v_and_b32 v27, 0xffff0000, v26
    v_lshlrev_b32 v26, 16, v26
    v_mul_f32 v28, s11, v24
    v_mul_f32 v29, s11, v25
    v_mul_f32 v30, s11, v26
    v_mul_f32 v31, s11, v27
    v_exp_f32 v28, v28
    v_exp_f32 v29, v29
    v_exp_f32 v30, v30
    v_exp_f32 v31, v31
    s_nop 0
    v_add_f32 v28, 1.0, v28
    v_add_f32 v29, 1.0, v29
    v_add_f32 v30, 1.0, v30
    v_add_f32 v31, 1.0, v31
    v_rcp_f32 v28, v28
    v_rcp_f32 v29, v29
    v_rcp_f32 v30, v30
    v_rcp_f32 v31, v31
    s_nop 0
    v_mul_f32 v24, v24, v28
    v_mul_f32 v25, v25, v29
    v_mul_f32 v26, v26, v30
    v_mul_f32 v27, v27, v31
    v_cvt_pk_bf16_f32 v24, v24, v25
    v_cvt_pk_bf16_f32 v25, v26, v27
    ds_write_b64 v20, v[24:25] offset:18816
    v_accvgpr_read_b32 v24, a72
    v_accvgpr_read_b32 v25, a73
    v_accvgpr_read_b32 v26, a74
    v_accvgpr_read_b32 v27, a75
    v_cvt_pk_bf16_f32 v24, v24, v25
    v_cvt_pk_bf16_f32 v26, v26, v27
    v_and_b32 v25, 0xffff0000, v24
    v_lshlrev_b32 v24, 16, v24
    v_and_b32 v27, 0xffff0000, v26
    v_lshlrev_b32 v26, 16, v26
    v_mul_f32 v28, s11, v24
    v_mul_f32 v29, s11, v25
    v_mul_f32 v30, s11, v26
    v_mul_f32 v31, s11, v27
    v_exp_f32 v28, v28
    v_exp_f32 v29, v29
    v_exp_f32 v30, v30
    v_exp_f32 v31, v31
    s_nop 0
    v_add_f32 v28, 1.0, v28
    v_add_f32 v29, 1.0, v29
    v_add_f32 v30, 1.0, v30
    v_add_f32 v31, 1.0, v31
    v_rcp_f32 v28, v28
    v_rcp_f32 v29, v29
    v_rcp_f32 v30, v30
    v_rcp_f32 v31, v31
    s_nop 0
    v_mul_f32 v24, v24, v28
    v_mul_f32 v25, v25, v29
    v_mul_f32 v26, v26, v30
    v_mul_f32 v27, v27, v31
    v_cvt_pk_bf16_f32 v24, v24, v25
    v_cvt_pk_bf16_f32 v25, v26, v27
    ds_write_b64 v20, v[24:25] offset:37504
    v_accvgpr_read_b32 v24, a76
    v_accvgpr_read_b32 v25, a77
    v_accvgpr_read_b32 v26, a78
    v_accvgpr_read_b32 v27, a79
    v_cvt_pk_bf16_f32 v24, v24, v25
    v_cvt_pk_bf16_f32 v26, v26, v27
    v_and_b32 v25, 0xffff0000, v24
    v_lshlrev_b32 v24, 16, v24
    v_and_b32 v27, 0xffff0000, v26
    v_lshlrev_b32 v26, 16, v26
    v_mul_f32 v28, s11, v24
    v_mul_f32 v29, s11, v25
    v_mul_f32 v30, s11, v26
    v_mul_f32 v31, s11, v27
    v_exp_f32 v28, v28
    v_exp_f32 v29, v29
    v_exp_f32 v30, v30
    v_exp_f32 v31, v31
    s_nop 0
    v_add_f32 v28, 1.0, v28
    v_add_f32 v29, 1.0, v29
    v_add_f32 v30, 1.0, v30
    v_add_f32 v31, 1.0, v31
    v_rcp_f32 v28, v28
    v_rcp_f32 v29, v29
    v_rcp_f32 v30, v30
    v_rcp_f32 v31, v31
    s_nop 0
    v_mul_f32 v24, v24, v28
    v_mul_f32 v25, v25, v29
    v_mul_f32 v26, v26, v30
    v_mul_f32 v27, v27, v31
    v_cvt_pk_bf16_f32 v24, v24, v25
    v_cvt_pk_bf16_f32 v25, v26, v27
    ds_write_b64 v20, v[24:25] offset:56192
    v_accvgpr_read_b32 v24, a80
    v_accvgpr_read_b32 v25, a81
    v_accvgpr_read_b32 v26, a82
    v_accvgpr_read_b32 v27, a83
    v_cvt_pk_bf16_f32 v24, v24, v25
    v_cvt_pk_bf16_f32 v26, v26, v27
    v_and_b32 v25, 0xffff0000, v24
    v_lshlrev_b32 v24, 16, v24
    v_and_b32 v27, 0xffff0000, v26
    v_lshlrev_b32 v26, 16, v26
    v_mul_f32 v28, s11, v24
    v_mul_f32 v29, s11, v25
    v_mul_f32 v30, s11, v26
    v_mul_f32 v31, s11, v27
    v_exp_f32 v28, v28
    v_exp_f32 v29, v29
    v_exp_f32 v30, v30
    v_exp_f32 v31, v31
    s_nop 0
    v_add_f32 v28, 1.0, v28
    v_add_f32 v29, 1.0, v29
    v_add_f32 v30, 1.0, v30
    v_add_f32 v31, 1.0, v31
    v_rcp_f32 v28, v28
    v_rcp_f32 v29, v29
    v_rcp_f32 v30, v30
    v_rcp_f32 v31, v31
    s_nop 0
    v_mul_f32 v24, v24, v28
    v_mul_f32 v25, v25, v29
    v_mul_f32 v26, v26, v30
    v_mul_f32 v27, v27, v31
    v_cvt_pk_bf16_f32 v24, v24, v25
    v_cvt_pk_bf16_f32 v25, v26, v27
    ds_write_b64 v20, v[24:25] offset:160
    v_accvgpr_read_b32 v24, a84
    v_accvgpr_read_b32 v25, a85
    v_accvgpr_read_b32 v26, a86
    v_accvgpr_read_b32 v27, a87
    v_cvt_pk_bf16_f32 v24, v24, v25
    v_cvt_pk_bf16_f32 v26, v26, v27
    v_and_b32 v25, 0xffff0000, v24
    v_lshlrev_b32 v24, 16, v24
    v_and_b32 v27, 0xffff0000, v26
    v_lshlrev_b32 v26, 16, v26
    v_mul_f32 v28, s11, v24
    v_mul_f32 v29, s11, v25
    v_mul_f32 v30, s11, v26
    v_mul_f32 v31, s11, v27
    v_exp_f32 v28, v28
    v_exp_f32 v29, v29
    v_exp_f32 v30, v30
    v_exp_f32 v31, v31
    s_nop 0
    v_add_f32 v28, 1.0, v28
    v_add_f32 v29, 1.0, v29
    v_add_f32 v30, 1.0, v30
    v_add_f32 v31, 1.0, v31
    v_rcp_f32 v28, v28
    v_rcp_f32 v29, v29
    v_rcp_f32 v30, v30
    v_rcp_f32 v31, v31
    s_nop 0
    v_mul_f32 v24, v24, v28
    v_mul_f32 v25, v25, v29
    v_mul_f32 v26, v26, v30
    v_mul_f32 v27, v27, v31
    v_cvt_pk_bf16_f32 v24, v24, v25
    v_cvt_pk_bf16_f32 v25, v26, v27
    ds_write_b64 v20, v[24:25] offset:18848
    v_accvgpr_read_b32 v24, a88
    v_accvgpr_read_b32 v25, a89
    v_accvgpr_read_b32 v26, a90
    v_accvgpr_read_b32 v27, a91
    v_cvt_pk_bf16_f32 v24, v24, v25
    v_cvt_pk_bf16_f32 v26, v26, v27
    v_and_b32 v25, 0xffff0000, v24
    v_lshlrev_b32 v24, 16, v24
    v_and_b32 v27, 0xffff0000, v26
    v_lshlrev_b32 v26, 16, v26
    v_mul_f32 v28, s11, v24
    v_mul_f32 v29, s11, v25
    v_mul_f32 v30, s11, v26
    v_mul_f32 v31, s11, v27
    v_exp_f32 v28, v28
    v_exp_f32 v29, v29
    v_exp_f32 v30, v30
    v_exp_f32 v31, v31
    s_nop 0
    v_add_f32 v28, 1.0, v28
    v_add_f32 v29, 1.0, v29
    v_add_f32 v30, 1.0, v30
    v_add_f32 v31, 1.0, v31
    v_rcp_f32 v28, v28
    v_rcp_f32 v29, v29
    v_rcp_f32 v30, v30
    v_rcp_f32 v31, v31
    s_nop 0
    v_mul_f32 v24, v24, v28
    v_mul_f32 v25, v25, v29
    v_mul_f32 v26, v26, v30
    v_mul_f32 v27, v27, v31
    v_cvt_pk_bf16_f32 v24, v24, v25
    v_cvt_pk_bf16_f32 v25, v26, v27
    ds_write_b64 v20, v[24:25] offset:37536
    v_accvgpr_read_b32 v24, a92
    v_accvgpr_read_b32 v25, a93
    v_accvgpr_read_b32 v26, a94
    v_accvgpr_read_b32 v27, a95
    v_cvt_pk_bf16_f32 v24, v24, v25
    v_cvt_pk_bf16_f32 v26, v26, v27
    v_and_b32 v25, 0xffff0000, v24
    v_lshlrev_b32 v24, 16, v24
    v_and_b32 v27, 0xffff0000, v26
    v_lshlrev_b32 v26, 16, v26
    v_mul_f32 v28, s11, v24
    v_mul_f32 v29, s11, v25
    v_mul_f32 v30, s11, v26
    v_mul_f32 v31, s11, v27
    v_exp_f32 v28, v28
    v_exp_f32 v29, v29
    v_exp_f32 v30, v30
    v_exp_f32 v31, v31
    s_nop 0
    v_add_f32 v28, 1.0, v28
    v_add_f32 v29, 1.0, v29
    v_add_f32 v30, 1.0, v30
    v_add_f32 v31, 1.0, v31
    v_rcp_f32 v28, v28
    v_rcp_f32 v29, v29
    v_rcp_f32 v30, v30
    v_rcp_f32 v31, v31
    s_nop 0
    v_mul_f32 v24, v24, v28
    v_mul_f32 v25, v25, v29
    v_mul_f32 v26, v26, v30
    v_mul_f32 v27, v27, v31
    v_cvt_pk_bf16_f32 v24, v24, v25
    v_cvt_pk_bf16_f32 v25, v26, v27
    ds_write_b64 v20, v[24:25] offset:56224
    v_accvgpr_read_b32 v24, a96
    v_accvgpr_read_b32 v25, a97
    v_accvgpr_read_b32 v26, a98
    v_accvgpr_read_b32 v27, a99
    v_cvt_pk_bf16_f32 v24, v24, v25
    v_cvt_pk_bf16_f32 v26, v26, v27
    v_and_b32 v25, 0xffff0000, v24
    v_lshlrev_b32 v24, 16, v24
    v_and_b32 v27, 0xffff0000, v26
    v_lshlrev_b32 v26, 16, v26
    v_mul_f32 v28, s11, v24
    v_mul_f32 v29, s11, v25
    v_mul_f32 v30, s11, v26
    v_mul_f32 v31, s11, v27
    v_exp_f32 v28, v28
    v_exp_f32 v29, v29
    v_exp_f32 v30, v30
    v_exp_f32 v31, v31
    s_nop 0
    v_add_f32 v28, 1.0, v28
    v_add_f32 v29, 1.0, v29
    v_add_f32 v30, 1.0, v30
    v_add_f32 v31, 1.0, v31
    v_rcp_f32 v28, v28
    v_rcp_f32 v29, v29
    v_rcp_f32 v30, v30
    v_rcp_f32 v31, v31
    s_nop 0
    v_mul_f32 v24, v24, v28
    v_mul_f32 v25, v25, v29
    v_mul_f32 v26, v26, v30
    v_mul_f32 v27, v27, v31
    v_cvt_pk_bf16_f32 v24, v24, v25
    v_cvt_pk_bf16_f32 v25, v26, v27
    ds_write_b64 v20, v[24:25] offset:192
    v_accvgpr_read_b32 v24, a100
    v_accvgpr_read_b32 v25, a101
    v_accvgpr_read_b32 v26, a102
    v_accvgpr_read_b32 v27, a103
    v_cvt_pk_bf16_f32 v24, v24, v25
    v_cvt_pk_bf16_f32 v26, v26, v27
    v_and_b32 v25, 0xffff0000, v24
    v_lshlrev_b32 v24, 16, v24
    v_and_b32 v27, 0xffff0000, v26
    v_lshlrev_b32 v26, 16, v26
    v_mul_f32 v28, s11, v24
    v_mul_f32 v29, s11, v25
    v_mul_f32 v30, s11, v26
    v_mul_f32 v31, s11, v27
    v_exp_f32 v28, v28
    v_exp_f32 v29, v29
    v_exp_f32 v30, v30
    v_exp_f32 v31, v31
    s_nop 0
    v_add_f32 v28, 1.0, v28
    v_add_f32 v29, 1.0, v29
    v_add_f32 v30, 1.0, v30
    v_add_f32 v31, 1.0, v31
    v_rcp_f32 v28, v28
    v_rcp_f32 v29, v29
    v_rcp_f32 v30, v30
    v_rcp_f32 v31, v31
    s_nop 0
    v_mul_f32 v24, v24, v28
    v_mul_f32 v25, v25, v29
    v_mul_f32 v26, v26, v30
    v_mul_f32 v27, v27, v31
    v_cvt_pk_bf16_f32 v24, v24, v25
    v_cvt_pk_bf16_f32 v25, v26, v27
    ds_write_b64 v20, v[24:25] offset:18880
    v_accvgpr_read_b32 v24, a104
    v_accvgpr_read_b32 v25, a105
    v_accvgpr_read_b32 v26, a106
    v_accvgpr_read_b32 v27, a107
    v_cvt_pk_bf16_f32 v24, v24, v25
    v_cvt_pk_bf16_f32 v26, v26, v27
    v_and_b32 v25, 0xffff0000, v24
    v_lshlrev_b32 v24, 16, v24
    v_and_b32 v27, 0xffff0000, v26
    v_lshlrev_b32 v26, 16, v26
    v_mul_f32 v28, s11, v24
    v_mul_f32 v29, s11, v25
    v_mul_f32 v30, s11, v26
    v_mul_f32 v31, s11, v27
    v_exp_f32 v28, v28
    v_exp_f32 v29, v29
    v_exp_f32 v30, v30
    v_exp_f32 v31, v31
    s_nop 0
    v_add_f32 v28, 1.0, v28
    v_add_f32 v29, 1.0, v29
    v_add_f32 v30, 1.0, v30
    v_add_f32 v31, 1.0, v31
    v_rcp_f32 v28, v28
    v_rcp_f32 v29, v29
    v_rcp_f32 v30, v30
    v_rcp_f32 v31, v31
    s_nop 0
    v_mul_f32 v24, v24, v28
    v_mul_f32 v25, v25, v29
    v_mul_f32 v26, v26, v30
    v_mul_f32 v27, v27, v31
    v_cvt_pk_bf16_f32 v24, v24, v25
    v_cvt_pk_bf16_f32 v25, v26, v27
    ds_write_b64 v20, v[24:25] offset:37568
    v_accvgpr_read_b32 v24, a108
    v_accvgpr_read_b32 v25, a109
    v_accvgpr_read_b32 v26, a110
    v_accvgpr_read_b32 v27, a111
    v_cvt_pk_bf16_f32 v24, v24, v25
    v_cvt_pk_bf16_f32 v26, v26, v27
    v_and_b32 v25, 0xffff0000, v24
    v_lshlrev_b32 v24, 16, v24
    v_and_b32 v27, 0xffff0000, v26
    v_lshlrev_b32 v26, 16, v26
    v_mul_f32 v28, s11, v24
    v_mul_f32 v29, s11, v25
    v_mul_f32 v30, s11, v26
    v_mul_f32 v31, s11, v27
    v_exp_f32 v28, v28
    v_exp_f32 v29, v29
    v_exp_f32 v30, v30
    v_exp_f32 v31, v31
    s_nop 0
    v_add_f32 v28, 1.0, v28
    v_add_f32 v29, 1.0, v29
    v_add_f32 v30, 1.0, v30
    v_add_f32 v31, 1.0, v31
    v_rcp_f32 v28, v28
    v_rcp_f32 v29, v29
    v_rcp_f32 v30, v30
    v_rcp_f32 v31, v31
    s_nop 0
    v_mul_f32 v24, v24, v28
    v_mul_f32 v25, v25, v29
    v_mul_f32 v26, v26, v30
    v_mul_f32 v27, v27, v31
    v_cvt_pk_bf16_f32 v24, v24, v25
    v_cvt_pk_bf16_f32 v25, v26, v27
    ds_write_b64 v20, v[24:25] offset:56256
    v_accvgpr_read_b32 v24, a112
    v_accvgpr_read_b32 v25, a113
    v_accvgpr_read_b32 v26, a114
    v_accvgpr_read_b32 v27, a115
    v_cvt_pk_bf16_f32 v24, v24, v25
    v_cvt_pk_bf16_f32 v26, v26, v27
    v_and_b32 v25, 0xffff0000, v24
    v_lshlrev_b32 v24, 16, v24
    v_and_b32 v27, 0xffff0000, v26
    v_lshlrev_b32 v26, 16, v26
    v_mul_f32 v28, s11, v24
    v_mul_f32 v29, s11, v25
    v_mul_f32 v30, s11, v26
    v_mul_f32 v31, s11, v27
    v_exp_f32 v28, v28
    v_exp_f32 v29, v29
    v_exp_f32 v30, v30
    v_exp_f32 v31, v31
    s_nop 0
    v_add_f32 v28, 1.0, v28
    v_add_f32 v29, 1.0, v29
    v_add_f32 v30, 1.0, v30
    v_add_f32 v31, 1.0, v31
    v_rcp_f32 v28, v28
    v_rcp_f32 v29, v29
    v_rcp_f32 v30, v30
    v_rcp_f32 v31, v31
    s_nop 0
    v_mul_f32 v24, v24, v28
    v_mul_f32 v25, v25, v29
    v_mul_f32 v26, v26, v30
    v_mul_f32 v27, v27, v31
    v_cvt_pk_bf16_f32 v24, v24, v25
    v_cvt_pk_bf16_f32 v25, v26, v27
    ds_write_b64 v20, v[24:25] offset:224
    v_accvgpr_read_b32 v24, a116
    v_accvgpr_read_b32 v25, a117
    v_accvgpr_read_b32 v26, a118
    v_accvgpr_read_b32 v27, a119
    v_cvt_pk_bf16_f32 v24, v24, v25
    v_cvt_pk_bf16_f32 v26, v26, v27
    v_and_b32 v25, 0xffff0000, v24
    v_lshlrev_b32 v24, 16, v24
    v_and_b32 v27, 0xffff0000, v26
    v_lshlrev_b32 v26, 16, v26
    v_mul_f32 v28, s11, v24
    v_mul_f32 v29, s11, v25
    v_mul_f32 v30, s11, v26
    v_mul_f32 v31, s11, v27
    v_exp_f32 v28, v28
    v_exp_f32 v29, v29
    v_exp_f32 v30, v30
    v_exp_f32 v31, v31
    s_nop 0
    v_add_f32 v28, 1.0, v28
    v_add_f32 v29, 1.0, v29
    v_add_f32 v30, 1.0, v30
    v_add_f32 v31, 1.0, v31
    v_rcp_f32 v28, v28
    v_rcp_f32 v29, v29
    v_rcp_f32 v30, v30
    v_rcp_f32 v31, v31
    s_nop 0
    v_mul_f32 v24, v24, v28
    v_mul_f32 v25, v25, v29
    v_mul_f32 v26, v26, v30
    v_mul_f32 v27, v27, v31
    v_cvt_pk_bf16_f32 v24, v24, v25
    v_cvt_pk_bf16_f32 v25, v26, v27
    ds_write_b64 v20, v[24:25] offset:18912
    v_accvgpr_read_b32 v24, a120
    v_accvgpr_read_b32 v25, a121
    v_accvgpr_read_b32 v26, a122
    v_accvgpr_read_b32 v27, a123
    v_cvt_pk_bf16_f32 v24, v24, v25
    v_cvt_pk_bf16_f32 v26, v26, v27
    v_and_b32 v25, 0xffff0000, v24
    v_lshlrev_b32 v24, 16, v24
    v_and_b32 v27, 0xffff0000, v26
    v_lshlrev_b32 v26, 16, v26
    v_mul_f32 v28, s11, v24
    v_mul_f32 v29, s11, v25
    v_mul_f32 v30, s11, v26
    v_mul_f32 v31, s11, v27
    v_exp_f32 v28, v28
    v_exp_f32 v29, v29
    v_exp_f32 v30, v30
    v_exp_f32 v31, v31
    s_nop 0
    v_add_f32 v28, 1.0, v28
    v_add_f32 v29, 1.0, v29
    v_add_f32 v30, 1.0, v30
    v_add_f32 v31, 1.0, v31
    v_rcp_f32 v28, v28
    v_rcp_f32 v29, v29
    v_rcp_f32 v30, v30
    v_rcp_f32 v31, v31
    s_nop 0
    v_mul_f32 v24, v24, v28
    v_mul_f32 v25, v25, v29
    v_mul_f32 v26, v26, v30
    v_mul_f32 v27, v27, v31
    v_cvt_pk_bf16_f32 v24, v24, v25
    v_cvt_pk_bf16_f32 v25, v26, v27
    ds_write_b64 v20, v[24:25] offset:37600
    v_accvgpr_read_b32 v24, a124
    v_accvgpr_read_b32 v25, a125
    v_accvgpr_read_b32 v26, a126
    v_accvgpr_read_b32 v27, a127
    v_cvt_pk_bf16_f32 v24, v24, v25
    v_cvt_pk_bf16_f32 v26, v26, v27
    v_and_b32 v25, 0xffff0000, v24
    v_lshlrev_b32 v24, 16, v24
    v_and_b32 v27, 0xffff0000, v26
    v_lshlrev_b32 v26, 16, v26
    v_mul_f32 v28, s11, v24
    v_mul_f32 v29, s11, v25
    v_mul_f32 v30, s11, v26
    v_mul_f32 v31, s11, v27
    v_exp_f32 v28, v28
    v_exp_f32 v29, v29
    v_exp_f32 v30, v30
    v_exp_f32 v31, v31
    s_nop 0
    v_add_f32 v28, 1.0, v28
    v_add_f32 v29, 1.0, v29
    v_add_f32 v30, 1.0, v30
    v_add_f32 v31, 1.0, v31
    v_rcp_f32 v28, v28
    v_rcp_f32 v29, v29
    v_rcp_f32 v30, v30
    v_rcp_f32 v31, v31
    s_nop 0
    v_mul_f32 v24, v24, v28
    v_mul_f32 v25, v25, v29
    v_mul_f32 v26, v26, v30
    v_mul_f32 v27, v27, v31
    v_cvt_pk_bf16_f32 v24, v24, v25
    v_cvt_pk_bf16_f32 v25, v26, v27
    ds_write_b64 v20, v[24:25] offset:56288
    v_accvgpr_read_b32 v24, a128
    v_accvgpr_read_b32 v25, a129
    v_accvgpr_read_b32 v26, a130
    v_accvgpr_read_b32 v27, a131
    v_cvt_pk_bf16_f32 v24, v24, v25
    v_cvt_pk_bf16_f32 v26, v26, v27
    v_and_b32 v25, 0xffff0000, v24
    v_lshlrev_b32 v24, 16, v24
    v_and_b32 v27, 0xffff0000, v26
    v_lshlrev_b32 v26, 16, v26
    v_mul_f32 v28, s11, v24
    v_mul_f32 v29, s11, v25
    v_mul_f32 v30, s11, v26
    v_mul_f32 v31, s11, v27
    v_exp_f32 v28, v28
    v_exp_f32 v29, v29
    v_exp_f32 v30, v30
    v_exp_f32 v31, v31
    s_nop 0
    v_add_f32 v28, 1.0, v28
    v_add_f32 v29, 1.0, v29
    v_add_f32 v30, 1.0, v30
    v_add_f32 v31, 1.0, v31
    v_rcp_f32 v28, v28
    v_rcp_f32 v29, v29
    v_rcp_f32 v30, v30
    v_rcp_f32 v31, v31
    s_nop 0
    v_mul_f32 v24, v24, v28
    v_mul_f32 v25, v25, v29
    v_mul_f32 v26, v26, v30
    v_mul_f32 v27, v27, v31
    v_cvt_pk_bf16_f32 v24, v24, v25
    v_cvt_pk_bf16_f32 v25, v26, v27
    ds_write_b64 v20, v[24:25] offset:256
    v_accvgpr_read_b32 v24, a132
    v_accvgpr_read_b32 v25, a133
    v_accvgpr_read_b32 v26, a134
    v_accvgpr_read_b32 v27, a135
    v_cvt_pk_bf16_f32 v24, v24, v25
    v_cvt_pk_bf16_f32 v26, v26, v27
    v_and_b32 v25, 0xffff0000, v24
    v_lshlrev_b32 v24, 16, v24
    v_and_b32 v27, 0xffff0000, v26
    v_lshlrev_b32 v26, 16, v26
    v_mul_f32 v28, s11, v24
    v_mul_f32 v29, s11, v25
    v_mul_f32 v30, s11, v26
    v_mul_f32 v31, s11, v27
    v_exp_f32 v28, v28
    v_exp_f32 v29, v29
    v_exp_f32 v30, v30
    v_exp_f32 v31, v31
    s_nop 0
    v_add_f32 v28, 1.0, v28
    v_add_f32 v29, 1.0, v29
    v_add_f32 v30, 1.0, v30
    v_add_f32 v31, 1.0, v31
    v_rcp_f32 v28, v28
    v_rcp_f32 v29, v29
    v_rcp_f32 v30, v30
    v_rcp_f32 v31, v31
    s_nop 0
    v_mul_f32 v24, v24, v28
    v_mul_f32 v25, v25, v29
    v_mul_f32 v26, v26, v30
    v_mul_f32 v27, v27, v31
    v_cvt_pk_bf16_f32 v24, v24, v25
    v_cvt_pk_bf16_f32 v25, v26, v27
    ds_write_b64 v20, v[24:25] offset:18944
    v_accvgpr_read_b32 v24, a136
    v_accvgpr_read_b32 v25, a137
    v_accvgpr_read_b32 v26, a138
    v_accvgpr_read_b32 v27, a139
    v_cvt_pk_bf16_f32 v24, v24, v25
    v_cvt_pk_bf16_f32 v26, v26, v27
    v_and_b32 v25, 0xffff0000, v24
    v_lshlrev_b32 v24, 16, v24
    v_and_b32 v27, 0xffff0000, v26
    v_lshlrev_b32 v26, 16, v26
    v_mul_f32 v28, s11, v24
    v_mul_f32 v29, s11, v25
    v_mul_f32 v30, s11, v26
    v_mul_f32 v31, s11, v27
    v_exp_f32 v28, v28
    v_exp_f32 v29, v29
    v_exp_f32 v30, v30
    v_exp_f32 v31, v31
    s_nop 0
    v_add_f32 v28, 1.0, v28
    v_add_f32 v29, 1.0, v29
    v_add_f32 v30, 1.0, v30
    v_add_f32 v31, 1.0, v31
    v_rcp_f32 v28, v28
    v_rcp_f32 v29, v29
    v_rcp_f32 v30, v30
    v_rcp_f32 v31, v31
    s_nop 0
    v_mul_f32 v24, v24, v28
    v_mul_f32 v25, v25, v29
    v_mul_f32 v26, v26, v30
    v_mul_f32 v27, v27, v31
    v_cvt_pk_bf16_f32 v24, v24, v25
    v_cvt_pk_bf16_f32 v25, v26, v27
    ds_write_b64 v20, v[24:25] offset:37632
    v_accvgpr_read_b32 v24, a140
    v_accvgpr_read_b32 v25, a141
    v_accvgpr_read_b32 v26, a142
    v_accvgpr_read_b32 v27, a143
    v_cvt_pk_bf16_f32 v24, v24, v25
    v_cvt_pk_bf16_f32 v26, v26, v27
    v_and_b32 v25, 0xffff0000, v24
    v_lshlrev_b32 v24, 16, v24
    v_and_b32 v27, 0xffff0000, v26
    v_lshlrev_b32 v26, 16, v26
    v_mul_f32 v28, s11, v24
    v_mul_f32 v29, s11, v25
    v_mul_f32 v30, s11, v26
    v_mul_f32 v31, s11, v27
    v_exp_f32 v28, v28
    v_exp_f32 v29, v29
    v_exp_f32 v30, v30
    v_exp_f32 v31, v31
    s_nop 0
    v_add_f32 v28, 1.0, v28
    v_add_f32 v29, 1.0, v29
    v_add_f32 v30, 1.0, v30
    v_add_f32 v31, 1.0, v31
    v_rcp_f32 v28, v28
    v_rcp_f32 v29, v29
    v_rcp_f32 v30, v30
    v_rcp_f32 v31, v31
    s_nop 0
    v_mul_f32 v24, v24, v28
    v_mul_f32 v25, v25, v29
    v_mul_f32 v26, v26, v30
    v_mul_f32 v27, v27, v31
    v_cvt_pk_bf16_f32 v24, v24, v25
    v_cvt_pk_bf16_f32 v25, v26, v27
    ds_write_b64 v20, v[24:25] offset:56320
    s_waitcnt lgkmcnt(0)
    s_barrier
    s_mul_i32 s24, s23, 1296
    s_mul_i32 s25, s21, 18
    s_add_u32 s24, s24, s25
    s_lshl_b32 s24, s24, 10
    s_add_u32 s24, s24, 21839872
    v_accvgpr_write_b32 a0, 0
    v_accvgpr_write_b32 a1, 0
    v_accvgpr_write_b32 a2, 0
    v_accvgpr_write_b32 a3, 0
    v_accvgpr_write_b32 a4, 0
    v_accvgpr_write_b32 a5, 0
    v_accvgpr_write_b32 a6, 0
    v_accvgpr_write_b32 a7, 0
    v_accvgpr_write_b32 a8, 0
    v_accvgpr_write_b32 a9, 0
    v_accvgpr_write_b32 a10, 0
    v_accvgpr_write_b32 a11, 0
    v_accvgpr_write_b32 a12, 0
    v_accvgpr_write_b32 a13, 0
    v_accvgpr_write_b32 a14, 0
    v_accvgpr_write_b32 a15, 0
    v_accvgpr_write_b32 a16, 0
    v_accvgpr_write_b32 a17, 0
    v_accvgpr_write_b32 a18, 0
    v_accvgpr_write_b32 a19, 0
    v_accvgpr_write_b32 a20, 0
    v_accvgpr_write_b32 a21, 0
    v_accvgpr_write_b32 a22, 0
    v_accvgpr_write_b32 a23, 0
    v_accvgpr_write_b32 a24, 0
    v_accvgpr_write_b32 a25, 0
    v_accvgpr_write_b32 a26, 0
    v_accvgpr_write_b32 a27, 0
    v_accvgpr_write_b32 a28, 0
    v_accvgpr_write_b32 a29, 0
    v_accvgpr_write_b32 a30, 0
    v_accvgpr_write_b32 a31, 0
    v_accvgpr_write_b32 a32, 0
    v_accvgpr_write_b32 a33, 0
    v_accvgpr_write_b32 a34, 0
    v_accvgpr_write_b32 a35, 0
    v_accvgpr_write_b32 a36, 0
    v_accvgpr_write_b32 a37, 0
    v_accvgpr_write_b32 a38, 0
    v_accvgpr_write_b32 a39, 0
    v_accvgpr_write_b32 a40, 0
    v_accvgpr_write_b32 a41, 0
    v_accvgpr_write_b32 a42, 0
    v_accvgpr_write_b32 a43, 0
    v_accvgpr_write_b32 a44, 0
    v_accvgpr_write_b32 a45, 0
    v_accvgpr_write_b32 a46, 0
    v_accvgpr_write_b32 a47, 0
    v_accvgpr_write_b32 a48, 0
    v_accvgpr_write_b32 a49, 0
    v_accvgpr_write_b32 a50, 0
    v_accvgpr_write_b32 a51, 0
    v_accvgpr_write_b32 a52, 0
    v_accvgpr_write_b32 a53, 0
    v_accvgpr_write_b32 a54, 0
    v_accvgpr_write_b32 a55, 0
    v_accvgpr_write_b32 a56, 0
    v_accvgpr_write_b32 a57, 0
    v_accvgpr_write_b32 a58, 0
    v_accvgpr_write_b32 a59, 0
    v_accvgpr_write_b32 a60, 0
    v_accvgpr_write_b32 a61, 0
    v_accvgpr_write_b32 a62, 0
    v_accvgpr_write_b32 a63, 0
    v_accvgpr_write_b32 a64, 0
    v_accvgpr_write_b32 a65, 0
    v_accvgpr_write_b32 a66, 0
    v_accvgpr_write_b32 a67, 0
    v_accvgpr_write_b32 a68, 0
    v_accvgpr_write_b32 a69, 0
    v_accvgpr_write_b32 a70, 0
    v_accvgpr_write_b32 a71, 0
    v_accvgpr_write_b32 a72, 0
    v_accvgpr_write_b32 a73, 0
    v_accvgpr_write_b32 a74, 0
    v_accvgpr_write_b32 a75, 0
    v_accvgpr_write_b32 a76, 0
    v_accvgpr_write_b32 a77, 0
    v_accvgpr_write_b32 a78, 0
    v_accvgpr_write_b32 a79, 0
    v_accvgpr_write_b32 a80, 0
    v_accvgpr_write_b32 a81, 0
    v_accvgpr_write_b32 a82, 0
    v_accvgpr_write_b32 a83, 0
    v_accvgpr_write_b32 a84, 0
    v_accvgpr_write_b32 a85, 0
    v_accvgpr_write_b32 a86, 0
    v_accvgpr_write_b32 a87, 0
    v_accvgpr_write_b32 a88, 0
    v_accvgpr_write_b32 a89, 0
    v_accvgpr_write_b32 a90, 0
    v_accvgpr_write_b32 a91, 0
    v_accvgpr_write_b32 a92, 0
    v_accvgpr_write_b32 a93, 0
    v_accvgpr_write_b32 a94, 0
    v_accvgpr_write_b32 a95, 0
    v_accvgpr_write_b32 a96, 0
    v_accvgpr_write_b32 a97, 0
    v_accvgpr_write_b32 a98, 0
    v_accvgpr_write_b32 a99, 0
    v_accvgpr_write_b32 a100, 0
    v_accvgpr_write_b32 a101, 0
    v_accvgpr_write_b32 a102, 0
    v_accvgpr_write_b32 a103, 0
    v_accvgpr_write_b32 a104, 0
    v_accvgpr_write_b32 a105, 0
    v_accvgpr_write_b32 a106, 0
    v_accvgpr_write_b32 a107, 0
    v_accvgpr_write_b32 a108, 0
    v_accvgpr_write_b32 a109, 0
    v_accvgpr_write_b32 a110, 0
    v_accvgpr_write_b32 a111, 0
    v_accvgpr_write_b32 a112, 0
    v_accvgpr_write_b32 a113, 0
    v_accvgpr_write_b32 a114, 0
    v_accvgpr_write_b32 a115, 0
    v_accvgpr_write_b32 a116, 0
    v_accvgpr_write_b32 a117, 0
    v_accvgpr_write_b32 a118, 0
    v_accvgpr_write_b32 a119, 0
    v_accvgpr_write_b32 a120, 0
    v_accvgpr_write_b32 a121, 0
    v_accvgpr_write_b32 a122, 0
    v_accvgpr_write_b32 a123, 0
    v_accvgpr_write_b32 a124, 0
    v_accvgpr_write_b32 a125, 0
    v_accvgpr_write_b32 a126, 0
    v_accvgpr_write_b32 a127, 0
    v_accvgpr_write_b32 a128, 0
    v_accvgpr_write_b32 a129, 0
    v_accvgpr_write_b32 a130, 0
    v_accvgpr_write_b32 a131, 0
    v_accvgpr_write_b32 a132, 0
    v_accvgpr_write_b32 a133, 0
    v_accvgpr_write_b32 a134, 0
    v_accvgpr_write_b32 a135, 0
    v_accvgpr_write_b32 a136, 0
    v_accvgpr_write_b32 a137, 0
    v_accvgpr_write_b32 a138, 0
    v_accvgpr_write_b32 a139, 0
    v_accvgpr_write_b32 a140, 0
    v_accvgpr_write_b32 a141, 0
    v_accvgpr_write_b32 a142, 0
    v_accvgpr_write_b32 a143, 0
    v_add_u32 v22, s24, v19
    v_add_u32 v23, 74752, v18
    v_add_u32 v164, 0, v22
    v_add_u32 v165, 147456, v22
    v_add_u32 v166, 294912, v22
    v_add_u32 v167, 442368, v22
    v_add_u32 v168, 589824, v22
    v_add_u32 v169, 737280, v22
    v_add_u32 v170, 884736, v22
    v_add_u32 v171, 1032192, v22
    v_add_u32 v172, 1179648, v22
    global_load_dwordx4 v[24:27], v164, s[18:19] offset:0
    global_load_dwordx4 v[28:31], v165, s[18:19] offset:0
    global_load_dwordx4 v[32:35], v166, s[18:19] offset:0
    global_load_dwordx4 v[36:39], v167, s[18:19] offset:0
    global_load_dwordx4 v[40:43], v168, s[18:19] offset:0
    global_load_dwordx4 v[44:47], v169, s[18:19] offset:0
    global_load_dwordx4 v[48:51], v170, s[18:19] offset:0
    global_load_dwordx4 v[52:55], v171, s[18:19] offset:0
    global_load_dwordx4 v[56:59], v172, s[18:19] offset:0
    global_load_dwordx4 v[60:63], v164, s[18:19] offset:1024
    global_load_dwordx4 v[64:67], v165, s[18:19] offset:1024
    global_load_dwordx4 v[68:71], v166, s[18:19] offset:1024
    global_load_dwordx4 v[72:75], v167, s[18:19] offset:1024
    global_load_dwordx4 v[76:79], v168, s[18:19] offset:1024
    global_load_dwordx4 v[80:83], v169, s[18:19] offset:1024
    global_load_dwordx4 v[84:87], v170, s[18:19] offset:1024
    global_load_dwordx4 v[88:91], v171, s[18:19] offset:1024
    global_load_dwordx4 v[92:95], v172, s[18:19] offset:1024
    ds_read_b128 v[132:135], v23 offset:0
    ds_read_b128 v[136:139], v23 offset:18688
    ds_read_b128 v[140:143], v23 offset:37376
    ds_read_b128 v[144:147], v23 offset:56064
    global_load_dwordx4 v[96:99], v164, s[18:19] offset:2048
    global_load_dwordx4 v[100:103], v165, s[18:19] offset:2048
    global_load_dwordx4 v[104:107], v166, s[18:19] offset:2048
    global_load_dwordx4 v[108:111], v167, s[18:19] offset:2048
    global_load_dwordx4 v[112:115], v168, s[18:19] offset:2048
    global_load_dwordx4 v[116:119], v169, s[18:19] offset:2048
    global_load_dwordx4 v[120:123], v170, s[18:19] offset:2048
    global_load_dwordx4 v[124:127], v171, s[18:19] offset:2048
    global_load_dwordx4 v[128:131], v172, s[18:19] offset:2048
    ds_read_b128 v[148:151], v23 offset:64
    ds_read_b128 v[152:155], v23 offset:18752
    ds_read_b128 v[156:159], v23 offset:37440
    ds_read_b128 v[160:163], v23 offset:56128
    s_waitcnt vmcnt(18) lgkmcnt(4)
    v_mfma_f32_16x16x32_bf16 a[0:3], v[24:27], v[132:135], a[0:3]
    v_mfma_f32_16x16x32_bf16 a[4:7], v[24:27], v[136:139], a[4:7]
    v_mfma_f32_16x16x32_bf16 a[8:11], v[24:27], v[140:143], a[8:11]
    v_mfma_f32_16x16x32_bf16 a[12:15], v[24:27], v[144:147], a[12:15]
    v_mfma_f32_16x16x32_bf16 a[16:19], v[28:31], v[132:135], a[16:19]
    v_mfma_f32_16x16x32_bf16 a[20:23], v[28:31], v[136:139], a[20:23]
    v_mfma_f32_16x16x32_bf16 a[24:27], v[28:31], v[140:143], a[24:27]
    v_mfma_f32_16x16x32_bf16 a[28:31], v[28:31], v[144:147], a[28:31]
    v_mfma_f32_16x16x32_bf16 a[32:35], v[32:35], v[132:135], a[32:35]
    v_mfma_f32_16x16x32_bf16 a[36:39], v[32:35], v[136:139], a[36:39]
    v_mfma_f32_16x16x32_bf16 a[40:43], v[32:35], v[140:143], a[40:43]
    v_mfma_f32_16x16x32_bf16 a[44:47], v[32:35], v[144:147], a[44:47]
    v_mfma_f32_16x16x32_bf16 a[48:51], v[36:39], v[132:135], a[48:51]
    v_mfma_f32_16x16x32_bf16 a[52:55], v[36:39], v[136:139], a[52:55]
    v_mfma_f32_16x16x32_bf16 a[56:59], v[36:39], v[140:143], a[56:59]
    v_mfma_f32_16x16x32_bf16 a[60:63], v[36:39], v[144:147], a[60:63]
    v_mfma_f32_16x16x32_bf16 a[64:67], v[40:43], v[132:135], a[64:67]
    v_mfma_f32_16x16x32_bf16 a[68:71], v[40:43], v[136:139], a[68:71]
    v_mfma_f32_16x16x32_bf16 a[72:75], v[40:43], v[140:143], a[72:75]
    v_mfma_f32_16x16x32_bf16 a[76:79], v[40:43], v[144:147], a[76:79]
    v_mfma_f32_16x16x32_bf16 a[80:83], v[44:47], v[132:135], a[80:83]
    v_mfma_f32_16x16x32_bf16 a[84:87], v[44:47], v[136:139], a[84:87]
    v_mfma_f32_16x16x32_bf16 a[88:91], v[44:47], v[140:143], a[88:91]
    v_mfma_f32_16x16x32_bf16 a[92:95], v[44:47], v[144:147], a[92:95]
    v_mfma_f32_16x16x32_bf16 a[96:99], v[48:51], v[132:135], a[96:99]
    v_mfma_f32_16x16x32_bf16 a[100:103], v[48:51], v[136:139], a[100:103]
    v_mfma_f32_16x16x32_bf16 a[104:107], v[48:51], v[140:143], a[104:107]
    v_mfma_f32_16x16x32_bf16 a[108:111], v[48:51], v[144:147], a[108:111]
    v_mfma_f32_16x16x32_bf16 a[112:115], v[52:55], v[132:135], a[112:115]
    v_mfma_f32_16x16x32_bf16 a[116:119], v[52:55], v[136:139], a[116:119]
    v_mfma_f32_16x16x32_bf16 a[120:123], v[52:55], v[140:143], a[120:123]
    v_mfma_f32_16x16x32_bf16 a[124:127], v[52:55], v[144:147], a[124:127]
    v_mfma_f32_16x16x32_bf16 a[128:131], v[56:59], v[132:135], a[128:131]
    v_mfma_f32_16x16x32_bf16 a[132:135], v[56:59], v[136:139], a[132:135]
    v_mfma_f32_16x16x32_bf16 a[136:139], v[56:59], v[140:143], a[136:139]
    v_mfma_f32_16x16x32_bf16 a[140:143], v[56:59], v[144:147], a[140:143]
    global_load_dwordx4 v[24:27], v164, s[18:19] offset:3072
    global_load_dwordx4 v[28:31], v165, s[18:19] offset:3072
    global_load_dwordx4 v[32:35], v166, s[18:19] offset:3072
    global_load_dwordx4 v[36:39], v167, s[18:19] offset:3072
    global_load_dwordx4 v[40:43], v168, s[18:19] offset:3072
    global_load_dwordx4 v[44:47], v169, s[18:19] offset:3072
    global_load_dwordx4 v[48:51], v170, s[18:19] offset:3072
    global_load_dwordx4 v[52:55], v171, s[18:19] offset:3072
    global_load_dwordx4 v[56:59], v172, s[18:19] offset:3072
    v_add_u32 v164, 4096, v164
    v_add_u32 v165, 4096, v165
    v_add_u32 v166, 4096, v166
    v_add_u32 v167, 4096, v167
    v_add_u32 v168, 4096, v168
    v_add_u32 v169, 4096, v169
    v_add_u32 v170, 4096, v170
    v_add_u32 v171, 4096, v171
    v_add_u32 v172, 4096, v172
    ds_read_b128 v[132:135], v23 offset:128
    ds_read_b128 v[136:139], v23 offset:18816
    ds_read_b128 v[140:143], v23 offset:37504
    ds_read_b128 v[144:147], v23 offset:56192
    s_waitcnt vmcnt(18) lgkmcnt(4)
    v_mfma_f32_16x16x32_bf16 a[0:3], v[60:63], v[148:151], a[0:3]
    v_mfma_f32_16x16x32_bf16 a[4:7], v[60:63], v[152:155], a[4:7]
    v_mfma_f32_16x16x32_bf16 a[8:11], v[60:63], v[156:159], a[8:11]
    v_mfma_f32_16x16x32_bf16 a[12:15], v[60:63], v[160:163], a[12:15]
    v_mfma_f32_16x16x32_bf16 a[16:19], v[64:67], v[148:151], a[16:19]
    v_mfma_f32_16x16x32_bf16 a[20:23], v[64:67], v[152:155], a[20:23]
    v_mfma_f32_16x16x32_bf16 a[24:27], v[64:67], v[156:159], a[24:27]
    v_mfma_f32_16x16x32_bf16 a[28:31], v[64:67], v[160:163], a[28:31]
    v_mfma_f32_16x16x32_bf16 a[32:35], v[68:71], v[148:151], a[32:35]
    v_mfma_f32_16x16x32_bf16 a[36:39], v[68:71], v[152:155], a[36:39]
    v_mfma_f32_16x16x32_bf16 a[40:43], v[68:71], v[156:159], a[40:43]
    v_mfma_f32_16x16x32_bf16 a[44:47], v[68:71], v[160:163], a[44:47]
    v_mfma_f32_16x16x32_bf16 a[48:51], v[72:75], v[148:151], a[48:51]
    v_mfma_f32_16x16x32_bf16 a[52:55], v[72:75], v[152:155], a[52:55]
    v_mfma_f32_16x16x32_bf16 a[56:59], v[72:75], v[156:159], a[56:59]
    v_mfma_f32_16x16x32_bf16 a[60:63], v[72:75], v[160:163], a[60:63]
    v_mfma_f32_16x16x32_bf16 a[64:67], v[76:79], v[148:151], a[64:67]
    v_mfma_f32_16x16x32_bf16 a[68:71], v[76:79], v[152:155], a[68:71]
    v_mfma_f32_16x16x32_bf16 a[72:75], v[76:79], v[156:159], a[72:75]
    v_mfma_f32_16x16x32_bf16 a[76:79], v[76:79], v[160:163], a[76:79]
    v_mfma_f32_16x16x32_bf16 a[80:83], v[80:83], v[148:151], a[80:83]
    v_mfma_f32_16x16x32_bf16 a[84:87], v[80:83], v[152:155], a[84:87]
    v_mfma_f32_16x16x32_bf16 a[88:91], v[80:83], v[156:159], a[88:91]
    v_mfma_f32_16x16x32_bf16 a[92:95], v[80:83], v[160:163], a[92:95]
    v_mfma_f32_16x16x32_bf16 a[96:99], v[84:87], v[148:151], a[96:99]
    v_mfma_f32_16x16x32_bf16 a[100:103], v[84:87], v[152:155], a[100:103]
    v_mfma_f32_16x16x32_bf16 a[104:107], v[84:87], v[156:159], a[104:107]
    v_mfma_f32_16x16x32_bf16 a[108:111], v[84:87], v[160:163], a[108:111]
    v_mfma_f32_16x16x32_bf16 a[112:115], v[88:91], v[148:151], a[112:115]
    v_mfma_f32_16x16x32_bf16 a[116:119], v[88:91], v[152:155], a[116:119]
    v_mfma_f32_16x16x32_bf16 a[120:123], v[88:91], v[156:159], a[120:123]
    v_mfma_f32_16x16x32_bf16 a[124:127], v[88:91], v[160:163], a[124:127]
    v_mfma_f32_16x16x32_bf16 a[128:131], v[92:95], v[148:151], a[128:131]
    v_mfma_f32_16x16x32_bf16 a[132:135], v[92:95], v[152:155], a[132:135]
    v_mfma_f32_16x16x32_bf16 a[136:139], v[92:95], v[156:159], a[136:139]
    v_mfma_f32_16x16x32_bf16 a[140:143], v[92:95], v[160:163], a[140:143]
    global_load_dwordx4 v[60:63], v164, s[18:19] offset:0
    global_load_dwordx4 v[64:67], v165, s[18:19] offset:0
    global_load_dwordx4 v[68:71], v166, s[18:19] offset:0
    global_load_dwordx4 v[72:75], v167, s[18:19] offset:0
    global_load_dwordx4 v[76:79], v168, s[18:19] offset:0
    global_load_dwordx4 v[80:83], v169, s[18:19] offset:0
    global_load_dwordx4 v[84:87], v170, s[18:19] offset:0
    global_load_dwordx4 v[88:91], v171, s[18:19] offset:0
    global_load_dwordx4 v[92:95], v172, s[18:19] offset:0
    ds_read_b128 v[148:151], v23 offset:192
    ds_read_b128 v[152:155], v23 offset:18880
    ds_read_b128 v[156:159], v23 offset:37568
    ds_read_b128 v[160:163], v23 offset:56256
    s_waitcnt vmcnt(18) lgkmcnt(4)
    v_mfma_f32_16x16x32_bf16 a[0:3], v[96:99], v[132:135], a[0:3]
    v_mfma_f32_16x16x32_bf16 a[4:7], v[96:99], v[136:139], a[4:7]
    v_mfma_f32_16x16x32_bf16 a[8:11], v[96:99], v[140:143], a[8:11]
    v_mfma_f32_16x16x32_bf16 a[12:15], v[96:99], v[144:147], a[12:15]
    v_mfma_f32_16x16x32_bf16 a[16:19], v[100:103], v[132:135], a[16:19]
    v_mfma_f32_16x16x32_bf16 a[20:23], v[100:103], v[136:139], a[20:23]
    v_mfma_f32_16x16x32_bf16 a[24:27], v[100:103], v[140:143], a[24:27]
    v_mfma_f32_16x16x32_bf16 a[28:31], v[100:103], v[144:147], a[28:31]
    v_mfma_f32_16x16x32_bf16 a[32:35], v[104:107], v[132:135], a[32:35]
    v_mfma_f32_16x16x32_bf16 a[36:39], v[104:107], v[136:139], a[36:39]
    v_mfma_f32_16x16x32_bf16 a[40:43], v[104:107], v[140:143], a[40:43]
    v_mfma_f32_16x16x32_bf16 a[44:47], v[104:107], v[144:147], a[44:47]
    v_mfma_f32_16x16x32_bf16 a[48:51], v[108:111], v[132:135], a[48:51]
    v_mfma_f32_16x16x32_bf16 a[52:55], v[108:111], v[136:139], a[52:55]
    v_mfma_f32_16x16x32_bf16 a[56:59], v[108:111], v[140:143], a[56:59]
    v_mfma_f32_16x16x32_bf16 a[60:63], v[108:111], v[144:147], a[60:63]
    v_mfma_f32_16x16x32_bf16 a[64:67], v[112:115], v[132:135], a[64:67]
    v_mfma_f32_16x16x32_bf16 a[68:71], v[112:115], v[136:139], a[68:71]
    v_mfma_f32_16x16x32_bf16 a[72:75], v[112:115], v[140:143], a[72:75]
    v_mfma_f32_16x16x32_bf16 a[76:79], v[112:115], v[144:147], a[76:79]
    v_mfma_f32_16x16x32_bf16 a[80:83], v[116:119], v[132:135], a[80:83]
    v_mfma_f32_16x16x32_bf16 a[84:87], v[116:119], v[136:139], a[84:87]
    v_mfma_f32_16x16x32_bf16 a[88:91], v[116:119], v[140:143], a[88:91]
    v_mfma_f32_16x16x32_bf16 a[92:95], v[116:119], v[144:147], a[92:95]
    v_mfma_f32_16x16x32_bf16 a[96:99], v[120:123], v[132:135], a[96:99]
    v_mfma_f32_16x16x32_bf16 a[100:103], v[120:123], v[136:139], a[100:103]
    v_mfma_f32_16x16x32_bf16 a[104:107], v[120:123], v[140:143], a[104:107]
    v_mfma_f32_16x16x32_bf16 a[108:111], v[120:123], v[144:147], a[108:111]
    v_mfma_f32_16x16x32_bf16 a[112:115], v[124:127], v[132:135], a[112:115]
    v_mfma_f32_16x16x32_bf16 a[116:119], v[124:127], v[136:139], a[116:119]
    v_mfma_f32_16x16x32_bf16 a[120:123], v[124:127], v[140:143], a[120:123]
    v_mfma_f32_16x16x32_bf16 a[124:127], v[124:127], v[144:147], a[124:127]
    v_mfma_f32_16x16x32_bf16 a[128:131], v[128:131], v[132:135], a[128:131]
    v_mfma_f32_16x16x32_bf16 a[132:135], v[128:131], v[136:139], a[132:135]
    v_mfma_f32_16x16x32_bf16 a[136:139], v[128:131], v[140:143], a[136:139]
    v_mfma_f32_16x16x32_bf16 a[140:143], v[128:131], v[144:147], a[140:143]
    global_load_dwordx4 v[96:99], v164, s[18:19] offset:1024
    global_load_dwordx4 v[100:103], v165, s[18:19] offset:1024
    global_load_dwordx4 v[104:107], v166, s[18:19] offset:1024
    global_load_dwordx4 v[108:111], v167, s[18:19] offset:1024
    global_load_dwordx4 v[112:115], v168, s[18:19] offset:1024
    global_load_dwordx4 v[116:119], v169, s[18:19] offset:1024
    global_load_dwordx4 v[120:123], v170, s[18:19] offset:1024
    global_load_dwordx4 v[124:127], v171, s[18:19] offset:1024
    global_load_dwordx4 v[128:131], v172, s[18:19] offset:1024
    ds_read_b128 v[132:135], v23 offset:256
    ds_read_b128 v[136:139], v23 offset:18944
    ds_read_b128 v[140:143], v23 offset:37632
    ds_read_b128 v[144:147], v23 offset:56320
    s_waitcnt vmcnt(18) lgkmcnt(4)
    v_mfma_f32_16x16x32_bf16 a[0:3], v[24:27], v[148:151], a[0:3]
    v_mfma_f32_16x16x32_bf16 a[4:7], v[24:27], v[152:155], a[4:7]
    v_mfma_f32_16x16x32_bf16 a[8:11], v[24:27], v[156:159], a[8:11]
    v_mfma_f32_16x16x32_bf16 a[12:15], v[24:27], v[160:163], a[12:15]
    v_mfma_f32_16x16x32_bf16 a[16:19], v[28:31], v[148:151], a[16:19]
    v_mfma_f32_16x16x32_bf16 a[20:23], v[28:31], v[152:155], a[20:23]
    v_mfma_f32_16x16x32_bf16 a[24:27], v[28:31], v[156:159], a[24:27]
    v_mfma_f32_16x16x32_bf16 a[28:31], v[28:31], v[160:163], a[28:31]
    v_mfma_f32_16x16x32_bf16 a[32:35], v[32:35], v[148:151], a[32:35]
    v_mfma_f32_16x16x32_bf16 a[36:39], v[32:35], v[152:155], a[36:39]
    v_mfma_f32_16x16x32_bf16 a[40:43], v[32:35], v[156:159], a[40:43]
    v_mfma_f32_16x16x32_bf16 a[44:47], v[32:35], v[160:163], a[44:47]
    v_mfma_f32_16x16x32_bf16 a[48:51], v[36:39], v[148:151], a[48:51]
    v_mfma_f32_16x16x32_bf16 a[52:55], v[36:39], v[152:155], a[52:55]
    v_mfma_f32_16x16x32_bf16 a[56:59], v[36:39], v[156:159], a[56:59]
    v_mfma_f32_16x16x32_bf16 a[60:63], v[36:39], v[160:163], a[60:63]
    v_mfma_f32_16x16x32_bf16 a[64:67], v[40:43], v[148:151], a[64:67]
    v_mfma_f32_16x16x32_bf16 a[68:71], v[40:43], v[152:155], a[68:71]
    v_mfma_f32_16x16x32_bf16 a[72:75], v[40:43], v[156:159], a[72:75]
    v_mfma_f32_16x16x32_bf16 a[76:79], v[40:43], v[160:163], a[76:79]
    v_mfma_f32_16x16x32_bf16 a[80:83], v[44:47], v[148:151], a[80:83]
    v_mfma_f32_16x16x32_bf16 a[84:87], v[44:47], v[152:155], a[84:87]
    v_mfma_f32_16x16x32_bf16 a[88:91], v[44:47], v[156:159], a[88:91]
    v_mfma_f32_16x16x32_bf16 a[92:95], v[44:47], v[160:163], a[92:95]
    v_mfma_f32_16x16x32_bf16 a[96:99], v[48:51], v[148:151], a[96:99]
    v_mfma_f32_16x16x32_bf16 a[100:103], v[48:51], v[152:155], a[100:103]
    v_mfma_f32_16x16x32_bf16 a[104:107], v[48:51], v[156:159], a[104:107]
    v_mfma_f32_16x16x32_bf16 a[108:111], v[48:51], v[160:163], a[108:111]
    v_mfma_f32_16x16x32_bf16 a[112:115], v[52:55], v[148:151], a[112:115]
    v_mfma_f32_16x16x32_bf16 a[116:119], v[52:55], v[152:155], a[116:119]
    v_mfma_f32_16x16x32_bf16 a[120:123], v[52:55], v[156:159], a[120:123]
    v_mfma_f32_16x16x32_bf16 a[124:127], v[52:55], v[160:163], a[124:127]
    v_mfma_f32_16x16x32_bf16 a[128:131], v[56:59], v[148:151], a[128:131]
    v_mfma_f32_16x16x32_bf16 a[132:135], v[56:59], v[152:155], a[132:135]
    v_mfma_f32_16x16x32_bf16 a[136:139], v[56:59], v[156:159], a[136:139]
    v_mfma_f32_16x16x32_bf16 a[140:143], v[56:59], v[160:163], a[140:143]
    global_load_dwordx4 v[24:27], v164, s[18:19] offset:2048
    global_load_dwordx4 v[28:31], v165, s[18:19] offset:2048
    global_load_dwordx4 v[32:35], v166, s[18:19] offset:2048
    global_load_dwordx4 v[36:39], v167, s[18:19] offset:2048
    global_load_dwordx4 v[40:43], v168, s[18:19] offset:2048
    global_load_dwordx4 v[44:47], v169, s[18:19] offset:2048
    global_load_dwordx4 v[48:51], v170, s[18:19] offset:2048
    global_load_dwordx4 v[52:55], v171, s[18:19] offset:2048
    global_load_dwordx4 v[56:59], v172, s[18:19] offset:2048
    ds_read_b128 v[148:151], v23 offset:320
    ds_read_b128 v[152:155], v23 offset:19008
    ds_read_b128 v[156:159], v23 offset:37696
    ds_read_b128 v[160:163], v23 offset:56384
    s_waitcnt vmcnt(18) lgkmcnt(4)
    v_mfma_f32_16x16x32_bf16 a[0:3], v[60:63], v[132:135], a[0:3]
    v_mfma_f32_16x16x32_bf16 a[4:7], v[60:63], v[136:139], a[4:7]
    v_mfma_f32_16x16x32_bf16 a[8:11], v[60:63], v[140:143], a[8:11]
    v_mfma_f32_16x16x32_bf16 a[12:15], v[60:63], v[144:147], a[12:15]
    v_mfma_f32_16x16x32_bf16 a[16:19], v[64:67], v[132:135], a[16:19]
    v_mfma_f32_16x16x32_bf16 a[20:23], v[64:67], v[136:139], a[20:23]
    v_mfma_f32_16x16x32_bf16 a[24:27], v[64:67], v[140:143], a[24:27]
    v_mfma_f32_16x16x32_bf16 a[28:31], v[64:67], v[144:147], a[28:31]
    v_mfma_f32_16x16x32_bf16 a[32:35], v[68:71], v[132:135], a[32:35]
    v_mfma_f32_16x16x32_bf16 a[36:39], v[68:71], v[136:139], a[36:39]
    v_mfma_f32_16x16x32_bf16 a[40:43], v[68:71], v[140:143], a[40:43]
    v_mfma_f32_16x16x32_bf16 a[44:47], v[68:71], v[144:147], a[44:47]
    v_mfma_f32_16x16x32_bf16 a[48:51], v[72:75], v[132:135], a[48:51]
    v_mfma_f32_16x16x32_bf16 a[52:55], v[72:75], v[136:139], a[52:55]
    v_mfma_f32_16x16x32_bf16 a[56:59], v[72:75], v[140:143], a[56:59]
    v_mfma_f32_16x16x32_bf16 a[60:63], v[72:75], v[144:147], a[60:63]
    v_mfma_f32_16x16x32_bf16 a[64:67], v[76:79], v[132:135], a[64:67]
    v_mfma_f32_16x16x32_bf16 a[68:71], v[76:79], v[136:139], a[68:71]
    v_mfma_f32_16x16x32_bf16 a[72:75], v[76:79], v[140:143], a[72:75]
    v_mfma_f32_16x16x32_bf16 a[76:79], v[76:79], v[144:147], a[76:79]
    v_mfma_f32_16x16x32_bf16 a[80:83], v[80:83], v[132:135], a[80:83]
    v_mfma_f32_16x16x32_bf16 a[84:87], v[80:83], v[136:139], a[84:87]
    v_mfma_f32_16x16x32_bf16 a[88:91], v[80:83], v[140:143], a[88:91]
    v_mfma_f32_16x16x32_bf16 a[92:95], v[80:83], v[144:147], a[92:95]
    v_mfma_f32_16x16x32_bf16 a[96:99], v[84:87], v[132:135], a[96:99]
    v_mfma_f32_16x16x32_bf16 a[100:103], v[84:87], v[136:139], a[100:103]
    v_mfma_f32_16x16x32_bf16 a[104:107], v[84:87], v[140:143], a[104:107]
    v_mfma_f32_16x16x32_bf16 a[108:111], v[84:87], v[144:147], a[108:111]
    v_mfma_f32_16x16x32_bf16 a[112:115], v[88:91], v[132:135], a[112:115]
    v_mfma_f32_16x16x32_bf16 a[116:119], v[88:91], v[136:139], a[116:119]
    v_mfma_f32_16x16x32_bf16 a[120:123], v[88:91], v[140:143], a[120:123]
    v_mfma_f32_16x16x32_bf16 a[124:127], v[88:91], v[144:147], a[124:127]
    v_mfma_f32_16x16x32_bf16 a[128:131], v[92:95], v[132:135], a[128:131]
    v_mfma_f32_16x16x32_bf16 a[132:135], v[92:95], v[136:139], a[132:135]
    v_mfma_f32_16x16x32_bf16 a[136:139], v[92:95], v[140:143], a[136:139]
    v_mfma_f32_16x16x32_bf16 a[140:143], v[92:95], v[144:147], a[140:143]
    global_load_dwordx4 v[60:63], v164, s[18:19] offset:3072
    global_load_dwordx4 v[64:67], v165, s[18:19] offset:3072
    global_load_dwordx4 v[68:71], v166, s[18:19] offset:3072
    global_load_dwordx4 v[72:75], v167, s[18:19] offset:3072
    global_load_dwordx4 v[76:79], v168, s[18:19] offset:3072
    global_load_dwordx4 v[80:83], v169, s[18:19] offset:3072
    global_load_dwordx4 v[84:87], v170, s[18:19] offset:3072
    global_load_dwordx4 v[88:91], v171, s[18:19] offset:3072
    global_load_dwordx4 v[92:95], v172, s[18:19] offset:3072
    v_add_u32 v164, 4096, v164
    v_add_u32 v165, 4096, v165
    v_add_u32 v166, 4096, v166
    v_add_u32 v167, 4096, v167
    v_add_u32 v168, 4096, v168
    v_add_u32 v169, 4096, v169
    v_add_u32 v170, 4096, v170
    v_add_u32 v171, 4096, v171
    v_add_u32 v172, 4096, v172
    ds_read_b128 v[132:135], v23 offset:384
    ds_read_b128 v[136:139], v23 offset:19072
    ds_read_b128 v[140:143], v23 offset:37760
    ds_read_b128 v[144:147], v23 offset:56448
    s_waitcnt vmcnt(18) lgkmcnt(4)
    v_mfma_f32_16x16x32_bf16 a[0:3], v[96:99], v[148:151], a[0:3]
    v_mfma_f32_16x16x32_bf16 a[4:7], v[96:99], v[152:155], a[4:7]
    v_mfma_f32_16x16x32_bf16 a[8:11], v[96:99], v[156:159], a[8:11]
    v_mfma_f32_16x16x32_bf16 a[12:15], v[96:99], v[160:163], a[12:15]
    v_mfma_f32_16x16x32_bf16 a[16:19], v[100:103], v[148:151], a[16:19]
    v_mfma_f32_16x16x32_bf16 a[20:23], v[100:103], v[152:155], a[20:23]
    v_mfma_f32_16x16x32_bf16 a[24:27], v[100:103], v[156:159], a[24:27]
    v_mfma_f32_16x16x32_bf16 a[28:31], v[100:103], v[160:163], a[28:31]
    v_mfma_f32_16x16x32_bf16 a[32:35], v[104:107], v[148:151], a[32:35]
    v_mfma_f32_16x16x32_bf16 a[36:39], v[104:107], v[152:155], a[36:39]
    v_mfma_f32_16x16x32_bf16 a[40:43], v[104:107], v[156:159], a[40:43]
    v_mfma_f32_16x16x32_bf16 a[44:47], v[104:107], v[160:163], a[44:47]
    v_mfma_f32_16x16x32_bf16 a[48:51], v[108:111], v[148:151], a[48:51]
    v_mfma_f32_16x16x32_bf16 a[52:55], v[108:111], v[152:155], a[52:55]
    v_mfma_f32_16x16x32_bf16 a[56:59], v[108:111], v[156:159], a[56:59]
    v_mfma_f32_16x16x32_bf16 a[60:63], v[108:111], v[160:163], a[60:63]
    v_mfma_f32_16x16x32_bf16 a[64:67], v[112:115], v[148:151], a[64:67]
    v_mfma_f32_16x16x32_bf16 a[68:71], v[112:115], v[152:155], a[68:71]
    v_mfma_f32_16x16x32_bf16 a[72:75], v[112:115], v[156:159], a[72:75]
    v_mfma_f32_16x16x32_bf16 a[76:79], v[112:115], v[160:163], a[76:79]
    v_mfma_f32_16x16x32_bf16 a[80:83], v[116:119], v[148:151], a[80:83]
    v_mfma_f32_16x16x32_bf16 a[84:87], v[116:119], v[152:155], a[84:87]
    v_mfma_f32_16x16x32_bf16 a[88:91], v[116:119], v[156:159], a[88:91]
    v_mfma_f32_16x16x32_bf16 a[92:95], v[116:119], v[160:163], a[92:95]
    v_mfma_f32_16x16x32_bf16 a[96:99], v[120:123], v[148:151], a[96:99]
    v_mfma_f32_16x16x32_bf16 a[100:103], v[120:123], v[152:155], a[100:103]
    v_mfma_f32_16x16x32_bf16 a[104:107], v[120:123], v[156:159], a[104:107]
    v_mfma_f32_16x16x32_bf16 a[108:111], v[120:123], v[160:163], a[108:111]
    v_mfma_f32_16x16x32_bf16 a[112:115], v[124:127], v[148:151], a[112:115]
    v_mfma_f32_16x16x32_bf16 a[116:119], v[124:127], v[152:155], a[116:119]
    v_mfma_f32_16x16x32_bf16 a[120:123], v[124:127], v[156:159], a[120:123]
    v_mfma_f32_16x16x32_bf16 a[124:127], v[124:127], v[160:163], a[124:127]
    v_mfma_f32_16x16x32_bf16 a[128:131], v[128:131], v[148:151], a[128:131]
    v_mfma_f32_16x16x32_bf16 a[132:135], v[128:131], v[152:155], a[132:135]
    v_mfma_f32_16x16x32_bf16 a[136:139], v[128:131], v[156:159], a[136:139]
    v_mfma_f32_16x16x32_bf16 a[140:143], v[128:131], v[160:163], a[140:143]
    global_load_dwordx4 v[96:99], v164, s[18:19] offset:0
    global_load_dwordx4 v[100:103], v165, s[18:19] offset:0
    global_load_dwordx4 v[104:107], v166, s[18:19] offset:0
    global_load_dwordx4 v[108:111], v167, s[18:19] offset:0
    global_load_dwordx4 v[112:115], v168, s[18:19] offset:0
    global_load_dwordx4 v[116:119], v169, s[18:19] offset:0
    global_load_dwordx4 v[120:123], v170, s[18:19] offset:0
    global_load_dwordx4 v[124:127], v171, s[18:19] offset:0
    global_load_dwordx4 v[128:131], v172, s[18:19] offset:0
    ds_read_b128 v[148:151], v23 offset:448
    ds_read_b128 v[152:155], v23 offset:19136
    ds_read_b128 v[156:159], v23 offset:37824
    ds_read_b128 v[160:163], v23 offset:56512
    s_waitcnt vmcnt(18) lgkmcnt(4)
    v_mfma_f32_16x16x32_bf16 a[0:3], v[24:27], v[132:135], a[0:3]
    v_mfma_f32_16x16x32_bf16 a[4:7], v[24:27], v[136:139], a[4:7]
    v_mfma_f32_16x16x32_bf16 a[8:11], v[24:27], v[140:143], a[8:11]
    v_mfma_f32_16x16x32_bf16 a[12:15], v[24:27], v[144:147], a[12:15]
    v_mfma_f32_16x16x32_bf16 a[16:19], v[28:31], v[132:135], a[16:19]
    v_mfma_f32_16x16x32_bf16 a[20:23], v[28:31], v[136:139], a[20:23]
    v_mfma_f32_16x16x32_bf16 a[24:27], v[28:31], v[140:143], a[24:27]
    v_mfma_f32_16x16x32_bf16 a[28:31], v[28:31], v[144:147], a[28:31]
    v_mfma_f32_16x16x32_bf16 a[32:35], v[32:35], v[132:135], a[32:35]
    v_mfma_f32_16x16x32_bf16 a[36:39], v[32:35], v[136:139], a[36:39]
    v_mfma_f32_16x16x32_bf16 a[40:43], v[32:35], v[140:143], a[40:43]
    v_mfma_f32_16x16x32_bf16 a[44:47], v[32:35], v[144:147], a[44:47]
    v_mfma_f32_16x16x32_bf16 a[48:51], v[36:39], v[132:135], a[48:51]
    v_mfma_f32_16x16x32_bf16 a[52:55], v[36:39], v[136:139], a[52:55]
    v_mfma_f32_16x16x32_bf16 a[56:59], v[36:39], v[140:143], a[56:59]
    v_mfma_f32_16x16x32_bf16 a[60:63], v[36:39], v[144:147], a[60:63]
    v_mfma_f32_16x16x32_bf16 a[64:67], v[40:43], v[132:135], a[64:67]
    v_mfma_f32_16x16x32_bf16 a[68:71], v[40:43], v[136:139], a[68:71]
    v_mfma_f32_16x16x32_bf16 a[72:75], v[40:43], v[140:143], a[72:75]
    v_mfma_f32_16x16x32_bf16 a[76:79], v[40:43], v[144:147], a[76:79]
    v_mfma_f32_16x16x32_bf16 a[80:83], v[44:47], v[132:135], a[80:83]
    v_mfma_f32_16x16x32_bf16 a[84:87], v[44:47], v[136:139], a[84:87]
    v_mfma_f32_16x16x32_bf16 a[88:91], v[44:47], v[140:143], a[88:91]
    v_mfma_f32_16x16x32_bf16 a[92:95], v[44:47], v[144:147], a[92:95]
    v_mfma_f32_16x16x32_bf16 a[96:99], v[48:51], v[132:135], a[96:99]
    v_mfma_f32_16x16x32_bf16 a[100:103], v[48:51], v[136:139], a[100:103]
    v_mfma_f32_16x16x32_bf16 a[104:107], v[48:51], v[140:143], a[104:107]
    v_mfma_f32_16x16x32_bf16 a[108:111], v[48:51], v[144:147], a[108:111]
    v_mfma_f32_16x16x32_bf16 a[112:115], v[52:55], v[132:135], a[112:115]
    v_mfma_f32_16x16x32_bf16 a[116:119], v[52:55], v[136:139], a[116:119]
    v_mfma_f32_16x16x32_bf16 a[120:123], v[52:55], v[140:143], a[120:123]
    v_mfma_f32_16x16x32_bf16 a[124:127], v[52:55], v[144:147], a[124:127]
    v_mfma_f32_16x16x32_bf16 a[128:131], v[56:59], v[132:135], a[128:131]
    v_mfma_f32_16x16x32_bf16 a[132:135], v[56:59], v[136:139], a[132:135]
    v_mfma_f32_16x16x32_bf16 a[136:139], v[56:59], v[140:143], a[136:139]
    v_mfma_f32_16x16x32_bf16 a[140:143], v[56:59], v[144:147], a[140:143]
    global_load_dwordx4 v[24:27], v164, s[18:19] offset:1024
    global_load_dwordx4 v[28:31], v165, s[18:19] offset:1024
    global_load_dwordx4 v[32:35], v166, s[18:19] offset:1024
    global_load_dwordx4 v[36:39], v167, s[18:19] offset:1024
    global_load_dwordx4 v[40:43], v168, s[18:19] offset:1024
    global_load_dwordx4 v[44:47], v169, s[18:19] offset:1024
    global_load_dwordx4 v[48:51], v170, s[18:19] offset:1024
    global_load_dwordx4 v[52:55], v171, s[18:19] offset:1024
    global_load_dwordx4 v[56:59], v172, s[18:19] offset:1024
    ds_read_b128 v[132:135], v23 offset:512
    ds_read_b128 v[136:139], v23 offset:19200
    ds_read_b128 v[140:143], v23 offset:37888
    ds_read_b128 v[144:147], v23 offset:56576
    s_waitcnt vmcnt(18) lgkmcnt(4)
    v_mfma_f32_16x16x32_bf16 a[0:3], v[60:63], v[148:151], a[0:3]
    v_mfma_f32_16x16x32_bf16 a[4:7], v[60:63], v[152:155], a[4:7]
    v_mfma_f32_16x16x32_bf16 a[8:11], v[60:63], v[156:159], a[8:11]
    v_mfma_f32_16x16x32_bf16 a[12:15], v[60:63], v[160:163], a[12:15]
    v_mfma_f32_16x16x32_bf16 a[16:19], v[64:67], v[148:151], a[16:19]
    v_mfma_f32_16x16x32_bf16 a[20:23], v[64:67], v[152:155], a[20:23]
    v_mfma_f32_16x16x32_bf16 a[24:27], v[64:67], v[156:159], a[24:27]
    v_mfma_f32_16x16x32_bf16 a[28:31], v[64:67], v[160:163], a[28:31]
    v_mfma_f32_16x16x32_bf16 a[32:35], v[68:71], v[148:151], a[32:35]
    v_mfma_f32_16x16x32_bf16 a[36:39], v[68:71], v[152:155], a[36:39]
    v_mfma_f32_16x16x32_bf16 a[40:43], v[68:71], v[156:159], a[40:43]
    v_mfma_f32_16x16x32_bf16 a[44:47], v[68:71], v[160:163], a[44:47]
    v_mfma_f32_16x16x32_bf16 a[48:51], v[72:75], v[148:151], a[48:51]
    v_mfma_f32_16x16x32_bf16 a[52:55], v[72:75], v[152:155], a[52:55]
    v_mfma_f32_16x16x32_bf16 a[56:59], v[72:75], v[156:159], a[56:59]
    v_mfma_f32_16x16x32_bf16 a[60:63], v[72:75], v[160:163], a[60:63]
    v_mfma_f32_16x16x32_bf16 a[64:67], v[76:79], v[148:151], a[64:67]
    v_mfma_f32_16x16x32_bf16 a[68:71], v[76:79], v[152:155], a[68:71]
    v_mfma_f32_16x16x32_bf16 a[72:75], v[76:79], v[156:159], a[72:75]
    v_mfma_f32_16x16x32_bf16 a[76:79], v[76:79], v[160:163], a[76:79]
    v_mfma_f32_16x16x32_bf16 a[80:83], v[80:83], v[148:151], a[80:83]
    v_mfma_f32_16x16x32_bf16 a[84:87], v[80:83], v[152:155], a[84:87]
    v_mfma_f32_16x16x32_bf16 a[88:91], v[80:83], v[156:159], a[88:91]
    v_mfma_f32_16x16x32_bf16 a[92:95], v[80:83], v[160:163], a[92:95]
    v_mfma_f32_16x16x32_bf16 a[96:99], v[84:87], v[148:151], a[96:99]
    v_mfma_f32_16x16x32_bf16 a[100:103], v[84:87], v[152:155], a[100:103]
    v_mfma_f32_16x16x32_bf16 a[104:107], v[84:87], v[156:159], a[104:107]
    v_mfma_f32_16x16x32_bf16 a[108:111], v[84:87], v[160:163], a[108:111]
    v_mfma_f32_16x16x32_bf16 a[112:115], v[88:91], v[148:151], a[112:115]
    v_mfma_f32_16x16x32_bf16 a[116:119], v[88:91], v[152:155], a[116:119]
    v_mfma_f32_16x16x32_bf16 a[120:123], v[88:91], v[156:159], a[120:123]
    v_mfma_f32_16x16x32_bf16 a[124:127], v[88:91], v[160:163], a[124:127]
    v_mfma_f32_16x16x32_bf16 a[128:131], v[92:95], v[148:151], a[128:131]
    v_mfma_f32_16x16x32_bf16 a[132:135], v[92:95], v[152:155], a[132:135]
    v_mfma_f32_16x16x32_bf16 a[136:139], v[92:95], v[156:159], a[136:139]
    v_mfma_f32_16x16x32_bf16 a[140:143], v[92:95], v[160:163], a[140:143]
    global_load_dwordx4 v[60:63], v164, s[18:19] offset:2048
    global_load_dwordx4 v[64:67], v165, s[18:19] offset:2048
    global_load_dwordx4 v[68:71], v166, s[18:19] offset:2048
    global_load_dwordx4 v[72:75], v167, s[18:19] offset:2048
    global_load_dwordx4 v[76:79], v168, s[18:19] offset:2048
    global_load_dwordx4 v[80:83], v169, s[18:19] offset:2048
    global_load_dwordx4 v[84:87], v170, s[18:19] offset:2048
    global_load_dwordx4 v[88:91], v171, s[18:19] offset:2048
    global_load_dwordx4 v[92:95], v172, s[18:19] offset:2048
    ds_read_b128 v[148:151], v23 offset:576
    ds_read_b128 v[152:155], v23 offset:19264
    ds_read_b128 v[156:159], v23 offset:37952
    ds_read_b128 v[160:163], v23 offset:56640
    s_waitcnt vmcnt(18) lgkmcnt(4)
    v_mfma_f32_16x16x32_bf16 a[0:3], v[96:99], v[132:135], a[0:3]
    v_mfma_f32_16x16x32_bf16 a[4:7], v[96:99], v[136:139], a[4:7]
    v_mfma_f32_16x16x32_bf16 a[8:11], v[96:99], v[140:143], a[8:11]
    v_mfma_f32_16x16x32_bf16 a[12:15], v[96:99], v[144:147], a[12:15]
    v_mfma_f32_16x16x32_bf16 a[16:19], v[100:103], v[132:135], a[16:19]
    v_mfma_f32_16x16x32_bf16 a[20:23], v[100:103], v[136:139], a[20:23]
    v_mfma_f32_16x16x32_bf16 a[24:27], v[100:103], v[140:143], a[24:27]
    v_mfma_f32_16x16x32_bf16 a[28:31], v[100:103], v[144:147], a[28:31]
    v_mfma_f32_16x16x32_bf16 a[32:35], v[104:107], v[132:135], a[32:35]
    v_mfma_f32_16x16x32_bf16 a[36:39], v[104:107], v[136:139], a[36:39]
    v_mfma_f32_16x16x32_bf16 a[40:43], v[104:107], v[140:143], a[40:43]
    v_mfma_f32_16x16x32_bf16 a[44:47], v[104:107], v[144:147], a[44:47]
    v_mfma_f32_16x16x32_bf16 a[48:51], v[108:111], v[132:135], a[48:51]
    v_mfma_f32_16x16x32_bf16 a[52:55], v[108:111], v[136:139], a[52:55]
    v_mfma_f32_16x16x32_bf16 a[56:59], v[108:111], v[140:143], a[56:59]
    v_mfma_f32_16x16x32_bf16 a[60:63], v[108:111], v[144:147], a[60:63]
    v_mfma_f32_16x16x32_bf16 a[64:67], v[112:115], v[132:135], a[64:67]
    v_mfma_f32_16x16x32_bf16 a[68:71], v[112:115], v[136:139], a[68:71]
    v_mfma_f32_16x16x32_bf16 a[72:75], v[112:115], v[140:143], a[72:75]
    v_mfma_f32_16x16x32_bf16 a[76:79], v[112:115], v[144:147], a[76:79]
    v_mfma_f32_16x16x32_bf16 a[80:83], v[116:119], v[132:135], a[80:83]
    v_mfma_f32_16x16x32_bf16 a[84:87], v[116:119], v[136:139], a[84:87]
    v_mfma_f32_16x16x32_bf16 a[88:91], v[116:119], v[140:143], a[88:91]
    v_mfma_f32_16x16x32_bf16 a[92:95], v[116:119], v[144:147], a[92:95]
    v_mfma_f32_16x16x32_bf16 a[96:99], v[120:123], v[132:135], a[96:99]
    v_mfma_f32_16x16x32_bf16 a[100:103], v[120:123], v[136:139], a[100:103]
    v_mfma_f32_16x16x32_bf16 a[104:107], v[120:123], v[140:143], a[104:107]
    v_mfma_f32_16x16x32_bf16 a[108:111], v[120:123], v[144:147], a[108:111]
    v_mfma_f32_16x16x32_bf16 a[112:115], v[124:127], v[132:135], a[112:115]
    v_mfma_f32_16x16x32_bf16 a[116:119], v[124:127], v[136:139], a[116:119]
    v_mfma_f32_16x16x32_bf16 a[120:123], v[124:127], v[140:143], a[120:123]
    v_mfma_f32_16x16x32_bf16 a[124:127], v[124:127], v[144:147], a[124:127]
    v_mfma_f32_16x16x32_bf16 a[128:131], v[128:131], v[132:135], a[128:131]
    v_mfma_f32_16x16x32_bf16 a[132:135], v[128:131], v[136:139], a[132:135]
    v_mfma_f32_16x16x32_bf16 a[136:139], v[128:131], v[140:143], a[136:139]
    v_mfma_f32_16x16x32_bf16 a[140:143], v[128:131], v[144:147], a[140:143]
    global_load_dwordx4 v[96:99], v164, s[18:19] offset:3072
    global_load_dwordx4 v[100:103], v165, s[18:19] offset:3072
    global_load_dwordx4 v[104:107], v166, s[18:19] offset:3072
    global_load_dwordx4 v[108:111], v167, s[18:19] offset:3072
    global_load_dwordx4 v[112:115], v168, s[18:19] offset:3072
    global_load_dwordx4 v[116:119], v169, s[18:19] offset:3072
    global_load_dwordx4 v[120:123], v170, s[18:19] offset:3072
    global_load_dwordx4 v[124:127], v171, s[18:19] offset:3072
    global_load_dwordx4 v[128:131], v172, s[18:19] offset:3072
    v_add_u32 v164, 4096, v164
    v_add_u32 v165, 4096, v165
    v_add_u32 v166, 4096, v166
    v_add_u32 v167, 4096, v167
    v_add_u32 v168, 4096, v168
    v_add_u32 v169, 4096, v169
    v_add_u32 v170, 4096, v170
    v_add_u32 v171, 4096, v171
    v_add_u32 v172, 4096, v172
    ds_read_b128 v[132:135], v23 offset:640
    ds_read_b128 v[136:139], v23 offset:19328
    ds_read_b128 v[140:143], v23 offset:38016
    ds_read_b128 v[144:147], v23 offset:56704
    s_waitcnt vmcnt(18) lgkmcnt(4)
    v_mfma_f32_16x16x32_bf16 a[0:3], v[24:27], v[148:151], a[0:3]
    v_mfma_f32_16x16x32_bf16 a[4:7], v[24:27], v[152:155], a[4:7]
    v_mfma_f32_16x16x32_bf16 a[8:11], v[24:27], v[156:159], a[8:11]
    v_mfma_f32_16x16x32_bf16 a[12:15], v[24:27], v[160:163], a[12:15]
    v_mfma_f32_16x16x32_bf16 a[16:19], v[28:31], v[148:151], a[16:19]
    v_mfma_f32_16x16x32_bf16 a[20:23], v[28:31], v[152:155], a[20:23]
    v_mfma_f32_16x16x32_bf16 a[24:27], v[28:31], v[156:159], a[24:27]
    v_mfma_f32_16x16x32_bf16 a[28:31], v[28:31], v[160:163], a[28:31]
    v_mfma_f32_16x16x32_bf16 a[32:35], v[32:35], v[148:151], a[32:35]
    v_mfma_f32_16x16x32_bf16 a[36:39], v[32:35], v[152:155], a[36:39]
    v_mfma_f32_16x16x32_bf16 a[40:43], v[32:35], v[156:159], a[40:43]
    v_mfma_f32_16x16x32_bf16 a[44:47], v[32:35], v[160:163], a[44:47]
    v_mfma_f32_16x16x32_bf16 a[48:51], v[36:39], v[148:151], a[48:51]
    v_mfma_f32_16x16x32_bf16 a[52:55], v[36:39], v[152:155], a[52:55]
    v_mfma_f32_16x16x32_bf16 a[56:59], v[36:39], v[156:159], a[56:59]
    v_mfma_f32_16x16x32_bf16 a[60:63], v[36:39], v[160:163], a[60:63]
    v_mfma_f32_16x16x32_bf16 a[64:67], v[40:43], v[148:151], a[64:67]
    v_mfma_f32_16x16x32_bf16 a[68:71], v[40:43], v[152:155], a[68:71]
    v_mfma_f32_16x16x32_bf16 a[72:75], v[40:43], v[156:159], a[72:75]
    v_mfma_f32_16x16x32_bf16 a[76:79], v[40:43], v[160:163], a[76:79]
    v_mfma_f32_16x16x32_bf16 a[80:83], v[44:47], v[148:151], a[80:83]
    v_mfma_f32_16x16x32_bf16 a[84:87], v[44:47], v[152:155], a[84:87]
    v_mfma_f32_16x16x32_bf16 a[88:91], v[44:47], v[156:159], a[88:91]
    v_mfma_f32_16x16x32_bf16 a[92:95], v[44:47], v[160:163], a[92:95]
    v_mfma_f32_16x16x32_bf16 a[96:99], v[48:51], v[148:151], a[96:99]
    v_mfma_f32_16x16x32_bf16 a[100:103], v[48:51], v[152:155], a[100:103]
    v_mfma_f32_16x16x32_bf16 a[104:107], v[48:51], v[156:159], a[104:107]
    v_mfma_f32_16x16x32_bf16 a[108:111], v[48:51], v[160:163], a[108:111]
    v_mfma_f32_16x16x32_bf16 a[112:115], v[52:55], v[148:151], a[112:115]
    v_mfma_f32_16x16x32_bf16 a[116:119], v[52:55], v[152:155], a[116:119]
    v_mfma_f32_16x16x32_bf16 a[120:123], v[52:55], v[156:159], a[120:123]
    v_mfma_f32_16x16x32_bf16 a[124:127], v[52:55], v[160:163], a[124:127]
    v_mfma_f32_16x16x32_bf16 a[128:131], v[56:59], v[148:151], a[128:131]
    v_mfma_f32_16x16x32_bf16 a[132:135], v[56:59], v[152:155], a[132:135]
    v_mfma_f32_16x16x32_bf16 a[136:139], v[56:59], v[156:159], a[136:139]
    v_mfma_f32_16x16x32_bf16 a[140:143], v[56:59], v[160:163], a[140:143]
    global_load_dwordx4 v[24:27], v164, s[18:19] offset:0
    global_load_dwordx4 v[28:31], v165, s[18:19] offset:0
    global_load_dwordx4 v[32:35], v166, s[18:19] offset:0
    global_load_dwordx4 v[36:39], v167, s[18:19] offset:0
    global_load_dwordx4 v[40:43], v168, s[18:19] offset:0
    global_load_dwordx4 v[44:47], v169, s[18:19] offset:0
    global_load_dwordx4 v[48:51], v170, s[18:19] offset:0
    global_load_dwordx4 v[52:55], v171, s[18:19] offset:0
    global_load_dwordx4 v[56:59], v172, s[18:19] offset:0
    ds_read_b128 v[148:151], v23 offset:704
    ds_read_b128 v[152:155], v23 offset:19392
    ds_read_b128 v[156:159], v23 offset:38080
    ds_read_b128 v[160:163], v23 offset:56768
    s_waitcnt vmcnt(18) lgkmcnt(4)
    v_mfma_f32_16x16x32_bf16 a[0:3], v[60:63], v[132:135], a[0:3]
    v_mfma_f32_16x16x32_bf16 a[4:7], v[60:63], v[136:139], a[4:7]
    v_mfma_f32_16x16x32_bf16 a[8:11], v[60:63], v[140:143], a[8:11]
    v_mfma_f32_16x16x32_bf16 a[12:15], v[60:63], v[144:147], a[12:15]
    v_mfma_f32_16x16x32_bf16 a[16:19], v[64:67], v[132:135], a[16:19]
    v_mfma_f32_16x16x32_bf16 a[20:23], v[64:67], v[136:139], a[20:23]
    v_mfma_f32_16x16x32_bf16 a[24:27], v[64:67], v[140:143], a[24:27]
    v_mfma_f32_16x16x32_bf16 a[28:31], v[64:67], v[144:147], a[28:31]
    v_mfma_f32_16x16x32_bf16 a[32:35], v[68:71], v[132:135], a[32:35]
    v_mfma_f32_16x16x32_bf16 a[36:39], v[68:71], v[136:139], a[36:39]
    v_mfma_f32_16x16x32_bf16 a[40:43], v[68:71], v[140:143], a[40:43]
    v_mfma_f32_16x16x32_bf16 a[44:47], v[68:71], v[144:147], a[44:47]
    v_mfma_f32_16x16x32_bf16 a[48:51], v[72:75], v[132:135], a[48:51]
    v_mfma_f32_16x16x32_bf16 a[52:55], v[72:75], v[136:139], a[52:55]
    v_mfma_f32_16x16x32_bf16 a[56:59], v[72:75], v[140:143], a[56:59]
    v_mfma_f32_16x16x32_bf16 a[60:63], v[72:75], v[144:147], a[60:63]
    v_mfma_f32_16x16x32_bf16 a[64:67], v[76:79], v[132:135], a[64:67]
    v_mfma_f32_16x16x32_bf16 a[68:71], v[76:79], v[136:139], a[68:71]
    v_mfma_f32_16x16x32_bf16 a[72:75], v[76:79], v[140:143], a[72:75]
    v_mfma_f32_16x16x32_bf16 a[76:79], v[76:79], v[144:147], a[76:79]
    v_mfma_f32_16x16x32_bf16 a[80:83], v[80:83], v[132:135], a[80:83]
    v_mfma_f32_16x16x32_bf16 a[84:87], v[80:83], v[136:139], a[84:87]
    v_mfma_f32_16x16x32_bf16 a[88:91], v[80:83], v[140:143], a[88:91]
    v_mfma_f32_16x16x32_bf16 a[92:95], v[80:83], v[144:147], a[92:95]
    v_mfma_f32_16x16x32_bf16 a[96:99], v[84:87], v[132:135], a[96:99]
    v_mfma_f32_16x16x32_bf16 a[100:103], v[84:87], v[136:139], a[100:103]
    v_mfma_f32_16x16x32_bf16 a[104:107], v[84:87], v[140:143], a[104:107]
    v_mfma_f32_16x16x32_bf16 a[108:111], v[84:87], v[144:147], a[108:111]
    v_mfma_f32_16x16x32_bf16 a[112:115], v[88:91], v[132:135], a[112:115]
    v_mfma_f32_16x16x32_bf16 a[116:119], v[88:91], v[136:139], a[116:119]
    v_mfma_f32_16x16x32_bf16 a[120:123], v[88:91], v[140:143], a[120:123]
    v_mfma_f32_16x16x32_bf16 a[124:127], v[88:91], v[144:147], a[124:127]
    v_mfma_f32_16x16x32_bf16 a[128:131], v[92:95], v[132:135], a[128:131]
    v_mfma_f32_16x16x32_bf16 a[132:135], v[92:95], v[136:139], a[132:135]
    v_mfma_f32_16x16x32_bf16 a[136:139], v[92:95], v[140:143], a[136:139]
    v_mfma_f32_16x16x32_bf16 a[140:143], v[92:95], v[144:147], a[140:143]
    global_load_dwordx4 v[60:63], v164, s[18:19] offset:1024
    global_load_dwordx4 v[64:67], v165, s[18:19] offset:1024
    global_load_dwordx4 v[68:71], v166, s[18:19] offset:1024
    global_load_dwordx4 v[72:75], v167, s[18:19] offset:1024
    global_load_dwordx4 v[76:79], v168, s[18:19] offset:1024
    global_load_dwordx4 v[80:83], v169, s[18:19] offset:1024
    global_load_dwordx4 v[84:87], v170, s[18:19] offset:1024
    global_load_dwordx4 v[88:91], v171, s[18:19] offset:1024
    global_load_dwordx4 v[92:95], v172, s[18:19] offset:1024
    ds_read_b128 v[132:135], v23 offset:768
    ds_read_b128 v[136:139], v23 offset:19456
    ds_read_b128 v[140:143], v23 offset:38144
    ds_read_b128 v[144:147], v23 offset:56832
    s_waitcnt vmcnt(18) lgkmcnt(4)
    v_mfma_f32_16x16x32_bf16 a[0:3], v[96:99], v[148:151], a[0:3]
    v_mfma_f32_16x16x32_bf16 a[4:7], v[96:99], v[152:155], a[4:7]
    v_mfma_f32_16x16x32_bf16 a[8:11], v[96:99], v[156:159], a[8:11]
    v_mfma_f32_16x16x32_bf16 a[12:15], v[96:99], v[160:163], a[12:15]
    v_mfma_f32_16x16x32_bf16 a[16:19], v[100:103], v[148:151], a[16:19]
    v_mfma_f32_16x16x32_bf16 a[20:23], v[100:103], v[152:155], a[20:23]
    v_mfma_f32_16x16x32_bf16 a[24:27], v[100:103], v[156:159], a[24:27]
    v_mfma_f32_16x16x32_bf16 a[28:31], v[100:103], v[160:163], a[28:31]
    v_mfma_f32_16x16x32_bf16 a[32:35], v[104:107], v[148:151], a[32:35]
    v_mfma_f32_16x16x32_bf16 a[36:39], v[104:107], v[152:155], a[36:39]
    v_mfma_f32_16x16x32_bf16 a[40:43], v[104:107], v[156:159], a[40:43]
    v_mfma_f32_16x16x32_bf16 a[44:47], v[104:107], v[160:163], a[44:47]
    v_mfma_f32_16x16x32_bf16 a[48:51], v[108:111], v[148:151], a[48:51]
    v_mfma_f32_16x16x32_bf16 a[52:55], v[108:111], v[152:155], a[52:55]
    v_mfma_f32_16x16x32_bf16 a[56:59], v[108:111], v[156:159], a[56:59]
    v_mfma_f32_16x16x32_bf16 a[60:63], v[108:111], v[160:163], a[60:63]
    v_mfma_f32_16x16x32_bf16 a[64:67], v[112:115], v[148:151], a[64:67]
    v_mfma_f32_16x16x32_bf16 a[68:71], v[112:115], v[152:155], a[68:71]
    v_mfma_f32_16x16x32_bf16 a[72:75], v[112:115], v[156:159], a[72:75]
    v_mfma_f32_16x16x32_bf16 a[76:79], v[112:115], v[160:163], a[76:79]
    v_mfma_f32_16x16x32_bf16 a[80:83], v[116:119], v[148:151], a[80:83]
    v_mfma_f32_16x16x32_bf16 a[84:87], v[116:119], v[152:155], a[84:87]
    v_mfma_f32_16x16x32_bf16 a[88:91], v[116:119], v[156:159], a[88:91]
    v_mfma_f32_16x16x32_bf16 a[92:95], v[116:119], v[160:163], a[92:95]
    v_mfma_f32_16x16x32_bf16 a[96:99], v[120:123], v[148:151], a[96:99]
    v_mfma_f32_16x16x32_bf16 a[100:103], v[120:123], v[152:155], a[100:103]
    v_mfma_f32_16x16x32_bf16 a[104:107], v[120:123], v[156:159], a[104:107]
    v_mfma_f32_16x16x32_bf16 a[108:111], v[120:123], v[160:163], a[108:111]
    v_mfma_f32_16x16x32_bf16 a[112:115], v[124:127], v[148:151], a[112:115]
    v_mfma_f32_16x16x32_bf16 a[116:119], v[124:127], v[152:155], a[116:119]
    v_mfma_f32_16x16x32_bf16 a[120:123], v[124:127], v[156:159], a[120:123]
    v_mfma_f32_16x16x32_bf16 a[124:127], v[124:127], v[160:163], a[124:127]
    v_mfma_f32_16x16x32_bf16 a[128:131], v[128:131], v[148:151], a[128:131]
    v_mfma_f32_16x16x32_bf16 a[132:135], v[128:131], v[152:155], a[132:135]
    v_mfma_f32_16x16x32_bf16 a[136:139], v[128:131], v[156:159], a[136:139]
    v_mfma_f32_16x16x32_bf16 a[140:143], v[128:131], v[160:163], a[140:143]
    global_load_dwordx4 v[96:99], v164, s[18:19] offset:2048
    global_load_dwordx4 v[100:103], v165, s[18:19] offset:2048
    global_load_dwordx4 v[104:107], v166, s[18:19] offset:2048
    global_load_dwordx4 v[108:111], v167, s[18:19] offset:2048
    global_load_dwordx4 v[112:115], v168, s[18:19] offset:2048
    global_load_dwordx4 v[116:119], v169, s[18:19] offset:2048
    global_load_dwordx4 v[120:123], v170, s[18:19] offset:2048
    global_load_dwordx4 v[124:127], v171, s[18:19] offset:2048
    global_load_dwordx4 v[128:131], v172, s[18:19] offset:2048
    ds_read_b128 v[148:151], v23 offset:832
    ds_read_b128 v[152:155], v23 offset:19520
    ds_read_b128 v[156:159], v23 offset:38208
    ds_read_b128 v[160:163], v23 offset:56896
    s_waitcnt vmcnt(18) lgkmcnt(4)
    v_mfma_f32_16x16x32_bf16 a[0:3], v[24:27], v[132:135], a[0:3]
    v_mfma_f32_16x16x32_bf16 a[4:7], v[24:27], v[136:139], a[4:7]
    v_mfma_f32_16x16x32_bf16 a[8:11], v[24:27], v[140:143], a[8:11]
    v_mfma_f32_16x16x32_bf16 a[12:15], v[24:27], v[144:147], a[12:15]
    v_mfma_f32_16x16x32_bf16 a[16:19], v[28:31], v[132:135], a[16:19]
    v_mfma_f32_16x16x32_bf16 a[20:23], v[28:31], v[136:139], a[20:23]
    v_mfma_f32_16x16x32_bf16 a[24:27], v[28:31], v[140:143], a[24:27]
    v_mfma_f32_16x16x32_bf16 a[28:31], v[28:31], v[144:147], a[28:31]
    v_mfma_f32_16x16x32_bf16 a[32:35], v[32:35], v[132:135], a[32:35]
    v_mfma_f32_16x16x32_bf16 a[36:39], v[32:35], v[136:139], a[36:39]
    v_mfma_f32_16x16x32_bf16 a[40:43], v[32:35], v[140:143], a[40:43]
    v_mfma_f32_16x16x32_bf16 a[44:47], v[32:35], v[144:147], a[44:47]
    v_mfma_f32_16x16x32_bf16 a[48:51], v[36:39], v[132:135], a[48:51]
    v_mfma_f32_16x16x32_bf16 a[52:55], v[36:39], v[136:139], a[52:55]
    v_mfma_f32_16x16x32_bf16 a[56:59], v[36:39], v[140:143], a[56:59]
    v_mfma_f32_16x16x32_bf16 a[60:63], v[36:39], v[144:147], a[60:63]
    v_mfma_f32_16x16x32_bf16 a[64:67], v[40:43], v[132:135], a[64:67]
    v_mfma_f32_16x16x32_bf16 a[68:71], v[40:43], v[136:139], a[68:71]
    v_mfma_f32_16x16x32_bf16 a[72:75], v[40:43], v[140:143], a[72:75]
    v_mfma_f32_16x16x32_bf16 a[76:79], v[40:43], v[144:147], a[76:79]
    v_mfma_f32_16x16x32_bf16 a[80:83], v[44:47], v[132:135], a[80:83]
    v_mfma_f32_16x16x32_bf16 a[84:87], v[44:47], v[136:139], a[84:87]
    v_mfma_f32_16x16x32_bf16 a[88:91], v[44:47], v[140:143], a[88:91]
    v_mfma_f32_16x16x32_bf16 a[92:95], v[44:47], v[144:147], a[92:95]
    v_mfma_f32_16x16x32_bf16 a[96:99], v[48:51], v[132:135], a[96:99]
    v_mfma_f32_16x16x32_bf16 a[100:103], v[48:51], v[136:139], a[100:103]
    v_mfma_f32_16x16x32_bf16 a[104:107], v[48:51], v[140:143], a[104:107]
    v_mfma_f32_16x16x32_bf16 a[108:111], v[48:51], v[144:147], a[108:111]
    v_mfma_f32_16x16x32_bf16 a[112:115], v[52:55], v[132:135], a[112:115]
    v_mfma_f32_16x16x32_bf16 a[116:119], v[52:55], v[136:139], a[116:119]
    v_mfma_f32_16x16x32_bf16 a[120:123], v[52:55], v[140:143], a[120:123]
    v_mfma_f32_16x16x32_bf16 a[124:127], v[52:55], v[144:147], a[124:127]
    v_mfma_f32_16x16x32_bf16 a[128:131], v[56:59], v[132:135], a[128:131]
    v_mfma_f32_16x16x32_bf16 a[132:135], v[56:59], v[136:139], a[132:135]
    v_mfma_f32_16x16x32_bf16 a[136:139], v[56:59], v[140:143], a[136:139]
    v_mfma_f32_16x16x32_bf16 a[140:143], v[56:59], v[144:147], a[140:143]
    global_load_dwordx4 v[24:27], v164, s[18:19] offset:3072
    global_load_dwordx4 v[28:31], v165, s[18:19] offset:3072
    global_load_dwordx4 v[32:35], v166, s[18:19] offset:3072
    global_load_dwordx4 v[36:39], v167, s[18:19] offset:3072
    global_load_dwordx4 v[40:43], v168, s[18:19] offset:3072
    global_load_dwordx4 v[44:47], v169, s[18:19] offset:3072
    global_load_dwordx4 v[48:51], v170, s[18:19] offset:3072
    global_load_dwordx4 v[52:55], v171, s[18:19] offset:3072
    global_load_dwordx4 v[56:59], v172, s[18:19] offset:3072
    v_add_u32 v164, 4096, v164
    v_add_u32 v165, 4096, v165
    v_add_u32 v166, 4096, v166
    v_add_u32 v167, 4096, v167
    v_add_u32 v168, 4096, v168
    v_add_u32 v169, 4096, v169
    v_add_u32 v170, 4096, v170
    v_add_u32 v171, 4096, v171
    v_add_u32 v172, 4096, v172
    ds_read_b128 v[132:135], v23 offset:896
    ds_read_b128 v[136:139], v23 offset:19584
    ds_read_b128 v[140:143], v23 offset:38272
    ds_read_b128 v[144:147], v23 offset:56960
    s_waitcnt vmcnt(18) lgkmcnt(4)
    v_mfma_f32_16x16x32_bf16 a[0:3], v[60:63], v[148:151], a[0:3]
    v_mfma_f32_16x16x32_bf16 a[4:7], v[60:63], v[152:155], a[4:7]
    v_mfma_f32_16x16x32_bf16 a[8:11], v[60:63], v[156:159], a[8:11]
    v_mfma_f32_16x16x32_bf16 a[12:15], v[60:63], v[160:163], a[12:15]
    v_mfma_f32_16x16x32_bf16 a[16:19], v[64:67], v[148:151], a[16:19]
    v_mfma_f32_16x16x32_bf16 a[20:23], v[64:67], v[152:155], a[20:23]
    v_mfma_f32_16x16x32_bf16 a[24:27], v[64:67], v[156:159], a[24:27]
    v_mfma_f32_16x16x32_bf16 a[28:31], v[64:67], v[160:163], a[28:31]
    v_mfma_f32_16x16x32_bf16 a[32:35], v[68:71], v[148:151], a[32:35]
    v_mfma_f32_16x16x32_bf16 a[36:39], v[68:71], v[152:155], a[36:39]
    v_mfma_f32_16x16x32_bf16 a[40:43], v[68:71], v[156:159], a[40:43]
    v_mfma_f32_16x16x32_bf16 a[44:47], v[68:71], v[160:163], a[44:47]
    v_mfma_f32_16x16x32_bf16 a[48:51], v[72:75], v[148:151], a[48:51]
    v_mfma_f32_16x16x32_bf16 a[52:55], v[72:75], v[152:155], a[52:55]
    v_mfma_f32_16x16x32_bf16 a[56:59], v[72:75], v[156:159], a[56:59]
    v_mfma_f32_16x16x32_bf16 a[60:63], v[72:75], v[160:163], a[60:63]
    v_mfma_f32_16x16x32_bf16 a[64:67], v[76:79], v[148:151], a[64:67]
    v_mfma_f32_16x16x32_bf16 a[68:71], v[76:79], v[152:155], a[68:71]
    v_mfma_f32_16x16x32_bf16 a[72:75], v[76:79], v[156:159], a[72:75]
    v_mfma_f32_16x16x32_bf16 a[76:79], v[76:79], v[160:163], a[76:79]
    v_mfma_f32_16x16x32_bf16 a[80:83], v[80:83], v[148:151], a[80:83]
    v_mfma_f32_16x16x32_bf16 a[84:87], v[80:83], v[152:155], a[84:87]
    v_mfma_f32_16x16x32_bf16 a[88:91], v[80:83], v[156:159], a[88:91]
    v_mfma_f32_16x16x32_bf16 a[92:95], v[80:83], v[160:163], a[92:95]
    v_mfma_f32_16x16x32_bf16 a[96:99], v[84:87], v[148:151], a[96:99]
    v_mfma_f32_16x16x32_bf16 a[100:103], v[84:87], v[152:155], a[100:103]
    v_mfma_f32_16x16x32_bf16 a[104:107], v[84:87], v[156:159], a[104:107]
    v_mfma_f32_16x16x32_bf16 a[108:111], v[84:87], v[160:163], a[108:111]
    v_mfma_f32_16x16x32_bf16 a[112:115], v[88:91], v[148:151], a[112:115]
    v_mfma_f32_16x16x32_bf16 a[116:119], v[88:91], v[152:155], a[116:119]
    v_mfma_f32_16x16x32_bf16 a[120:123], v[88:91], v[156:159], a[120:123]
    v_mfma_f32_16x16x32_bf16 a[124:127], v[88:91], v[160:163], a[124:127]
    v_mfma_f32_16x16x32_bf16 a[128:131], v[92:95], v[148:151], a[128:131]
    v_mfma_f32_16x16x32_bf16 a[132:135], v[92:95], v[152:155], a[132:135]
    v_mfma_f32_16x16x32_bf16 a[136:139], v[92:95], v[156:159], a[136:139]
    v_mfma_f32_16x16x32_bf16 a[140:143], v[92:95], v[160:163], a[140:143]
    global_load_dwordx4 v[60:63], v164, s[18:19] offset:0
    global_load_dwordx4 v[64:67], v165, s[18:19] offset:0
    global_load_dwordx4 v[68:71], v166, s[18:19] offset:0
    global_load_dwordx4 v[72:75], v167, s[18:19] offset:0
    global_load_dwordx4 v[76:79], v168, s[18:19] offset:0
    global_load_dwordx4 v[80:83], v169, s[18:19] offset:0
    global_load_dwordx4 v[84:87], v170, s[18:19] offset:0
    global_load_dwordx4 v[88:91], v171, s[18:19] offset:0
    global_load_dwordx4 v[92:95], v172, s[18:19] offset:0
    ds_read_b128 v[148:151], v23 offset:960
    ds_read_b128 v[152:155], v23 offset:19648
    ds_read_b128 v[156:159], v23 offset:38336
    ds_read_b128 v[160:163], v23 offset:57024
    s_waitcnt vmcnt(18) lgkmcnt(4)
    v_mfma_f32_16x16x32_bf16 a[0:3], v[96:99], v[132:135], a[0:3]
    v_mfma_f32_16x16x32_bf16 a[4:7], v[96:99], v[136:139], a[4:7]
    v_mfma_f32_16x16x32_bf16 a[8:11], v[96:99], v[140:143], a[8:11]
    v_mfma_f32_16x16x32_bf16 a[12:15], v[96:99], v[144:147], a[12:15]
    v_mfma_f32_16x16x32_bf16 a[16:19], v[100:103], v[132:135], a[16:19]
    v_mfma_f32_16x16x32_bf16 a[20:23], v[100:103], v[136:139], a[20:23]
    v_mfma_f32_16x16x32_bf16 a[24:27], v[100:103], v[140:143], a[24:27]
    v_mfma_f32_16x16x32_bf16 a[28:31], v[100:103], v[144:147], a[28:31]
    v_mfma_f32_16x16x32_bf16 a[32:35], v[104:107], v[132:135], a[32:35]
    v_mfma_f32_16x16x32_bf16 a[36:39], v[104:107], v[136:139], a[36:39]
    v_mfma_f32_16x16x32_bf16 a[40:43], v[104:107], v[140:143], a[40:43]
    v_mfma_f32_16x16x32_bf16 a[44:47], v[104:107], v[144:147], a[44:47]
    v_mfma_f32_16x16x32_bf16 a[48:51], v[108:111], v[132:135], a[48:51]
    v_mfma_f32_16x16x32_bf16 a[52:55], v[108:111], v[136:139], a[52:55]
    v_mfma_f32_16x16x32_bf16 a[56:59], v[108:111], v[140:143], a[56:59]
    v_mfma_f32_16x16x32_bf16 a[60:63], v[108:111], v[144:147], a[60:63]
    v_mfma_f32_16x16x32_bf16 a[64:67], v[112:115], v[132:135], a[64:67]
    v_mfma_f32_16x16x32_bf16 a[68:71], v[112:115], v[136:139], a[68:71]
    v_mfma_f32_16x16x32_bf16 a[72:75], v[112:115], v[140:143], a[72:75]
    v_mfma_f32_16x16x32_bf16 a[76:79], v[112:115], v[144:147], a[76:79]
    v_mfma_f32_16x16x32_bf16 a[80:83], v[116:119], v[132:135], a[80:83]
    v_mfma_f32_16x16x32_bf16 a[84:87], v[116:119], v[136:139], a[84:87]
    v_mfma_f32_16x16x32_bf16 a[88:91], v[116:119], v[140:143], a[88:91]
    v_mfma_f32_16x16x32_bf16 a[92:95], v[116:119], v[144:147], a[92:95]
    v_mfma_f32_16x16x32_bf16 a[96:99], v[120:123], v[132:135], a[96:99]
    v_mfma_f32_16x16x32_bf16 a[100:103], v[120:123], v[136:139], a[100:103]
    v_mfma_f32_16x16x32_bf16 a[104:107], v[120:123], v[140:143], a[104:107]
    v_mfma_f32_16x16x32_bf16 a[108:111], v[120:123], v[144:147], a[108:111]
    v_mfma_f32_16x16x32_bf16 a[112:115], v[124:127], v[132:135], a[112:115]
    v_mfma_f32_16x16x32_bf16 a[116:119], v[124:127], v[136:139], a[116:119]
    v_mfma_f32_16x16x32_bf16 a[120:123], v[124:127], v[140:143], a[120:123]
    v_mfma_f32_16x16x32_bf16 a[124:127], v[124:127], v[144:147], a[124:127]
    v_mfma_f32_16x16x32_bf16 a[128:131], v[128:131], v[132:135], a[128:131]
    v_mfma_f32_16x16x32_bf16 a[132:135], v[128:131], v[136:139], a[132:135]
    v_mfma_f32_16x16x32_bf16 a[136:139], v[128:131], v[140:143], a[136:139]
    v_mfma_f32_16x16x32_bf16 a[140:143], v[128:131], v[144:147], a[140:143]
    global_load_dwordx4 v[96:99], v164, s[18:19] offset:1024
    global_load_dwordx4 v[100:103], v165, s[18:19] offset:1024
    global_load_dwordx4 v[104:107], v166, s[18:19] offset:1024
    global_load_dwordx4 v[108:111], v167, s[18:19] offset:1024
    global_load_dwordx4 v[112:115], v168, s[18:19] offset:1024
    global_load_dwordx4 v[116:119], v169, s[18:19] offset:1024
    global_load_dwordx4 v[120:123], v170, s[18:19] offset:1024
    global_load_dwordx4 v[124:127], v171, s[18:19] offset:1024
    global_load_dwordx4 v[128:131], v172, s[18:19] offset:1024
    ds_read_b128 v[132:135], v23 offset:1024
    ds_read_b128 v[136:139], v23 offset:19712
    ds_read_b128 v[140:143], v23 offset:38400
    ds_read_b128 v[144:147], v23 offset:57088
    s_waitcnt vmcnt(18) lgkmcnt(4)
    v_mfma_f32_16x16x32_bf16 a[0:3], v[24:27], v[148:151], a[0:3]
    v_mfma_f32_16x16x32_bf16 a[4:7], v[24:27], v[152:155], a[4:7]
    v_mfma_f32_16x16x32_bf16 a[8:11], v[24:27], v[156:159], a[8:11]
    v_mfma_f32_16x16x32_bf16 a[12:15], v[24:27], v[160:163], a[12:15]
    v_mfma_f32_16x16x32_bf16 a[16:19], v[28:31], v[148:151], a[16:19]
    v_mfma_f32_16x16x32_bf16 a[20:23], v[28:31], v[152:155], a[20:23]
    v_mfma_f32_16x16x32_bf16 a[24:27], v[28:31], v[156:159], a[24:27]
    v_mfma_f32_16x16x32_bf16 a[28:31], v[28:31], v[160:163], a[28:31]
    v_mfma_f32_16x16x32_bf16 a[32:35], v[32:35], v[148:151], a[32:35]
    v_mfma_f32_16x16x32_bf16 a[36:39], v[32:35], v[152:155], a[36:39]
    v_mfma_f32_16x16x32_bf16 a[40:43], v[32:35], v[156:159], a[40:43]
    v_mfma_f32_16x16x32_bf16 a[44:47], v[32:35], v[160:163], a[44:47]
    v_mfma_f32_16x16x32_bf16 a[48:51], v[36:39], v[148:151], a[48:51]
    v_mfma_f32_16x16x32_bf16 a[52:55], v[36:39], v[152:155], a[52:55]
    v_mfma_f32_16x16x32_bf16 a[56:59], v[36:39], v[156:159], a[56:59]
    v_mfma_f32_16x16x32_bf16 a[60:63], v[36:39], v[160:163], a[60:63]
    v_mfma_f32_16x16x32_bf16 a[64:67], v[40:43], v[148:151], a[64:67]
    v_mfma_f32_16x16x32_bf16 a[68:71], v[40:43], v[152:155], a[68:71]
    v_mfma_f32_16x16x32_bf16 a[72:75], v[40:43], v[156:159], a[72:75]
    v_mfma_f32_16x16x32_bf16 a[76:79], v[40:43], v[160:163], a[76:79]
    v_mfma_f32_16x16x32_bf16 a[80:83], v[44:47], v[148:151], a[80:83]
    v_mfma_f32_16x16x32_bf16 a[84:87], v[44:47], v[152:155], a[84:87]
    v_mfma_f32_16x16x32_bf16 a[88:91], v[44:47], v[156:159], a[88:91]
    v_mfma_f32_16x16x32_bf16 a[92:95], v[44:47], v[160:163], a[92:95]
    v_mfma_f32_16x16x32_bf16 a[96:99], v[48:51], v[148:151], a[96:99]
    v_mfma_f32_16x16x32_bf16 a[100:103], v[48:51], v[152:155], a[100:103]
    v_mfma_f32_16x16x32_bf16 a[104:107], v[48:51], v[156:159], a[104:107]
    v_mfma_f32_16x16x32_bf16 a[108:111], v[48:51], v[160:163], a[108:111]
    v_mfma_f32_16x16x32_bf16 a[112:115], v[52:55], v[148:151], a[112:115]
    v_mfma_f32_16x16x32_bf16 a[116:119], v[52:55], v[152:155], a[116:119]
    v_mfma_f32_16x16x32_bf16 a[120:123], v[52:55], v[156:159], a[120:123]
    v_mfma_f32_16x16x32_bf16 a[124:127], v[52:55], v[160:163], a[124:127]
    v_mfma_f32_16x16x32_bf16 a[128:131], v[56:59], v[148:151], a[128:131]
    v_mfma_f32_16x16x32_bf16 a[132:135], v[56:59], v[152:155], a[132:135]
    v_mfma_f32_16x16x32_bf16 a[136:139], v[56:59], v[156:159], a[136:139]
    v_mfma_f32_16x16x32_bf16 a[140:143], v[56:59], v[160:163], a[140:143]
    ds_read_b128 v[148:151], v23 offset:1088
    ds_read_b128 v[152:155], v23 offset:19776
    ds_read_b128 v[156:159], v23 offset:38464
    ds_read_b128 v[160:163], v23 offset:57152
    s_waitcnt vmcnt(9) lgkmcnt(4)
    v_mfma_f32_16x16x32_bf16 a[0:3], v[60:63], v[132:135], a[0:3]
    v_mfma_f32_16x16x32_bf16 a[4:7], v[60:63], v[136:139], a[4:7]
    v_mfma_f32_16x16x32_bf16 a[8:11], v[60:63], v[140:143], a[8:11]
    v_mfma_f32_16x16x32_bf16 a[12:15], v[60:63], v[144:147], a[12:15]
    v_mfma_f32_16x16x32_bf16 a[16:19], v[64:67], v[132:135], a[16:19]
    v_mfma_f32_16x16x32_bf16 a[20:23], v[64:67], v[136:139], a[20:23]
    v_mfma_f32_16x16x32_bf16 a[24:27], v[64:67], v[140:143], a[24:27]
    v_mfma_f32_16x16x32_bf16 a[28:31], v[64:67], v[144:147], a[28:31]
    v_mfma_f32_16x16x32_bf16 a[32:35], v[68:71], v[132:135], a[32:35]
    v_mfma_f32_16x16x32_bf16 a[36:39], v[68:71], v[136:139], a[36:39]
    v_mfma_f32_16x16x32_bf16 a[40:43], v[68:71], v[140:143], a[40:43]
    v_mfma_f32_16x16x32_bf16 a[44:47], v[68:71], v[144:147], a[44:47]
    v_mfma_f32_16x16x32_bf16 a[48:51], v[72:75], v[132:135], a[48:51]
    v_mfma_f32_16x16x32_bf16 a[52:55], v[72:75], v[136:139], a[52:55]
    v_mfma_f32_16x16x32_bf16 a[56:59], v[72:75], v[140:143], a[56:59]
    v_mfma_f32_16x16x32_bf16 a[60:63], v[72:75], v[144:147], a[60:63]
    v_mfma_f32_16x16x32_bf16 a[64:67], v[76:79], v[132:135], a[64:67]
    v_mfma_f32_16x16x32_bf16 a[68:71], v[76:79], v[136:139], a[68:71]
    v_mfma_f32_16x16x32_bf16 a[72:75], v[76:79], v[140:143], a[72:75]
    v_mfma_f32_16x16x32_bf16 a[76:79], v[76:79], v[144:147], a[76:79]
    v_mfma_f32_16x16x32_bf16 a[80:83], v[80:83], v[132:135], a[80:83]
    v_mfma_f32_16x16x32_bf16 a[84:87], v[80:83], v[136:139], a[84:87]
    v_mfma_f32_16x16x32_bf16 a[88:91], v[80:83], v[140:143], a[88:91]
    v_mfma_f32_16x16x32_bf16 a[92:95], v[80:83], v[144:147], a[92:95]
    v_mfma_f32_16x16x32_bf16 a[96:99], v[84:87], v[132:135], a[96:99]
    v_mfma_f32_16x16x32_bf16 a[100:103], v[84:87], v[136:139], a[100:103]
    v_mfma_f32_16x16x32_bf16 a[104:107], v[84:87], v[140:143], a[104:107]
    v_mfma_f32_16x16x32_bf16 a[108:111], v[84:87], v[144:147], a[108:111]
    v_mfma_f32_16x16x32_bf16 a[112:115], v[88:91], v[132:135], a[112:115]
    v_mfma_f32_16x16x32_bf16 a[116:119], v[88:91], v[136:139], a[116:119]
    v_mfma_f32_16x16x32_bf16 a[120:123], v[88:91], v[140:143], a[120:123]
    v_mfma_f32_16x16x32_bf16 a[124:127], v[88:91], v[144:147], a[124:127]
    v_mfma_f32_16x16x32_bf16 a[128:131], v[92:95], v[132:135], a[128:131]
    v_mfma_f32_16x16x32_bf16 a[132:135], v[92:95], v[136:139], a[132:135]
    v_mfma_f32_16x16x32_bf16 a[136:139], v[92:95], v[140:143], a[136:139]
    v_mfma_f32_16x16x32_bf16 a[140:143], v[92:95], v[144:147], a[140:143]
    s_waitcnt vmcnt(0) lgkmcnt(0)
    v_mfma_f32_16x16x32_bf16 a[0:3], v[96:99], v[148:151], a[0:3]
    v_mfma_f32_16x16x32_bf16 a[4:7], v[96:99], v[152:155], a[4:7]
    v_mfma_f32_16x16x32_bf16 a[8:11], v[96:99], v[156:159], a[8:11]
    v_mfma_f32_16x16x32_bf16 a[12:15], v[96:99], v[160:163], a[12:15]
    v_mfma_f32_16x16x32_bf16 a[16:19], v[100:103], v[148:151], a[16:19]
    v_mfma_f32_16x16x32_bf16 a[20:23], v[100:103], v[152:155], a[20:23]
    v_mfma_f32_16x16x32_bf16 a[24:27], v[100:103], v[156:159], a[24:27]
    v_mfma_f32_16x16x32_bf16 a[28:31], v[100:103], v[160:163], a[28:31]
    v_mfma_f32_16x16x32_bf16 a[32:35], v[104:107], v[148:151], a[32:35]
    v_mfma_f32_16x16x32_bf16 a[36:39], v[104:107], v[152:155], a[36:39]
    v_mfma_f32_16x16x32_bf16 a[40:43], v[104:107], v[156:159], a[40:43]
    v_mfma_f32_16x16x32_bf16 a[44:47], v[104:107], v[160:163], a[44:47]
    v_mfma_f32_16x16x32_bf16 a[48:51], v[108:111], v[148:151], a[48:51]
    v_mfma_f32_16x16x32_bf16 a[52:55], v[108:111], v[152:155], a[52:55]
    v_mfma_f32_16x16x32_bf16 a[56:59], v[108:111], v[156:159], a[56:59]
    v_mfma_f32_16x16x32_bf16 a[60:63], v[108:111], v[160:163], a[60:63]
    v_mfma_f32_16x16x32_bf16 a[64:67], v[112:115], v[148:151], a[64:67]
    v_mfma_f32_16x16x32_bf16 a[68:71], v[112:115], v[152:155], a[68:71]
    v_mfma_f32_16x16x32_bf16 a[72:75], v[112:115], v[156:159], a[72:75]
    v_mfma_f32_16x16x32_bf16 a[76:79], v[112:115], v[160:163], a[76:79]
    v_mfma_f32_16x16x32_bf16 a[80:83], v[116:119], v[148:151], a[80:83]
    v_mfma_f32_16x16x32_bf16 a[84:87], v[116:119], v[152:155], a[84:87]
    v_mfma_f32_16x16x32_bf16 a[88:91], v[116:119], v[156:159], a[88:91]
    v_mfma_f32_16x16x32_bf16 a[92:95], v[116:119], v[160:163], a[92:95]
    v_mfma_f32_16x16x32_bf16 a[96:99], v[120:123], v[148:151], a[96:99]
    v_mfma_f32_16x16x32_bf16 a[100:103], v[120:123], v[152:155], a[100:103]
    v_mfma_f32_16x16x32_bf16 a[104:107], v[120:123], v[156:159], a[104:107]
    v_mfma_f32_16x16x32_bf16 a[108:111], v[120:123], v[160:163], a[108:111]
    v_mfma_f32_16x16x32_bf16 a[112:115], v[124:127], v[148:151], a[112:115]
    v_mfma_f32_16x16x32_bf16 a[116:119], v[124:127], v[152:155], a[116:119]
    v_mfma_f32_16x16x32_bf16 a[120:123], v[124:127], v[156:159], a[120:123]
    v_mfma_f32_16x16x32_bf16 a[124:127], v[124:127], v[160:163], a[124:127]
    v_mfma_f32_16x16x32_bf16 a[128:131], v[128:131], v[148:151], a[128:131]
    v_mfma_f32_16x16x32_bf16 a[132:135], v[128:131], v[152:155], a[132:135]
    v_mfma_f32_16x16x32_bf16 a[136:139], v[128:131], v[156:159], a[136:139]
    v_mfma_f32_16x16x32_bf16 a[140:143], v[128:131], v[160:163], a[140:143]
    s_nop 15
    v_add_u32 v20, s22, v16
    v_mul_u32_u24 v20, 2304, v20
    v_lshl_add_u32 v20, v17, 4, v20
    v_mul_u32_u24 v21, 576, v2
    v_add_u32 v20, v20, v21
    s_mul_i32 s24, s21, 4718592
    s_add_u32 s24, s24, 27148288
    v_add_u32 v20, s24, v20
    global_store_dwordx4 v20, a[0:3], s[18:19] offset:0
    global_store_dwordx4 v20, a[16:19], s[18:19] offset:64
    global_store_dwordx4 v20, a[32:35], s[18:19] offset:128
    global_store_dwordx4 v20, a[48:51], s[18:19] offset:192
    global_store_dwordx4 v20, a[64:67], s[18:19] offset:256
    global_store_dwordx4 v20, a[80:83], s[18:19] offset:320
    global_store_dwordx4 v20, a[96:99], s[18:19] offset:384
    global_store_dwordx4 v20, a[112:115], s[18:19] offset:448
    global_store_dwordx4 v20, a[128:131], s[18:19] offset:512
    v_add_u32 v20, 36864, v20
    global_store_dwordx4 v20, a[4:7], s[18:19] offset:0
    global_store_dwordx4 v20, a[20:23], s[18:19] offset:64
    global_store_dwordx4 v20, a[36:39], s[18:19] offset:128
    global_store_dwordx4 v20, a[52:55], s[18:19] offset:192
    global_store_dwordx4 v20, a[68:71], s[18:19] offset:256
    global_store_dwordx4 v20, a[84:87], s[18:19] offset:320
    global_store_dwordx4 v20, a[100:103], s[18:19] offset:384
    global_store_dwordx4 v20, a[116:119], s[18:19] offset:448
    global_store_dwordx4 v20, a[132:135], s[18:19] offset:512
    v_add_u32 v20, 36864, v20
    global_store_dwordx4 v20, a[8:11], s[18:19] offset:0
    global_store_dwordx4 v20, a[24:27], s[18:19] offset:64
    global_store_dwordx4 v20, a[40:43], s[18:19] offset:128
    global_store_dwordx4 v20, a[56:59], s[18:19] offset:192
    global_store_dwordx4 v20, a[72:75], s[18:19] offset:256
    global_store_dwordx4 v20, a[88:91], s[18:19] offset:320
    global_store_dwordx4 v20, a[104:107], s[18:19] offset:384
    global_store_dwordx4 v20, a[120:123], s[18:19] offset:448
    global_store_dwordx4 v20, a[136:139], s[18:19] offset:512
    v_add_u32 v20, 36864, v20
    global_store_dwordx4 v20, a[12:15], s[18:19] offset:0
    global_store_dwordx4 v20, a[28:31], s[18:19] offset:64
    global_store_dwordx4 v20, a[44:47], s[18:19] offset:128
    global_store_dwordx4 v20, a[60:63], s[18:19] offset:192
    global_store_dwordx4 v20, a[76:79], s[18:19] offset:256
    global_store_dwordx4 v20, a[92:95], s[18:19] offset:320
    global_store_dwordx4 v20, a[108:111], s[18:19] offset:384
    global_store_dwordx4 v20, a[124:127], s[18:19] offset:448
    global_store_dwordx4 v20, a[140:143], s[18:19] offset:512
mlp_end:
    s_endpgm
.text
.globl reduce_kernel
.p2align 8
.type reduce_kernel,@function
reduce_kernel:
    s_cmp_ge_u32 s2, 576
    s_cbranch_scc1 red_end
    s_load_dwordx2 s[18:19], s[0:1], 128
    s_load_dwordx2 s[16:17], s[0:1], 112
    s_lshl_b32 s20, s2, 8
    v_add_u32 v1, s20, v0
    v_lshlrev_b32 v2, 5, v1
    v_lshlrev_b32 v3, 4, v1
    s_mov_b32 s21, 59652324
    v_mul_hi_u32 v4, v1, s21
    v_mul_u32_u24 v5, 72, v4
    v_sub_u32 v5, v1, v5
    v_lshlrev_b32 v5, 5, v5
    v_add_u32 v5, 11520, v5
    s_waitcnt lgkmcnt(0)
    global_load_dwordx4 v[8:11], v5, s[18:19]
    global_load_dwordx4 v[12:15], v5, s[18:19] offset:16
    v_add_u32 v6, 7094272, v3
    global_load_dwordx4 v[16:19], v6, s[18:19]
    v_add_u32 v7, 27148288, v2
    global_load_dwordx4 v[32:35], v7, s[18:19]
    global_load_dwordx4 v[36:39], v7, s[18:19] offset:16
    v_add_u32 v7, 4718592, v7
    global_load_dwordx4 v[40:43], v7, s[18:19]
    global_load_dwordx4 v[44:47], v7, s[18:19] offset:16
    v_add_u32 v7, 4718592, v7
    global_load_dwordx4 v[48:51], v7, s[18:19]
    global_load_dwordx4 v[52:55], v7, s[18:19] offset:16
    v_add_u32 v7, 4718592, v7
    global_load_dwordx4 v[56:59], v7, s[18:19]
    global_load_dwordx4 v[60:63], v7, s[18:19] offset:16
    v_add_u32 v7, 4718592, v7
    global_load_dwordx4 v[64:67], v7, s[18:19]
    global_load_dwordx4 v[68:71], v7, s[18:19] offset:16
    v_add_u32 v7, 4718592, v7
    global_load_dwordx4 v[72:75], v7, s[18:19]
    global_load_dwordx4 v[76:79], v7, s[18:19] offset:16
    v_add_u32 v7, 4718592, v7
    global_load_dwordx4 v[80:83], v7, s[18:19]
    global_load_dwordx4 v[84:87], v7, s[18:19] offset:16
    v_add_u32 v7, 4718592, v7
    global_load_dwordx4 v[88:91], v7, s[18:19]
    global_load_dwordx4 v[92:95], v7, s[18:19] offset:16
    s_waitcnt vmcnt(0)
    v_add_f32 v32, v32, v40
    v_add_f32 v33, v33, v41
    v_add_f32 v34, v34, v42
    v_add_f32 v35, v35, v43
    v_add_f32 v36, v36, v44
    v_add_f32 v37, v37, v45
    v_add_f32 v38, v38, v46
    v_add_f32 v39, v39, v47
    v_add_f32 v32, v32, v48
    v_add_f32 v33, v33, v49
    v_add_f32 v34, v34, v50
    v_add_f32 v35, v35, v51
    v_add_f32 v36, v36, v52
    v_add_f32 v37, v37, v53
    v_add_f32 v38, v38, v54
    v_add_f32 v39, v39, v55
    v_add_f32 v32, v32, v56
    v_add_f32 v33, v33, v57
    v_add_f32 v34, v34, v58
    v_add_f32 v35, v35, v59
    v_add_f32 v36, v36, v60
    v_add_f32 v37, v37, v61
    v_add_f32 v38, v38, v62
    v_add_f32 v39, v39, v63
    v_add_f32 v32, v32, v64
    v_add_f32 v33, v33, v65
    v_add_f32 v34, v34, v66
    v_add_f32 v35, v35, v67
    v_add_f32 v36, v36, v68
    v_add_f32 v37, v37, v69
    v_add_f32 v38, v38, v70
    v_add_f32 v39, v39, v71
    v_add_f32 v32, v32, v72
    v_add_f32 v33, v33, v73
    v_add_f32 v34, v34, v74
    v_add_f32 v35, v35, v75
    v_add_f32 v36, v36, v76
    v_add_f32 v37, v37, v77
    v_add_f32 v38, v38, v78
    v_add_f32 v39, v39, v79
    v_add_f32 v32, v32, v80
    v_add_f32 v33, v33, v81
    v_add_f32 v34, v34, v82
    v_add_f32 v35, v35, v83
    v_add_f32 v36, v36, v84
    v_add_f32 v37, v37, v85
    v_add_f32 v38, v38, v86
    v_add_f32 v39, v39, v87
    v_add_f32 v32, v32, v88
    v_add_f32 v33, v33, v89
    v_add_f32 v34, v34, v90
    v_add_f32 v35, v35, v91
    v_add_f32 v36, v36, v92
    v_add_f32 v37, v37, v93
    v_add_f32 v38, v38, v94
    v_add_f32 v39, v39, v95
    v_cvt_pk_bf16_f32 v20, v32, v33
    v_and_b32 v21, 0xffff0000, v20
    v_lshlrev_b32 v20, 16, v20
    v_mul_f32 v20, v20, v8
    v_mul_f32 v21, v21, v9
    v_cvt_pk_bf16_f32 v20, v20, v21
    v_and_b32 v21, 0xffff0000, v20
    v_lshlrev_b32 v20, 16, v20
    v_lshlrev_b32 v22, 16, v16
    v_and_b32 v23, 0xffff0000, v16
    v_add_f32 v20, v20, v22
    v_add_f32 v21, v21, v23
    v_cvt_pk_bf16_f32 v24, v20, v21
    v_cvt_pk_bf16_f32 v20, v34, v35
    v_and_b32 v21, 0xffff0000, v20
    v_lshlrev_b32 v20, 16, v20
    v_mul_f32 v20, v20, v10
    v_mul_f32 v21, v21, v11
    v_cvt_pk_bf16_f32 v20, v20, v21
    v_and_b32 v21, 0xffff0000, v20
    v_lshlrev_b32 v20, 16, v20
    v_lshlrev_b32 v22, 16, v17
    v_and_b32 v23, 0xffff0000, v17
    v_add_f32 v20, v20, v22
    v_add_f32 v21, v21, v23
    v_cvt_pk_bf16_f32 v25, v20, v21
    v_cvt_pk_bf16_f32 v20, v36, v37
    v_and_b32 v21, 0xffff0000, v20
    v_lshlrev_b32 v20, 16, v20
    v_mul_f32 v20, v20, v12
    v_mul_f32 v21, v21, v13
    v_cvt_pk_bf16_f32 v20, v20, v21
    v_and_b32 v21, 0xffff0000, v20
    v_lshlrev_b32 v20, 16, v20
    v_lshlrev_b32 v22, 16, v18
    v_and_b32 v23, 0xffff0000, v18
    v_add_f32 v20, v20, v22
    v_add_f32 v21, v21, v23
    v_cvt_pk_bf16_f32 v26, v20, v21
    v_cvt_pk_bf16_f32 v20, v38, v39
    v_and_b32 v21, 0xffff0000, v20
    v_lshlrev_b32 v20, 16, v20
    v_mul_f32 v20, v20, v14
    v_mul_f32 v21, v21, v15
    v_cvt_pk_bf16_f32 v20, v20, v21
    v_and_b32 v21, 0xffff0000, v20
    v_lshlrev_b32 v20, 16, v20
    v_lshlrev_b32 v22, 16, v19
    v_and_b32 v23, 0xffff0000, v19
    v_add_f32 v20, v20, v22
    v_add_f32 v21, v21, v23
    v_cvt_pk_bf16_f32 v27, v20, v21
    global_store_dwordx4 v3, v[24:27], s[16:17]
red_end:
    s_endpgm
.section .rodata,"a"
.p2align 6
.amdhsa_kernel prep_kernel
  .amdhsa_next_free_vgpr 144
  .amdhsa_next_free_sgpr 96
  .amdhsa_accum_offset 144
  .amdhsa_group_segment_fixed_size 0
  .amdhsa_kernarg_size 136
  .amdhsa_user_sgpr_count 2
  .amdhsa_user_sgpr_kernarg_segment_ptr 1
  .amdhsa_system_sgpr_workgroup_id_x 1
.end_amdhsa_kernel
.section .rodata,"a"
.p2align 6
.amdhsa_kernel conv_kernel
  .amdhsa_next_free_vgpr 128
  .amdhsa_next_free_sgpr 96
  .amdhsa_accum_offset 96
  .amdhsa_group_segment_fixed_size 0
  .amdhsa_kernarg_size 136
  .amdhsa_user_sgpr_count 2
  .amdhsa_user_sgpr_kernarg_segment_ptr 1
  .amdhsa_system_sgpr_workgroup_id_x 1
.end_amdhsa_kernel
.section .rodata,"a"
.p2align 6
.amdhsa_kernel ln2_kernel
  .amdhsa_next_free_vgpr 128
  .amdhsa_next_free_sgpr 96
  .amdhsa_accum_offset 128
  .amdhsa_group_segment_fixed_size 0
  .amdhsa_kernarg_size 136
  .amdhsa_user_sgpr_count 2
  .amdhsa_user_sgpr_kernarg_segment_ptr 1
  .amdhsa_system_sgpr_workgroup_id_x 1
.end_amdhsa_kernel
.section .rodata,"a"
.p2align 6
.amdhsa_kernel mlp_kernel
  .amdhsa_next_free_vgpr 320
  .amdhsa_next_free_sgpr 96
  .amdhsa_accum_offset 176
  .amdhsa_group_segment_fixed_size 0
  .amdhsa_kernarg_size 136
  .amdhsa_user_sgpr_count 2
  .amdhsa_user_sgpr_kernarg_segment_ptr 1
  .amdhsa_system_sgpr_workgroup_id_x 1
.end_amdhsa_kernel
.section .rodata,"a"
.p2align 6
.amdhsa_kernel reduce_kernel
  .amdhsa_next_free_vgpr 100
  .amdhsa_next_free_sgpr 96
  .amdhsa_accum_offset 100
  .amdhsa_group_segment_fixed_size 0
  .amdhsa_kernarg_size 136
  .amdhsa_user_sgpr_count 2
  .amdhsa_user_sgpr_kernarg_segment_ptr 1
  .amdhsa_system_sgpr_workgroup_id_x 1
.end_amdhsa_kernel
```
